```python
import torch

def _softmax(x, axis=-1):
    return torch.softmax(x, dim=axis)
def _gelu(x):
    return torch.nn.functional.gelu(x, approximate="tanh")
def _silu(x):
    return torch.nn.functional.silu(x)
def _sigmoid(x):
    return torch.sigmoid(x)
def _layernorm(x, axis=-1, eps=1e-5):
    m = x.mean(dim=axis, keepdim=True)
    v = x.var(dim=axis, keepdim=True, unbiased=False)
    return (x - m) / torch.sqrt(v + eps)
def _scatter_add(tgt, idx, src, axis=0):
    return tgt.clone().index_add_(axis, idx, src)
def _segment_sum(src, seg, n):
    out = torch.zeros((n,) + src.shape[1:], dtype=src.dtype)
    return out.index_add_(0, seg, src)
def _pad(x, pw):
    flat = tuple(v for pair in reversed(pw) for v in pair)
    return torch.nn.functional.pad(x, flat)

kernel_name = 'interleave_layers__sliding_block__glu_gated_geglu__prompt'

def setup_inputs():

    _w = (lambda a: (lambda t: t.to(torch.bfloat16) if t.is_floating_point() else t)(torch.as_tensor(a)))
    def _A_setup():
        B, S, D = 1, 2048, 576
        return {
            "x": _w((lambda *s: torch.randn(*s, dtype=torch.bfloat16) * 0.05)(B, S, D)),
            "wqkv": _w((lambda *s: torch.randn(*s, dtype=torch.bfloat16) * 0.05)(D, 3 * D)),
            "wo": _w((lambda *s: torch.randn(*s, dtype=torch.bfloat16) * 0.05)(D, D)),
        }
    _A_in = _A_setup()

    def _B_setup():
        B, S, Dm, Df = 1, 2048, 576, 4608
        return {
            "x": _w((lambda *s: torch.randn(*s, dtype=torch.bfloat16) * 0.05)(B, S, Dm)),
            "w_gate": _w((lambda *s: torch.randn(*s, dtype=torch.bfloat16) * 0.8)(Dm, Df) * (Dm ** -0.5)),
            "w_up": _w((lambda *s: torch.randn(*s, dtype=torch.bfloat16) * 0.8)(Dm, Df) * (Dm ** -0.5)),
            "w_down": _w((lambda *s: torch.randn(*s, dtype=torch.bfloat16) * 0.8)(Df, Dm) * (Df ** -0.5)),
        }
    _B_in = _B_setup()

    return {
        "A_x": _A_in["x"],
        "A_wqkv": _A_in["wqkv"],
        "A_wo": _A_in["wo"],
        "B_x": _B_in["x"],
        "B_w_gate": _B_in["w_gate"],
        "B_w_up": _B_in["w_up"],
        "B_w_down": _B_in["w_down"],
    }

def reference(A_x, A_wqkv, A_wo, B_x, B_w_gate, B_w_up, B_w_down):
    def _A_ref(x, wqkv, wo):
        B, S, D = x.shape
        H = 32; Dh = D // H; W = 256
        qkv = (lambda x, *d: x.permute(*d))((x @ wqkv).reshape(B, S, 3, H, Dh), 2, 0, 3, 1, 4)
        q, k, v = qkv[0], qkv[1], qkv[2]
        scores = torch.einsum("bhqd,bhkd->bhqk", q, k) * (Dh ** -0.5)
        idx = torch.arange(S)
        mask = (idx[:, None] - idx[None, :] >= 0) & (idx[:, None] - idx[None, :] < W)
        scores = torch.where(mask[None, None], scores, -1e9)
        p = _softmax(scores, axis=-1)
        o = torch.einsum("bhqk,bhkd->bhqd", p, v)
        return (lambda x, *d: x.permute(*d))(o, 0, 2, 1, 3).reshape(B, S, D) @ wo

    def _B_ref(x, w_gate, w_up, w_down):
        g = torch.einsum("bsd,df->bsf", x, w_gate)
        u = torch.einsum("bsd,df->bsf", x, w_up)
        h = _gelu(g) * u
        return torch.einsum("bsf,fd->bsd", h, w_down)

    x = A_x
    x = x + _A_ref(_layernorm(x, axis=-1), A_wqkv, A_wo)
    x = x + _B_ref(_layernorm(x, axis=-1), B_w_gate, B_w_up, B_w_down)
    x = x + _A_ref(_layernorm(x, axis=-1), A_wqkv, A_wo)
    x = x + _B_ref(_layernorm(x, axis=-1), B_w_gate, B_w_up, B_w_down)
    return x
```

```asm
; @launch kernel=prep_kernel grid=(256,1,1) block=(256,1,1) lds=75008
; @launch kernel=main_kernel grid=(256,1,1) block=(256,1,1) lds=163840
.amdgcn_target "amdgcn-amd-amdhsa--gfx950"
.text
.globl prep_kernel
.p2align 8
.type prep_kernel,@function
prep_kernel:
  s_cmp_ge_u32 s2, 256
  s_cbranch_scc1 prep_kernel_fin2
  s_load_dwordx4 s[36:39], s[0:1], 0
  s_load_dwordx4 s[52:55], s[0:1], 32
  s_load_dwordx2 s[50:51], s[0:1], 72
  v_and_b32 v1, 63, v0
  s_lshr_b32 s59, s2, 3
  s_cmp_ge_u32 s59, 2
  s_cbranch_scc1 cp_self_skip
  s_getpc_b64 s[60:61]
cp_self:
  s_lshl_b32 s62, s59, 13
  s_sub_u32 s60, s60, cp_self-prep_kernel
  s_subb_u32 s61, s61, 0
  s_add_u32 s60, s60, s62
  s_addc_u32 s61, s61, 0
  v_lshlrev_b32 v100, 7, v1
  v_mov_b32 v101, s61
  v_add_co_u32 v100, vcc, s60, v100
  s_nop 1
  v_addc_co_u32 v101, vcc, 0, v101, vcc
  global_load_dword v102, v[100:101], off
cp_self_skip:
  s_mov_b32 s44, s2
  s_mov_b32 s46, 0
  s_mov_b32 s45, 1
  s_mov_b32 s43, 256
  s_cmp_lt_u32 s44, 144
  s_cbranch_scc1 prep_kernel_c2
  s_add_u32 s44, s44, 72
  s_min_u32 s44, s44, 256
  s_branch prep_kernel_c2
prep_common:
  s_load_dwordx4 s[36:39], s[0:1], 0
  s_load_dwordx4 s[52:55], s[0:1], 32
  s_load_dwordx2 s[50:51], s[0:1], 72
prep_kernel_c2:
  v_lshrrev_b32 v2, 6, v0
  v_and_b32 v3, 7, v1
  v_lshrrev_b32 v4, 3, v1
  v_readfirstlane_b32 s20, v2
  s_mov_b32 s11, 0x20000
  s_mov_b32 s47, 0
  s_mov_b32 s42, 0
  s_mul_i32 s24, s20, 18432
  s_cmp_lt_u32 s44, 144
  s_cbranch_scc0 prep_kernel_oth
  s_cmp_ge_u32 s44, 72
  s_cselect_b32 s26, 72, 0
  s_cselect_b32 s27, 1, 0
  s_mov_b32 s28, 9216
  s_mov_b32 s10, 5308416
  s_waitcnt lgkmcnt(0)
  s_cselect_b32 s8, s54, s52
  s_cselect_b32 s9, s55, s53
  s_sub_u32 s26, s44, s26
prep_kernel_ldG2:
  s_lshl_b32 s26, s26, 1
  s_lshr_b32 s29, s46, 1
  s_add_u32 s26, s26, s29
  s_min_u32 s29, s46, 1
  s_lshl_b32 s29, s29, 2
  v_mul_lo_u32 v20, v4, s28
  v_lshl_add_u32 v20, v3, 4, v20
  v_and_b32 v21, s29, v3
  v_lshl_or_b32 v20, v21, 29, v20
  s_lshl_b32 s25, s26, 6
  s_mul_i32 s29, s20, 144
  s_mul_i32 s29, s29, s28
  s_add_u32 s25, s25, s29
  s_lshl_b32 s29, s28, 3
  s_mov_b32 m0, s24
  s_add_u32 s30, s24, 18432
prep_kernel_gl:
  buffer_load_dwordx4 v20, s[8:11], s25 offen nt lds
  s_add_u32 m0, m0, 1024
  s_add_u32 s25, s25, s29
  buffer_load_dwordx4 v20, s[8:11], s25 offen nt lds
  s_add_u32 m0, m0, 1024
  s_add_u32 s25, s25, s29
  s_cmp_lt_u32 m0, s30
  s_cbranch_scc1 prep_kernel_gl
  s_branch prep_kernel_w18
prep_kernel_oth:
  s_load_dwordx2 s[40:41], s[0:1], 16
  s_load_dwordx2 s[48:49], s[0:1], 48
  s_waitcnt lgkmcnt(0)
  s_cmp_lt_u32 s44, 216
  s_cbranch_scc1 prep_kernel_ldD
  s_cmp_ge_u32 s44, 243
  s_cbranch_scc1 prep_kernel_o2
  s_mov_b32 s8, s38
  s_mov_b32 s9, s39
  s_mov_b32 s10, 1990656
  s_mov_b32 s11, 0x20000
  s_mov_b32 s28, 3456
  s_sub_u32 s26, s44, 216
  s_branch prep_kernel_ldG2
prep_kernel_o2:
  s_cmp_lt_u32 s44, 252
  s_cbranch_scc1 prep_kernel_ldWo
  s_cmp_ge_u32 s44, 254
  s_cbranch_scc1 prep_kernel_w18
  s_mov_b32 s12, s50
  s_mov_b32 s13, s51
  s_mov_b32 s14, 268435456
  s_mov_b32 s15, 0x20000
  s_cmp_eq_u32 s44, 252
  s_cbranch_scc1 prep_kernel_zero
  v_mov_b32 v24, 0x3f803f80
  v_lshlrev_b32 v20, 2, v1
  v_cmp_gt_u32 vcc, 16, v0
  s_and_saveexec_b64 s[26:27], vcc
  s_cbranch_execz prep_kernel_ones1
  s_mov_b32 s25, 44302336
  buffer_store_dword v24, v20, s[12:15], s25 offen sc1
  s_add_u32 s25, s25, 67108864
  buffer_store_dword v24, v20, s[12:15], s25 offen sc1
prep_kernel_ones1:
  s_mov_b64 exec, s[26:27]
  s_branch prep_kernel_w18
prep_kernel_zero:
  v_mov_b32 v24, 0
  v_mov_b32 v25, 0
  v_mov_b32 v26, 0
  v_mov_b32 v27, 0
  v_lshlrev_b32 v20, 4, v1
  s_mul_i32 s25, s20, 18432
  s_add_u32 s25, s25, 1917952
  s_mov_b32 s26, 0
  s_add_u32 s27, s25, 73728
prep_kernel_zerol:
  buffer_store_dwordx4 v[24:27], v20, s[12:15], s25 offen sc1
  buffer_store_dwordx4 v[24:27], v20, s[12:15], s27 offen sc1
  s_add_u32 s25, s25, 2048
  s_add_u32 s27, s27, 2048
  s_add_u32 s26, s26, 1
  s_cmp_lt_u32 s26, 9
  s_cbranch_scc1 prep_kernel_zerol
  s_branch prep_kernel_w18
prep_kernel_ldD:
  s_mov_b32 s8, s48
  s_mov_b32 s9, s49
  s_mov_b32 s10, 5308416
  s_mov_b32 s11, 0x20000
  s_sub_u32 s26, s44, 144
  s_mul_i32 s25, s26, 73728
  s_lshr_b32 s29, s20, 1
  s_mul_i32 s29, s29, 36864
  s_add_u32 s25, s25, s29
  s_and_b32 s29, s20, 1
  s_mul_i32 s29, s29, 576
  s_add_u32 s25, s25, s29
  v_cmp_le_u32 vcc, 36, v1
  v_lshlrev_b32 v23, 4, v1
  v_add_u32 v24, 576, v23
  v_subrev_u32 v22, 36, v1
  v_cndmask_b32 v23, v23, v24, vcc
  v_cndmask_b32 v22, v1, v22, vcc
  s_add_u32 m0, s24, 0
  s_nop 0
  buffer_load_dwordx4 v23, s[8:11], s25 offen nt lds
  v_add_u32 v22, 28, v22
  v_cmp_le_u32 vcc, 36, v22
  v_add_u32 v23, 1600, v23
  v_add_u32 v24, 576, v23
  v_subrev_u32 v25, 36, v22
  v_cndmask_b32 v23, v23, v24, vcc
  v_cndmask_b32 v22, v22, v25, vcc
  s_add_u32 m0, s24, 1024
  s_nop 0
  buffer_load_dwordx4 v23, s[8:11], s25 offen nt lds
  v_add_u32 v22, 28, v22
  v_cmp_le_u32 vcc, 36, v22
  v_add_u32 v23, 1600, v23
  v_add_u32 v24, 576, v23
  v_subrev_u32 v25, 36, v22
  v_cndmask_b32 v23, v23, v24, vcc
  v_cndmask_b32 v22, v22, v25, vcc
  s_add_u32 m0, s24, 2048
  s_nop 0
  buffer_load_dwordx4 v23, s[8:11], s25 offen nt lds
  v_add_u32 v22, 28, v22
  v_cmp_le_u32 vcc, 36, v22
  v_add_u32 v23, 1600, v23
  v_add_u32 v24, 576, v23
  v_subrev_u32 v25, 36, v22
  v_cndmask_b32 v23, v23, v24, vcc
  v_cndmask_b32 v22, v22, v25, vcc
  s_add_u32 m0, s24, 3072
  s_nop 0
  buffer_load_dwordx4 v23, s[8:11], s25 offen nt lds
  v_add_u32 v22, 28, v22
  v_cmp_le_u32 vcc, 36, v22
  v_add_u32 v23, 1600, v23
  v_add_u32 v24, 576, v23
  v_subrev_u32 v25, 36, v22
  v_cndmask_b32 v23, v23, v24, vcc
  v_cndmask_b32 v22, v22, v25, vcc
  s_add_u32 m0, s24, 4096
  s_nop 0
  buffer_load_dwordx4 v23, s[8:11], s25 offen nt lds
  v_add_u32 v22, 28, v22
  v_cmp_le_u32 vcc, 36, v22
  v_add_u32 v23, 1600, v23
  v_add_u32 v24, 576, v23
  v_subrev_u32 v25, 36, v22
  v_cndmask_b32 v23, v23, v24, vcc
  v_cndmask_b32 v22, v22, v25, vcc
  s_add_u32 m0, s24, 5120
  s_nop 0
  buffer_load_dwordx4 v23, s[8:11], s25 offen nt lds
  v_add_u32 v22, 28, v22
  v_cmp_le_u32 vcc, 36, v22
  v_add_u32 v23, 1600, v23
  v_add_u32 v24, 576, v23
  v_subrev_u32 v25, 36, v22
  v_cndmask_b32 v23, v23, v24, vcc
  v_cndmask_b32 v22, v22, v25, vcc
  s_add_u32 m0, s24, 6144
  s_nop 0
  buffer_load_dwordx4 v23, s[8:11], s25 offen nt lds
  v_add_u32 v22, 28, v22
  v_cmp_le_u32 vcc, 36, v22
  v_add_u32 v23, 1600, v23
  v_add_u32 v24, 576, v23
  v_subrev_u32 v25, 36, v22
  v_cndmask_b32 v23, v23, v24, vcc
  v_cndmask_b32 v22, v22, v25, vcc
  s_add_u32 m0, s24, 7168
  s_nop 0
  buffer_load_dwordx4 v23, s[8:11], s25 offen nt lds
  v_add_u32 v22, 28, v22
  v_cmp_le_u32 vcc, 36, v22
  v_add_u32 v23, 1600, v23
  v_add_u32 v24, 576, v23
  v_subrev_u32 v25, 36, v22
  v_cndmask_b32 v23, v23, v24, vcc
  v_cndmask_b32 v22, v22, v25, vcc
  s_add_u32 m0, s24, 8192
  s_nop 0
  buffer_load_dwordx4 v23, s[8:11], s25 offen nt lds
  v_add_u32 v22, 28, v22
  v_cmp_le_u32 vcc, 36, v22
  v_add_u32 v23, 1600, v23
  v_add_u32 v24, 576, v23
  v_subrev_u32 v25, 36, v22
  v_cndmask_b32 v23, v23, v24, vcc
  v_cndmask_b32 v22, v22, v25, vcc
  s_add_u32 m0, s24, 9216
  s_nop 0
  buffer_load_dwordx4 v23, s[8:11], s25 offen nt lds
  v_add_u32 v22, 28, v22
  v_cmp_le_u32 vcc, 36, v22
  v_add_u32 v23, 1600, v23
  v_add_u32 v24, 576, v23
  v_subrev_u32 v25, 36, v22
  v_cndmask_b32 v23, v23, v24, vcc
  v_cndmask_b32 v22, v22, v25, vcc
  s_add_u32 m0, s24, 10240
  s_nop 0
  buffer_load_dwordx4 v23, s[8:11], s25 offen nt lds
  v_add_u32 v22, 28, v22
  v_cmp_le_u32 vcc, 36, v22
  v_add_u32 v23, 1600, v23
  v_add_u32 v24, 576, v23
  v_subrev_u32 v25, 36, v22
  v_cndmask_b32 v23, v23, v24, vcc
  v_cndmask_b32 v22, v22, v25, vcc
  s_add_u32 m0, s24, 11264
  s_nop 0
  buffer_load_dwordx4 v23, s[8:11], s25 offen nt lds
  v_add_u32 v22, 28, v22
  v_cmp_le_u32 vcc, 36, v22
  v_add_u32 v23, 1600, v23
  v_add_u32 v24, 576, v23
  v_subrev_u32 v25, 36, v22
  v_cndmask_b32 v23, v23, v24, vcc
  v_cndmask_b32 v22, v22, v25, vcc
  s_add_u32 m0, s24, 12288
  s_nop 0
  buffer_load_dwordx4 v23, s[8:11], s25 offen nt lds
  v_add_u32 v22, 28, v22
  v_cmp_le_u32 vcc, 36, v22
  v_add_u32 v23, 1600, v23
  v_add_u32 v24, 576, v23
  v_subrev_u32 v25, 36, v22
  v_cndmask_b32 v23, v23, v24, vcc
  v_cndmask_b32 v22, v22, v25, vcc
  s_add_u32 m0, s24, 13312
  s_nop 0
  buffer_load_dwordx4 v23, s[8:11], s25 offen nt lds
  v_add_u32 v22, 28, v22
  v_cmp_le_u32 vcc, 36, v22
  v_add_u32 v23, 1600, v23
  v_add_u32 v24, 576, v23
  v_subrev_u32 v25, 36, v22
  v_cndmask_b32 v23, v23, v24, vcc
  v_cndmask_b32 v22, v22, v25, vcc
  s_add_u32 m0, s24, 14336
  s_nop 0
  buffer_load_dwordx4 v23, s[8:11], s25 offen nt lds
  v_add_u32 v22, 28, v22
  v_cmp_le_u32 vcc, 36, v22
  v_add_u32 v23, 1600, v23
  v_add_u32 v24, 576, v23
  v_subrev_u32 v25, 36, v22
  v_cndmask_b32 v23, v23, v24, vcc
  v_cndmask_b32 v22, v22, v25, vcc
  s_add_u32 m0, s24, 15360
  s_nop 0
  buffer_load_dwordx4 v23, s[8:11], s25 offen nt lds
  v_add_u32 v22, 28, v22
  v_cmp_le_u32 vcc, 36, v22
  v_add_u32 v23, 1600, v23
  v_add_u32 v24, 576, v23
  v_subrev_u32 v25, 36, v22
  v_cndmask_b32 v23, v23, v24, vcc
  v_cndmask_b32 v22, v22, v25, vcc
  s_add_u32 m0, s24, 16384
  s_nop 0
  buffer_load_dwordx4 v23, s[8:11], s25 offen nt lds
  v_add_u32 v22, 28, v22
  v_cmp_le_u32 vcc, 36, v22
  v_add_u32 v23, 1600, v23
  v_add_u32 v24, 576, v23
  v_subrev_u32 v25, 36, v22
  v_cndmask_b32 v23, v23, v24, vcc
  v_cndmask_b32 v22, v22, v25, vcc
  s_add_u32 m0, s24, 17408
  s_nop 0
  buffer_load_dwordx4 v23, s[8:11], s25 offen nt lds
  s_branch prep_kernel_w18
prep_kernel_ldWo:
  s_mov_b32 s8, s40
  s_mov_b32 s9, s41
  s_mov_b32 s10, 663552
  s_mov_b32 s11, 0x20000
  s_sub_u32 s26, s44, 243
  s_lshl_b32 s31, s26, 6
  s_lshl_b32 s29, s20, 4
  s_add_u32 s31, s31, s29
  v_mov_b32 v21, s31
  v_mov_b32 v22, v1
  s_mov_b32 s30, 0
prep_kernel_wol:
  v_lshrrev_b32 v26, 4, v21
  v_mul_u32_u24 v26, 18, v26
  v_and_b32 v27, 3, v21
  v_add_u32 v26, v26, v27
  v_bfe_u32 v27, v21, 3, 1
  v_lshl_add_u32 v26, v27, 2, v26
  v_bfe_u32 v27, v21, 2, 1
  v_lshl_add_u32 v26, v27, 3, v26
  v_bfe_u32 v27, v21, 2, 4
  v_bfe_u32 v28, v21, 1, 1
  v_lshl_add_u32 v27, v28, 4, v27
  v_mul_u32_u24 v27, 18, v27
  v_and_b32 v28, 1, v21
  v_cmp_le_u32 vcc, 512, v21
  v_add3_u32 v27, v27, v28, 16
  s_add_u32 m0, s24, s30
  v_cndmask_b32 v26, v26, v27, vcc
  v_mul_u32_u24 v23, 1152, v26
  v_lshl_add_u32 v23, v22, 4, v23
  buffer_load_dwordx4 v23, s[8:11], 0 offen nt lds
  v_add_u32 v22, 64, v22
  v_cmp_le_u32 vcc, 72, v22
  v_subrev_u32 v24, 72, v22
  s_add_u32 s30, s30, 1024
  v_cndmask_b32 v22, v22, v24, vcc
  v_addc_co_u32 v21, vcc, 0, v21, vcc
  s_cmp_lt_u32 s30, 18432
  s_cbranch_scc1 prep_kernel_wol
prep_kernel_w18:
  s_mov_b32 s12, s50
  s_mov_b32 s13, s51
  s_mov_b32 s14, 268435456
  s_mov_b32 s15, 0x20000
  s_mov_b32 s21, 0x3f803f80
  s_cmp_eq_u32 s45, 0
  s_cbranch_scc1 prep_kernel_lnskip
  s_lshr_b32 s59, s2, 3
  s_lshl_b32 s59, s59, 2
  s_add_u32 s59, s59, s20
  s_cmp_ge_u32 s59, 3
  s_cbranch_scc1 cp_prep_skip
  s_getpc_b64 s[60:61]
cp_prep:
  s_lshl_b32 s62, s59, 13
  s_add_u32 s62, s62, main_kernel-cp_prep
  s_add_u32 s60, s60, s62
  s_addc_u32 s61, s61, 0
  v_lshlrev_b32 v104, 7, v1
  v_mov_b32 v105, s61
  v_add_co_u32 v104, vcc, s60, v104
  s_nop 1
  v_addc_co_u32 v105, vcc, 0, v105, vcc
  global_load_dword v106, v[104:105], off
cp_prep_skip:
  v_mul_u32_u24 v5, 1152, v3
  v_lshl_add_u32 v5, v4, 4, v5
  s_mul_i32 s22, s2, 9216
  s_mul_i32 s23, s20, 384
  s_add_u32 s22, s22, s23
  s_cmp_eq_u32 s20, 3
  s_cselect_b32 s22, 2359296, s22
  s_mov_b32 s16, s36
  s_mov_b32 s17, s37
  s_mov_b32 s18, 2359296
  s_mov_b32 s19, 0x20000
  buffer_load_dwordx4 v[120:123], v5, s[16:19], s22 offen offset:0
  buffer_load_dwordx4 v[124:127], v5, s[16:19], s22 offen offset:128
  buffer_load_dwordx4 v[128:131], v5, s[16:19], s22 offen offset:256
  s_cmp_lt_u32 s44, 252
  s_cbranch_scc1 prep_kernel_ln2
  s_lshr_b32 s33, s2, 3
  s_sub_u32 s33, s33, 23
  s_lshl_b32 s33, s33, 2
  s_add_u32 s33, s33, s20
  s_mul_i32 s33, s33, 134217728
  v_lshlrev_b32 v7, 21, v1
  s_cmp_lt_u32 s2, 184
  s_cselect_b32 s33, 268435456, s33
  buffer_load_dword v8, v7, s[12:15], s33 offen
  s_waitcnt vmcnt(0)
  s_branch prep_kernel_x
prep_kernel_lnskip:
prep_kernel_ln2:
  s_cmp_ge_u32 s44, 252
  s_cbranch_scc1 prep_kernel_end
  v_lshrrev_b32 v20, 4, v1
  v_bfe_u32 v21, v1, 2, 2
  v_and_b32 v22, 3, v1
  v_lshrrev_b32 v23, 1, v20
  v_and_b32 v24, 1, v20
  v_lshlrev_b32 v31, 4, v1
  s_cmp_lt_u32 s44, 144
  s_cbranch_scc1 prep_kernel_pG
  s_cmp_lt_u32 s44, 216
  s_cbranch_scc1 prep_kernel_pD
  s_cmp_ge_u32 s44, 243
  s_cbranch_scc1 prep_kernel_pWo
  s_lshl_b32 s29, s26, 3
  v_bfe_u32 v25, v1, 2, 3
  v_add_u32 v25, s29, v25
  v_mul_u32_u24 v26, 456, v25
  v_lshrrev_b32 v26, 16, v26
  v_mul_u32_u24 v27, 144, v26
  v_sub_u32 v27, v25, v27
  v_mul_u32_u24 v32, 7282, v27
  v_lshrrev_b32 v32, 16, v32
  v_mul_u32_u24 v33, 9, v32
  v_sub_u32 v33, v27, v33
  v_cmp_lt_u32 vcc, 4, v33
  v_add_u32 v34, 3, v33
  v_lshrrev_b32 v36, 3, v32
  v_cndmask_b32 v34, v33, v34, vcc
  v_and_b32 v35, 1, v34
  v_lshlrev_b32 v35, 3, v35
  v_bfe_u32 v37, v34, 1, 1
  v_lshl_add_u32 v35, v37, 2, v35
  v_bfe_u32 v37, v34, 3, 1
  v_lshl_add_u32 v35, v37, 4, v35
  v_lshl_add_u32 v36, v36, 1, v26
  v_add_u32 v36, 32, v36
  v_and_b32 v37, 3, v32
  v_lshlrev_b32 v37, 3, v37
  v_bfe_u32 v38, v32, 2, 1
  v_lshl_add_u32 v37, v38, 2, v37
  v_bfe_u32 v38, v32, 1, 2
  v_lshl_add_u32 v38, v26, 2, v38
  v_lshrrev_b32 v39, 3, v32
  v_and_b32 v32, 1, v32
  v_lshl_add_u32 v32, v39, 1, v32
  v_lshl_add_u32 v32, v38, 2, v32
  v_cmp_eq_u32 vcc, 4, v33
  v_lshrrev_b32 v38, 3, v27
  v_add_u32 v39, -9, v38
  v_cndmask_b32 v32, v32, v36, vcc
  v_cndmask_b32 v35, v35, v37, vcc
  v_cmp_lt_u32 vcc, 8, v38
  v_and_b32 v37, 7, v27
  v_lshlrev_b32 v37, 2, v37
  v_cndmask_b32 v38, v38, v39, vcc
  v_cndmask_b32 v39, 0, 2, vcc
  v_and_b32 v36, 1, v38
  v_add3_u32 v39, v39, v36, 36
  v_lshrrev_b32 v38, 1, v38
  v_cmp_eq_u32 vcc, 2, v26
  v_lshl_add_u32 v38, v38, 2, v39
  v_mov_b32 v18, 0x800
  v_cndmask_b32 v32, v32, v38, vcc
  v_cndmask_b32 v35, v35, v37, vcc
  v_lshrrev_b32 v36, 2, v32
  v_mul_u32_u24 v36, 144, v36
  v_bfe_u32 v33, v32, 1, 1
  v_mul_u32_u24 v33, 72, v33
  v_and_b32 v32, 1, v32
  v_add3_u32 v32, v32, v36, v33
  v_add_u32 v35, v35, v22
  v_lshl_add_u32 v35, v23, 5, v35
  v_lshlrev_b32 v35, 4, v35
  v_lshl_add_u32 v28, v32, 10, v35
  s_mov_b32 s30, 0
  v_add_u32 v25, 8, v25
  v_mul_u32_u24 v26, 456, v25
  v_lshrrev_b32 v26, 16, v26
  v_mul_u32_u24 v27, 144, v26
  v_sub_u32 v27, v25, v27
  v_mul_u32_u24 v32, 7282, v27
  v_lshrrev_b32 v32, 16, v32
  v_mul_u32_u24 v33, 9, v32
  v_sub_u32 v33, v27, v33
  v_cmp_lt_u32 vcc, 4, v33
  v_add_u32 v34, 3, v33
  v_lshrrev_b32 v36, 3, v32
  v_cndmask_b32 v34, v33, v34, vcc
  v_and_b32 v35, 1, v34
  v_lshlrev_b32 v35, 3, v35
  v_bfe_u32 v37, v34, 1, 1
  v_lshl_add_u32 v35, v37, 2, v35
  v_bfe_u32 v37, v34, 3, 1
  v_lshl_add_u32 v35, v37, 4, v35
  v_lshl_add_u32 v36, v36, 1, v26
  v_add_u32 v36, 32, v36
  v_and_b32 v37, 3, v32
  v_lshlrev_b32 v37, 3, v37
  v_bfe_u32 v38, v32, 2, 1
  v_lshl_add_u32 v37, v38, 2, v37
  v_bfe_u32 v38, v32, 1, 2
  v_lshl_add_u32 v38, v26, 2, v38
  v_lshrrev_b32 v39, 3, v32
  v_and_b32 v32, 1, v32
  v_lshl_add_u32 v32, v39, 1, v32
  v_lshl_add_u32 v32, v38, 2, v32
  v_cmp_eq_u32 vcc, 4, v33
  v_lshrrev_b32 v38, 3, v27
  v_add_u32 v39, -9, v38
  v_cndmask_b32 v32, v32, v36, vcc
  v_cndmask_b32 v35, v35, v37, vcc
  v_cmp_lt_u32 vcc, 8, v38
  v_and_b32 v37, 7, v27
  v_lshlrev_b32 v37, 2, v37
  v_cndmask_b32 v38, v38, v39, vcc
  v_cndmask_b32 v39, 0, 2, vcc
  v_and_b32 v36, 1, v38
  v_add3_u32 v39, v39, v36, 36
  v_lshrrev_b32 v38, 1, v38
  v_cmp_eq_u32 vcc, 2, v26
  v_lshl_add_u32 v38, v38, 2, v39
  v_mov_b32 v19, 0x800
  v_cndmask_b32 v32, v32, v38, vcc
  v_cndmask_b32 v35, v35, v37, vcc
  v_lshrrev_b32 v36, 2, v32
  v_mul_u32_u24 v36, 144, v36
  v_bfe_u32 v33, v32, 1, 1
  v_mul_u32_u24 v33, 72, v33
  v_and_b32 v32, 1, v32
  v_add3_u32 v32, v32, v36, v33
  v_add_u32 v35, v35, v22
  v_lshl_add_u32 v35, v23, 5, v35
  v_lshlrev_b32 v35, 4, v35
  v_lshl_add_u32 v29, v32, 10, v35
  s_branch prep_kernel_pG2
prep_kernel_pG:
  s_lshl_b32 s29, s26, 1
  v_add_u32 v25, s29, v24
  v_bfe_u32 v35, v1, 2, 1
  v_lshlrev_b32 v35, 3, v35
  v_bfe_u32 v36, v1, 3, 1
  v_lshl_add_u32 v35, v36, 2, v35
  v_add_u32 v35, v35, v22
  s_lshl_b32 s29, s27, 4
  v_add_u32 v35, s29, v35
  v_lshl_add_u32 v35, v23, 5, v35
  v_lshlrev_b32 v35, 4, v35
  v_mov_b32 v37, 0x400
  v_mov_b32 v38, 4096
  v_mul_u32_u24 v26, 7282, v25
  v_lshrrev_b32 v26, 16, v26
  v_mul_u32_u24 v27, 9, v26
  v_sub_u32 v27, v25, v27
  v_cmp_gt_u32 vcc, 4, v27
  v_mul_u32_u24 v32, 36, v27
  v_mul_u32_u24 v26, 324, v26
  v_cndmask_b32 v32, v32, v27, vcc
  v_cndmask_b32 v18, v37, v38, vcc
  v_add_u32 v32, v32, v26
  v_lshl_add_u32 v28, v32, 10, v35
  v_add_u32 v25, 2, v25
  v_mul_u32_u24 v26, 7282, v25
  v_lshrrev_b32 v26, 16, v26
  v_mul_u32_u24 v27, 9, v26
  v_sub_u32 v27, v25, v27
  v_cmp_gt_u32 vcc, 4, v27
  v_mul_u32_u24 v32, 36, v27
  v_mul_u32_u24 v26, 324, v26
  v_cndmask_b32 v32, v32, v27, vcc
  v_cndmask_b32 v19, v37, v38, vcc
  v_add_u32 v32, v32, v26
  v_lshl_add_u32 v29, v32, 10, v35
  s_mov_b32 s30, 3145728
prep_kernel_pG2:
  s_mul_i32 s29, s20, 9
  v_mul_lo_u32 v32, v18, s29
  v_add_u32 v28, v28, v32
  v_mul_lo_u32 v32, v19, s29
  v_add_u32 v29, v29, v32
  v_lshl_add_u32 v26, v23, 3, v21
  v_lshlrev_b32 v26, 7, v26
  v_lshl_add_u32 v26, v24, 5, v26
  v_lshl_add_u32 v26, v22, 3, v26
  v_add_u32 v26, s24, v26
  v_mov_b32 v40, 0
  v_mov_b32 v41, 0
  v_and_b32 v27, 31, v1
  v_lshlrev_b32 v27, 3, v27
  s_add_u32 s29, s47, 73984
  v_add_u32 v27, s29, v27
  s_lshl_b32 s29, s20, 8
  v_add_u32 v32, s29, v27
  s_waitcnt vmcnt(0)
prep_kernel_ww1:
  ds_read_b64_tr_b16 v[48:49], v26 offset:0
  ds_read_b64_tr_b16 v[50:51], v26 offset:512
  ds_read_b64_tr_b16 v[56:57], v26 offset:2048
  ds_read_b64_tr_b16 v[58:59], v26 offset:2560
  ds_read_b64_tr_b16 v[64:65], v26 offset:4096
  ds_read_b64_tr_b16 v[66:67], v26 offset:4608
  ds_read_b64_tr_b16 v[72:73], v26 offset:6144
  ds_read_b64_tr_b16 v[74:75], v26 offset:6656
  ds_read_b64_tr_b16 v[80:81], v26 offset:8192
  ds_read_b64_tr_b16 v[82:83], v26 offset:8704
  ds_read_b64_tr_b16 v[88:89], v26 offset:10240
  ds_read_b64_tr_b16 v[90:91], v26 offset:10752
  ds_read_b64_tr_b16 v[96:97], v26 offset:12288
  ds_read_b64_tr_b16 v[98:99], v26 offset:12800
  ds_read_b64_tr_b16 v[104:105], v26 offset:14336
  s_waitcnt lgkmcnt(14)
  ds_read_b64_tr_b16 v[106:107], v26 offset:14848
  s_waitcnt lgkmcnt(14)
  ds_read_b64_tr_b16 v[112:113], v26 offset:16384
  s_waitcnt lgkmcnt(14)
  ds_read_b64_tr_b16 v[114:115], v26 offset:16896
  v_dot2c_f32_bf16 v40, s21, v48
  v_dot2c_f32_bf16 v40, s21, v49
  v_dot2c_f32_bf16 v40, s21, v50
  v_dot2c_f32_bf16 v40, s21, v51
  s_waitcnt lgkmcnt(14)
  v_dot2c_f32_bf16 v40, s21, v56
  v_dot2c_f32_bf16 v40, s21, v57
  v_dot2c_f32_bf16 v40, s21, v58
  v_dot2c_f32_bf16 v40, s21, v59
  s_waitcnt lgkmcnt(12)
  v_dot2c_f32_bf16 v40, s21, v64
  v_dot2c_f32_bf16 v40, s21, v65
  v_dot2c_f32_bf16 v40, s21, v66
  v_dot2c_f32_bf16 v40, s21, v67
  s_waitcnt lgkmcnt(10)
  v_dot2c_f32_bf16 v40, s21, v72
  v_dot2c_f32_bf16 v40, s21, v73
  v_dot2c_f32_bf16 v40, s21, v74
  v_dot2c_f32_bf16 v40, s21, v75
  s_waitcnt lgkmcnt(8)
  v_dot2c_f32_bf16 v40, s21, v80
  v_dot2c_f32_bf16 v40, s21, v81
  v_dot2c_f32_bf16 v40, s21, v82
  v_dot2c_f32_bf16 v40, s21, v83
  s_waitcnt lgkmcnt(6)
  v_dot2c_f32_bf16 v40, s21, v88
  v_dot2c_f32_bf16 v40, s21, v89
  v_dot2c_f32_bf16 v40, s21, v90
  v_dot2c_f32_bf16 v40, s21, v91
  s_waitcnt lgkmcnt(4)
  v_dot2c_f32_bf16 v40, s21, v96
  v_dot2c_f32_bf16 v40, s21, v97
  v_dot2c_f32_bf16 v40, s21, v98
  v_dot2c_f32_bf16 v40, s21, v99
  s_waitcnt lgkmcnt(2)
  v_dot2c_f32_bf16 v40, s21, v104
  v_dot2c_f32_bf16 v40, s21, v105
  v_dot2c_f32_bf16 v40, s21, v106
  v_dot2c_f32_bf16 v40, s21, v107
  s_waitcnt lgkmcnt(0)
  v_dot2c_f32_bf16 v40, s21, v112
  v_dot2c_f32_bf16 v40, s21, v113
  v_dot2c_f32_bf16 v40, s21, v114
  v_dot2c_f32_bf16 v40, s21, v115
  ds_read_b64_tr_b16 v[52:53], v26 offset:64
  ds_read_b64_tr_b16 v[54:55], v26 offset:576
  ds_read_b64_tr_b16 v[60:61], v26 offset:2112
  ds_read_b64_tr_b16 v[62:63], v26 offset:2624
  ds_read_b64_tr_b16 v[68:69], v26 offset:4160
  ds_read_b64_tr_b16 v[70:71], v26 offset:4672
  ds_read_b64_tr_b16 v[76:77], v26 offset:6208
  ds_read_b64_tr_b16 v[78:79], v26 offset:6720
  ds_read_b64_tr_b16 v[84:85], v26 offset:8256
  ds_read_b64_tr_b16 v[86:87], v26 offset:8768
  ds_read_b64_tr_b16 v[92:93], v26 offset:10304
  ds_read_b64_tr_b16 v[94:95], v26 offset:10816
  ds_read_b64_tr_b16 v[100:101], v26 offset:12352
  ds_read_b64_tr_b16 v[102:103], v26 offset:12864
  ds_read_b64_tr_b16 v[108:109], v26 offset:14400
  s_waitcnt lgkmcnt(14)
  ds_read_b64_tr_b16 v[110:111], v26 offset:14912
  s_waitcnt lgkmcnt(14)
  ds_read_b64_tr_b16 v[116:117], v26 offset:16448
  s_waitcnt lgkmcnt(14)
  ds_read_b64_tr_b16 v[118:119], v26 offset:16960
  v_dot2c_f32_bf16 v41, s21, v52
  v_dot2c_f32_bf16 v41, s21, v53
  v_dot2c_f32_bf16 v41, s21, v54
  v_dot2c_f32_bf16 v41, s21, v55
  s_waitcnt lgkmcnt(14)
  v_dot2c_f32_bf16 v41, s21, v60
  v_dot2c_f32_bf16 v41, s21, v61
  v_dot2c_f32_bf16 v41, s21, v62
  v_dot2c_f32_bf16 v41, s21, v63
  s_waitcnt lgkmcnt(12)
  v_dot2c_f32_bf16 v41, s21, v68
  v_dot2c_f32_bf16 v41, s21, v69
  v_dot2c_f32_bf16 v41, s21, v70
  v_dot2c_f32_bf16 v41, s21, v71
  s_waitcnt lgkmcnt(10)
  v_dot2c_f32_bf16 v41, s21, v76
  v_dot2c_f32_bf16 v41, s21, v77
  v_dot2c_f32_bf16 v41, s21, v78
  v_dot2c_f32_bf16 v41, s21, v79
  s_waitcnt lgkmcnt(8)
  v_dot2c_f32_bf16 v41, s21, v84
  v_dot2c_f32_bf16 v41, s21, v85
  v_dot2c_f32_bf16 v41, s21, v86
  v_dot2c_f32_bf16 v41, s21, v87
  s_waitcnt lgkmcnt(6)
  v_dot2c_f32_bf16 v41, s21, v92
  v_dot2c_f32_bf16 v41, s21, v93
  v_dot2c_f32_bf16 v41, s21, v94
  v_dot2c_f32_bf16 v41, s21, v95
  s_waitcnt lgkmcnt(4)
  v_dot2c_f32_bf16 v41, s21, v100
  v_dot2c_f32_bf16 v41, s21, v101
  v_dot2c_f32_bf16 v41, s21, v102
  v_dot2c_f32_bf16 v41, s21, v103
  s_waitcnt lgkmcnt(2)
  v_dot2c_f32_bf16 v41, s21, v108
  v_dot2c_f32_bf16 v41, s21, v109
  v_dot2c_f32_bf16 v41, s21, v110
  v_dot2c_f32_bf16 v41, s21, v111
  s_waitcnt lgkmcnt(0)
  v_dot2c_f32_bf16 v41, s21, v116
  v_dot2c_f32_bf16 v41, s21, v117
  v_dot2c_f32_bf16 v41, s21, v118
  v_dot2c_f32_bf16 v41, s21, v119
prep_kernel_h1:
  s_nop 2
  v_mov_b32 v42, v40
  v_mov_b32 v43, v41
  s_nop 1
  v_permlane32_swap_b32 v42, v40
  v_permlane32_swap_b32 v43, v41
  v_add_f32 v40, v40, v42
  v_add_f32 v41, v41, v43
  ds_write_b64 v32, v[40:41]
  s_waitcnt lgkmcnt(0)
  s_barrier
  ds_read_b64 v[32:33], v27 offset:0
  ds_read_b64 v[34:35], v27 offset:256
  ds_read_b64 v[36:37], v27 offset:512
  ds_read_b64 v[38:39], v27 offset:768
  s_mov_b32 s35, 0x00003f80
  s_mov_b32 s36, 0x3f800000
  s_mov_b32 s37, 0xbf80bf80
  s_waitcnt lgkmcnt(0)
  v_add_f32 v32, v32, v34
  v_add_f32 v36, v36, v38
  v_add_f32 v32, v32, v36
  v_mul_f32 v40, 0xbae38e39, v32
  v_add_f32 v33, v33, v35
  v_add_f32 v37, v37, v39
  v_add_f32 v33, v33, v37
  v_mul_f32 v41, 0xbae38e39, v33
  v_mov_b32 v44, v40
  v_mov_b32 v45, v40
  v_mov_b32 v46, v40
  v_mov_b32 v47, v40
  v_dot2_f32_bf16 v32, v48, s35, v44
  v_dot2_f32_bf16 v33, v48, s36, v44
  v_dot2_f32_bf16 v34, v49, s35, v45
  v_dot2_f32_bf16 v35, v49, s36, v45
  v_dot2_f32_bf16 v36, v50, s35, v46
  v_dot2_f32_bf16 v37, v50, s36, v46
  v_dot2_f32_bf16 v38, v51, s35, v47
  v_dot2_f32_bf16 v39, v51, s36, v47
  v_cvt_pk_bf16_f32 v48, v32, v33
  v_cvt_pk_bf16_f32 v49, v34, v35
  v_cvt_pk_bf16_f32 v50, v36, v37
  v_cvt_pk_bf16_f32 v51, v38, v39
  buffer_store_dwordx4 v[48:51], v28, s[12:15], s30 offen sc1
  v_add_u32 v28, v28, v18
  v_add_f32 v32, v32, v33
  v_add_f32 v34, v34, v35
  v_add_f32 v36, v36, v37
  v_add_f32 v38, v38, v39
  v_dot2c_f32_bf16 v32, s37, v48
  v_dot2c_f32_bf16 v34, s37, v49
  v_dot2c_f32_bf16 v36, s37, v50
  v_dot2c_f32_bf16 v38, s37, v51
  s_nop 0
  v_fma_f32 v44, v32, 0.5, v40
  s_nop 0
  v_fma_f32 v45, v34, 0.5, v40
  v_fma_f32 v46, v36, 0.5, v40
  v_fma_f32 v47, v38, 0.5, v40
  v_dot2_f32_bf16 v32, v56, s35, v44
  v_dot2_f32_bf16 v33, v56, s36, v44
  v_dot2_f32_bf16 v34, v57, s35, v45
  v_dot2_f32_bf16 v35, v57, s36, v45
  v_dot2_f32_bf16 v36, v58, s35, v46
  v_dot2_f32_bf16 v37, v58, s36, v46
  v_dot2_f32_bf16 v38, v59, s35, v47
  v_dot2_f32_bf16 v39, v59, s36, v47
  v_cvt_pk_bf16_f32 v56, v32, v33
  v_cvt_pk_bf16_f32 v57, v34, v35
  v_cvt_pk_bf16_f32 v58, v36, v37
  v_cvt_pk_bf16_f32 v59, v38, v39
  buffer_store_dwordx4 v[56:59], v28, s[12:15], s30 offen sc1
  v_add_u32 v28, v28, v18
  v_add_f32 v32, v32, v33
  v_add_f32 v34, v34, v35
  v_add_f32 v36, v36, v37
  v_add_f32 v38, v38, v39
  v_dot2c_f32_bf16 v32, s37, v56
  v_dot2c_f32_bf16 v34, s37, v57
  v_dot2c_f32_bf16 v36, s37, v58
  v_dot2c_f32_bf16 v38, s37, v59
  s_nop 0
  v_fma_f32 v44, v32, 0.5, v40
  s_nop 0
  v_fma_f32 v45, v34, 0.5, v40
  v_fma_f32 v46, v36, 0.5, v40
  v_fma_f32 v47, v38, 0.5, v40
  v_dot2_f32_bf16 v32, v64, s35, v44
  v_dot2_f32_bf16 v33, v64, s36, v44
  v_dot2_f32_bf16 v34, v65, s35, v45
  v_dot2_f32_bf16 v35, v65, s36, v45
  v_dot2_f32_bf16 v36, v66, s35, v46
  v_dot2_f32_bf16 v37, v66, s36, v46
  v_dot2_f32_bf16 v38, v67, s35, v47
  v_dot2_f32_bf16 v39, v67, s36, v47
  v_cvt_pk_bf16_f32 v64, v32, v33
  v_cvt_pk_bf16_f32 v65, v34, v35
  v_cvt_pk_bf16_f32 v66, v36, v37
  v_cvt_pk_bf16_f32 v67, v38, v39
  buffer_store_dwordx4 v[64:67], v28, s[12:15], s30 offen sc1
  v_add_u32 v28, v28, v18
  v_add_f32 v32, v32, v33
  v_add_f32 v34, v34, v35
  v_add_f32 v36, v36, v37
  v_add_f32 v38, v38, v39
  v_dot2c_f32_bf16 v32, s37, v64
  v_dot2c_f32_bf16 v34, s37, v65
  v_dot2c_f32_bf16 v36, s37, v66
  v_dot2c_f32_bf16 v38, s37, v67
  s_nop 0
  v_fma_f32 v44, v32, 0.5, v40
  s_nop 0
  v_fma_f32 v45, v34, 0.5, v40
  v_fma_f32 v46, v36, 0.5, v40
  v_fma_f32 v47, v38, 0.5, v40
  v_dot2_f32_bf16 v32, v72, s35, v44
  v_dot2_f32_bf16 v33, v72, s36, v44
  v_dot2_f32_bf16 v34, v73, s35, v45
  v_dot2_f32_bf16 v35, v73, s36, v45
  v_dot2_f32_bf16 v36, v74, s35, v46
  v_dot2_f32_bf16 v37, v74, s36, v46
  v_dot2_f32_bf16 v38, v75, s35, v47
  v_dot2_f32_bf16 v39, v75, s36, v47
  v_cvt_pk_bf16_f32 v72, v32, v33
  v_cvt_pk_bf16_f32 v73, v34, v35
  v_cvt_pk_bf16_f32 v74, v36, v37
  v_cvt_pk_bf16_f32 v75, v38, v39
  buffer_store_dwordx4 v[72:75], v28, s[12:15], s30 offen sc1
  v_add_u32 v28, v28, v18
  v_add_f32 v32, v32, v33
  v_add_f32 v34, v34, v35
  v_add_f32 v36, v36, v37
  v_add_f32 v38, v38, v39
  v_dot2c_f32_bf16 v32, s37, v72
  v_dot2c_f32_bf16 v34, s37, v73
  v_dot2c_f32_bf16 v36, s37, v74
  v_dot2c_f32_bf16 v38, s37, v75
  s_nop 0
  v_fma_f32 v44, v32, 0.5, v40
  s_nop 0
  v_fma_f32 v45, v34, 0.5, v40
  v_fma_f32 v46, v36, 0.5, v40
  v_fma_f32 v47, v38, 0.5, v40
  v_dot2_f32_bf16 v32, v80, s35, v44
  v_dot2_f32_bf16 v33, v80, s36, v44
  v_dot2_f32_bf16 v34, v81, s35, v45
  v_dot2_f32_bf16 v35, v81, s36, v45
  v_dot2_f32_bf16 v36, v82, s35, v46
  v_dot2_f32_bf16 v37, v82, s36, v46
  v_dot2_f32_bf16 v38, v83, s35, v47
  v_dot2_f32_bf16 v39, v83, s36, v47
  v_cvt_pk_bf16_f32 v80, v32, v33
  v_cvt_pk_bf16_f32 v81, v34, v35
  v_cvt_pk_bf16_f32 v82, v36, v37
  v_cvt_pk_bf16_f32 v83, v38, v39
  buffer_store_dwordx4 v[80:83], v28, s[12:15], s30 offen sc1
  v_add_u32 v28, v28, v18
  v_add_f32 v32, v32, v33
  v_add_f32 v34, v34, v35
  v_add_f32 v36, v36, v37
  v_add_f32 v38, v38, v39
  v_dot2c_f32_bf16 v32, s37, v80
  v_dot2c_f32_bf16 v34, s37, v81
  v_dot2c_f32_bf16 v36, s37, v82
  v_dot2c_f32_bf16 v38, s37, v83
  s_nop 0
  v_fma_f32 v44, v32, 0.5, v40
  s_nop 0
  v_fma_f32 v45, v34, 0.5, v40
  v_fma_f32 v46, v36, 0.5, v40
  v_fma_f32 v47, v38, 0.5, v40
  v_dot2_f32_bf16 v32, v88, s35, v44
  v_dot2_f32_bf16 v33, v88, s36, v44
  v_dot2_f32_bf16 v34, v89, s35, v45
  v_dot2_f32_bf16 v35, v89, s36, v45
  v_dot2_f32_bf16 v36, v90, s35, v46
  v_dot2_f32_bf16 v37, v90, s36, v46
  v_dot2_f32_bf16 v38, v91, s35, v47
  v_dot2_f32_bf16 v39, v91, s36, v47
  v_cvt_pk_bf16_f32 v88, v32, v33
  v_cvt_pk_bf16_f32 v89, v34, v35
  v_cvt_pk_bf16_f32 v90, v36, v37
  v_cvt_pk_bf16_f32 v91, v38, v39
  buffer_store_dwordx4 v[88:91], v28, s[12:15], s30 offen sc1
  v_add_u32 v28, v28, v18
  v_add_f32 v32, v32, v33
  v_add_f32 v34, v34, v35
  v_add_f32 v36, v36, v37
  v_add_f32 v38, v38, v39
  v_dot2c_f32_bf16 v32, s37, v88
  v_dot2c_f32_bf16 v34, s37, v89
  v_dot2c_f32_bf16 v36, s37, v90
  v_dot2c_f32_bf16 v38, s37, v91
  s_nop 0
  v_fma_f32 v44, v32, 0.5, v40
  s_nop 0
  v_fma_f32 v45, v34, 0.5, v40
  v_fma_f32 v46, v36, 0.5, v40
  v_fma_f32 v47, v38, 0.5, v40
  v_dot2_f32_bf16 v32, v96, s35, v44
  v_dot2_f32_bf16 v33, v96, s36, v44
  v_dot2_f32_bf16 v34, v97, s35, v45
  v_dot2_f32_bf16 v35, v97, s36, v45
  v_dot2_f32_bf16 v36, v98, s35, v46
  v_dot2_f32_bf16 v37, v98, s36, v46
  v_dot2_f32_bf16 v38, v99, s35, v47
  v_dot2_f32_bf16 v39, v99, s36, v47
  v_cvt_pk_bf16_f32 v96, v32, v33
  v_cvt_pk_bf16_f32 v97, v34, v35
  v_cvt_pk_bf16_f32 v98, v36, v37
  v_cvt_pk_bf16_f32 v99, v38, v39
  buffer_store_dwordx4 v[96:99], v28, s[12:15], s30 offen sc1
  v_add_u32 v28, v28, v18
  v_add_f32 v32, v32, v33
  v_add_f32 v34, v34, v35
  v_add_f32 v36, v36, v37
  v_add_f32 v38, v38, v39
  v_dot2c_f32_bf16 v32, s37, v96
  v_dot2c_f32_bf16 v34, s37, v97
  v_dot2c_f32_bf16 v36, s37, v98
  v_dot2c_f32_bf16 v38, s37, v99
  s_nop 0
  v_fma_f32 v44, v32, 0.5, v40
  s_nop 0
  v_fma_f32 v45, v34, 0.5, v40
  v_fma_f32 v46, v36, 0.5, v40
  v_fma_f32 v47, v38, 0.5, v40
  v_dot2_f32_bf16 v32, v104, s35, v44
  v_dot2_f32_bf16 v33, v104, s36, v44
  v_dot2_f32_bf16 v34, v105, s35, v45
  v_dot2_f32_bf16 v35, v105, s36, v45
  v_dot2_f32_bf16 v36, v106, s35, v46
  v_dot2_f32_bf16 v37, v106, s36, v46
  v_dot2_f32_bf16 v38, v107, s35, v47
  v_dot2_f32_bf16 v39, v107, s36, v47
  v_cvt_pk_bf16_f32 v104, v32, v33
  v_cvt_pk_bf16_f32 v105, v34, v35
  v_cvt_pk_bf16_f32 v106, v36, v37
  v_cvt_pk_bf16_f32 v107, v38, v39
  buffer_store_dwordx4 v[104:107], v28, s[12:15], s30 offen sc1
  v_add_u32 v28, v28, v18
  v_add_f32 v32, v32, v33
  v_add_f32 v34, v34, v35
  v_add_f32 v36, v36, v37
  v_add_f32 v38, v38, v39
  v_dot2c_f32_bf16 v32, s37, v104
  v_dot2c_f32_bf16 v34, s37, v105
  v_dot2c_f32_bf16 v36, s37, v106
  v_dot2c_f32_bf16 v38, s37, v107
  s_nop 0
  v_fma_f32 v44, v32, 0.5, v40
  s_nop 0
  v_fma_f32 v45, v34, 0.5, v40
  v_fma_f32 v46, v36, 0.5, v40
  v_fma_f32 v47, v38, 0.5, v40
  v_dot2_f32_bf16 v32, v112, s35, v44
  v_dot2_f32_bf16 v33, v112, s36, v44
  v_dot2_f32_bf16 v34, v113, s35, v45
  v_dot2_f32_bf16 v35, v113, s36, v45
  v_dot2_f32_bf16 v36, v114, s35, v46
  v_dot2_f32_bf16 v37, v114, s36, v46
  v_dot2_f32_bf16 v38, v115, s35, v47
  v_dot2_f32_bf16 v39, v115, s36, v47
  v_cvt_pk_bf16_f32 v112, v32, v33
  v_cvt_pk_bf16_f32 v113, v34, v35
  v_cvt_pk_bf16_f32 v114, v36, v37
  v_cvt_pk_bf16_f32 v115, v38, v39
  buffer_store_dwordx4 v[112:115], v28, s[12:15], s30 offen sc1
  v_add_u32 v28, v28, v18
  v_mov_b32 v44, v41
  v_mov_b32 v45, v41
  v_mov_b32 v46, v41
  v_mov_b32 v47, v41
  v_dot2_f32_bf16 v32, v52, s35, v44
  v_dot2_f32_bf16 v33, v52, s36, v44
  v_dot2_f32_bf16 v34, v53, s35, v45
  v_dot2_f32_bf16 v35, v53, s36, v45
  v_dot2_f32_bf16 v36, v54, s35, v46
  v_dot2_f32_bf16 v37, v54, s36, v46
  v_dot2_f32_bf16 v38, v55, s35, v47
  v_dot2_f32_bf16 v39, v55, s36, v47
  v_cvt_pk_bf16_f32 v52, v32, v33
  v_cvt_pk_bf16_f32 v53, v34, v35
  v_cvt_pk_bf16_f32 v54, v36, v37
  v_cvt_pk_bf16_f32 v55, v38, v39
  buffer_store_dwordx4 v[52:55], v29, s[12:15], s30 offen sc1
  v_add_u32 v29, v29, v19
  v_add_f32 v32, v32, v33
  v_add_f32 v34, v34, v35
  v_add_f32 v36, v36, v37
  v_add_f32 v38, v38, v39
  v_dot2c_f32_bf16 v32, s37, v52
  v_dot2c_f32_bf16 v34, s37, v53
  v_dot2c_f32_bf16 v36, s37, v54
  v_dot2c_f32_bf16 v38, s37, v55
  s_nop 0
  v_fma_f32 v44, v32, 0.5, v41
  s_nop 0
  v_fma_f32 v45, v34, 0.5, v41
  v_fma_f32 v46, v36, 0.5, v41
  v_fma_f32 v47, v38, 0.5, v41
  v_dot2_f32_bf16 v32, v60, s35, v44
  v_dot2_f32_bf16 v33, v60, s36, v44
  v_dot2_f32_bf16 v34, v61, s35, v45
  v_dot2_f32_bf16 v35, v61, s36, v45
  v_dot2_f32_bf16 v36, v62, s35, v46
  v_dot2_f32_bf16 v37, v62, s36, v46
  v_dot2_f32_bf16 v38, v63, s35, v47
  v_dot2_f32_bf16 v39, v63, s36, v47
  v_cvt_pk_bf16_f32 v60, v32, v33
  v_cvt_pk_bf16_f32 v61, v34, v35
  v_cvt_pk_bf16_f32 v62, v36, v37
  v_cvt_pk_bf16_f32 v63, v38, v39
  buffer_store_dwordx4 v[60:63], v29, s[12:15], s30 offen sc1
  v_add_u32 v29, v29, v19
  v_add_f32 v32, v32, v33
  v_add_f32 v34, v34, v35
  v_add_f32 v36, v36, v37
  v_add_f32 v38, v38, v39
  v_dot2c_f32_bf16 v32, s37, v60
  v_dot2c_f32_bf16 v34, s37, v61
  v_dot2c_f32_bf16 v36, s37, v62
  v_dot2c_f32_bf16 v38, s37, v63
  s_nop 0
  v_fma_f32 v44, v32, 0.5, v41
  s_nop 0
  v_fma_f32 v45, v34, 0.5, v41
  v_fma_f32 v46, v36, 0.5, v41
  v_fma_f32 v47, v38, 0.5, v41
  v_dot2_f32_bf16 v32, v68, s35, v44
  v_dot2_f32_bf16 v33, v68, s36, v44
  v_dot2_f32_bf16 v34, v69, s35, v45
  v_dot2_f32_bf16 v35, v69, s36, v45
  v_dot2_f32_bf16 v36, v70, s35, v46
  v_dot2_f32_bf16 v37, v70, s36, v46
  v_dot2_f32_bf16 v38, v71, s35, v47
  v_dot2_f32_bf16 v39, v71, s36, v47
  v_cvt_pk_bf16_f32 v68, v32, v33
  v_cvt_pk_bf16_f32 v69, v34, v35
  v_cvt_pk_bf16_f32 v70, v36, v37
  v_cvt_pk_bf16_f32 v71, v38, v39
  buffer_store_dwordx4 v[68:71], v29, s[12:15], s30 offen sc1
  v_add_u32 v29, v29, v19
  v_add_f32 v32, v32, v33
  v_add_f32 v34, v34, v35
  v_add_f32 v36, v36, v37
  v_add_f32 v38, v38, v39
  v_dot2c_f32_bf16 v32, s37, v68
  v_dot2c_f32_bf16 v34, s37, v69
  v_dot2c_f32_bf16 v36, s37, v70
  v_dot2c_f32_bf16 v38, s37, v71
  s_nop 0
  v_fma_f32 v44, v32, 0.5, v41
  s_nop 0
  v_fma_f32 v45, v34, 0.5, v41
  v_fma_f32 v46, v36, 0.5, v41
  v_fma_f32 v47, v38, 0.5, v41
  v_dot2_f32_bf16 v32, v76, s35, v44
  v_dot2_f32_bf16 v33, v76, s36, v44
  v_dot2_f32_bf16 v34, v77, s35, v45
  v_dot2_f32_bf16 v35, v77, s36, v45
  v_dot2_f32_bf16 v36, v78, s35, v46
  v_dot2_f32_bf16 v37, v78, s36, v46
  v_dot2_f32_bf16 v38, v79, s35, v47
  v_dot2_f32_bf16 v39, v79, s36, v47
  v_cvt_pk_bf16_f32 v76, v32, v33
  v_cvt_pk_bf16_f32 v77, v34, v35
  v_cvt_pk_bf16_f32 v78, v36, v37
  v_cvt_pk_bf16_f32 v79, v38, v39
  buffer_store_dwordx4 v[76:79], v29, s[12:15], s30 offen sc1
  v_add_u32 v29, v29, v19
  v_add_f32 v32, v32, v33
  v_add_f32 v34, v34, v35
  v_add_f32 v36, v36, v37
  v_add_f32 v38, v38, v39
  v_dot2c_f32_bf16 v32, s37, v76
  v_dot2c_f32_bf16 v34, s37, v77
  v_dot2c_f32_bf16 v36, s37, v78
  v_dot2c_f32_bf16 v38, s37, v79
  s_nop 0
  v_fma_f32 v44, v32, 0.5, v41
  s_nop 0
  v_fma_f32 v45, v34, 0.5, v41
  v_fma_f32 v46, v36, 0.5, v41
  v_fma_f32 v47, v38, 0.5, v41
  v_dot2_f32_bf16 v32, v84, s35, v44
  v_dot2_f32_bf16 v33, v84, s36, v44
  v_dot2_f32_bf16 v34, v85, s35, v45
  v_dot2_f32_bf16 v35, v85, s36, v45
  v_dot2_f32_bf16 v36, v86, s35, v46
  v_dot2_f32_bf16 v37, v86, s36, v46
  v_dot2_f32_bf16 v38, v87, s35, v47
  v_dot2_f32_bf16 v39, v87, s36, v47
  v_cvt_pk_bf16_f32 v84, v32, v33
  v_cvt_pk_bf16_f32 v85, v34, v35
  v_cvt_pk_bf16_f32 v86, v36, v37
  v_cvt_pk_bf16_f32 v87, v38, v39
  buffer_store_dwordx4 v[84:87], v29, s[12:15], s30 offen sc1
  v_add_u32 v29, v29, v19
  v_add_f32 v32, v32, v33
  v_add_f32 v34, v34, v35
  v_add_f32 v36, v36, v37
  v_add_f32 v38, v38, v39
  v_dot2c_f32_bf16 v32, s37, v84
  v_dot2c_f32_bf16 v34, s37, v85
  v_dot2c_f32_bf16 v36, s37, v86
  v_dot2c_f32_bf16 v38, s37, v87
  s_nop 0
  v_fma_f32 v44, v32, 0.5, v41
  s_nop 0
  v_fma_f32 v45, v34, 0.5, v41
  v_fma_f32 v46, v36, 0.5, v41
  v_fma_f32 v47, v38, 0.5, v41
  v_dot2_f32_bf16 v32, v92, s35, v44
  v_dot2_f32_bf16 v33, v92, s36, v44
  v_dot2_f32_bf16 v34, v93, s35, v45
  v_dot2_f32_bf16 v35, v93, s36, v45
  v_dot2_f32_bf16 v36, v94, s35, v46
  v_dot2_f32_bf16 v37, v94, s36, v46
  v_dot2_f32_bf16 v38, v95, s35, v47
  v_dot2_f32_bf16 v39, v95, s36, v47
  v_cvt_pk_bf16_f32 v92, v32, v33
  v_cvt_pk_bf16_f32 v93, v34, v35
  v_cvt_pk_bf16_f32 v94, v36, v37
  v_cvt_pk_bf16_f32 v95, v38, v39
  buffer_store_dwordx4 v[92:95], v29, s[12:15], s30 offen sc1
  v_add_u32 v29, v29, v19
  v_add_f32 v32, v32, v33
  v_add_f32 v34, v34, v35
  v_add_f32 v36, v36, v37
  v_add_f32 v38, v38, v39
  v_dot2c_f32_bf16 v32, s37, v92
  v_dot2c_f32_bf16 v34, s37, v93
  v_dot2c_f32_bf16 v36, s37, v94
  v_dot2c_f32_bf16 v38, s37, v95
  s_nop 0
  v_fma_f32 v44, v32, 0.5, v41
  s_nop 0
  v_fma_f32 v45, v34, 0.5, v41
  v_fma_f32 v46, v36, 0.5, v41
  v_fma_f32 v47, v38, 0.5, v41
  v_dot2_f32_bf16 v32, v100, s35, v44
  v_dot2_f32_bf16 v33, v100, s36, v44
  v_dot2_f32_bf16 v34, v101, s35, v45
  v_dot2_f32_bf16 v35, v101, s36, v45
  v_dot2_f32_bf16 v36, v102, s35, v46
  v_dot2_f32_bf16 v37, v102, s36, v46
  v_dot2_f32_bf16 v38, v103, s35, v47
  v_dot2_f32_bf16 v39, v103, s36, v47
  v_cvt_pk_bf16_f32 v100, v32, v33
  v_cvt_pk_bf16_f32 v101, v34, v35
  v_cvt_pk_bf16_f32 v102, v36, v37
  v_cvt_pk_bf16_f32 v103, v38, v39
  buffer_store_dwordx4 v[100:103], v29, s[12:15], s30 offen sc1
  v_add_u32 v29, v29, v19
  v_add_f32 v32, v32, v33
  v_add_f32 v34, v34, v35
  v_add_f32 v36, v36, v37
  v_add_f32 v38, v38, v39
  v_dot2c_f32_bf16 v32, s37, v100
  v_dot2c_f32_bf16 v34, s37, v101
  v_dot2c_f32_bf16 v36, s37, v102
  v_dot2c_f32_bf16 v38, s37, v103
  s_nop 0
  v_fma_f32 v44, v32, 0.5, v41
  s_nop 0
  v_fma_f32 v45, v34, 0.5, v41
  v_fma_f32 v46, v36, 0.5, v41
  v_fma_f32 v47, v38, 0.5, v41
  v_dot2_f32_bf16 v32, v108, s35, v44
  v_dot2_f32_bf16 v33, v108, s36, v44
  v_dot2_f32_bf16 v34, v109, s35, v45
  v_dot2_f32_bf16 v35, v109, s36, v45
  v_dot2_f32_bf16 v36, v110, s35, v46
  v_dot2_f32_bf16 v37, v110, s36, v46
  v_dot2_f32_bf16 v38, v111, s35, v47
  v_dot2_f32_bf16 v39, v111, s36, v47
  v_cvt_pk_bf16_f32 v108, v32, v33
  v_cvt_pk_bf16_f32 v109, v34, v35
  v_cvt_pk_bf16_f32 v110, v36, v37
  v_cvt_pk_bf16_f32 v111, v38, v39
  buffer_store_dwordx4 v[108:111], v29, s[12:15], s30 offen sc1
  v_add_u32 v29, v29, v19
  v_add_f32 v32, v32, v33
  v_add_f32 v34, v34, v35
  v_add_f32 v36, v36, v37
  v_add_f32 v38, v38, v39
  v_dot2c_f32_bf16 v32, s37, v108
  v_dot2c_f32_bf16 v34, s37, v109
  v_dot2c_f32_bf16 v36, s37, v110
  v_dot2c_f32_bf16 v38, s37, v111
  s_nop 0
  v_fma_f32 v44, v32, 0.5, v41
  s_nop 0
  v_fma_f32 v45, v34, 0.5, v41
  v_fma_f32 v46, v36, 0.5, v41
  v_fma_f32 v47, v38, 0.5, v41
  v_dot2_f32_bf16 v32, v116, s35, v44
  v_dot2_f32_bf16 v33, v116, s36, v44
  v_dot2_f32_bf16 v34, v117, s35, v45
  v_dot2_f32_bf16 v35, v117, s36, v45
  v_dot2_f32_bf16 v36, v118, s35, v46
  v_dot2_f32_bf16 v37, v118, s36, v46
  v_dot2_f32_bf16 v38, v119, s35, v47
  v_dot2_f32_bf16 v39, v119, s36, v47
  v_cvt_pk_bf16_f32 v116, v32, v33
  v_cvt_pk_bf16_f32 v117, v34, v35
  v_cvt_pk_bf16_f32 v118, v36, v37
  v_cvt_pk_bf16_f32 v119, v38, v39
  buffer_store_dwordx4 v[116:119], v29, s[12:15], s30 offen sc1
  v_add_u32 v29, v29, v19
  s_branch prep_kernel_end
prep_kernel_pWo:
  v_lshl_add_u32 v26, v23, 3, v21
  v_mul_u32_u24 v26, 1152, v26
  v_add_u32 v26, s24, v26
  v_and_b32 v27, 1, v22
  v_lshl_add_u32 v26, v27, 4, v26
  v_lshrrev_b32 v27, 1, v22
  v_lshl_add_u32 v26, v27, 3, v26
  v_lshl_add_u32 v28, v24, 5, v26
  s_lshl_b32 s29, s26, 2
  s_add_u32 s29, s29, s20
  s_mul_i32 s30, s29, 3072
  s_add_u32 s30, s30, 2097152
  s_waitcnt vmcnt(0)
prep_kernel_ww2:
  ds_read_b64_tr_b16 v[48:49], v28 offset:0
  ds_read_b64_tr_b16 v[50:51], v28 offset:4608
  ds_read_b64_tr_b16 v[52:53], v28 offset:64
  ds_read_b64_tr_b16 v[54:55], v28 offset:4672
  ds_read_b64_tr_b16 v[56:57], v28 offset:128
  ds_read_b64_tr_b16 v[58:59], v28 offset:4736
  ds_read_b64_tr_b16 v[60:61], v28 offset:192
  ds_read_b64_tr_b16 v[62:63], v28 offset:4800
  ds_read_b64_tr_b16 v[64:65], v28 offset:256
  ds_read_b64_tr_b16 v[66:67], v28 offset:4864
  ds_read_b64_tr_b16 v[68:69], v28 offset:320
  ds_read_b64_tr_b16 v[70:71], v28 offset:4928
  ds_read_b64_tr_b16 v[72:73], v28 offset:384
  ds_read_b64_tr_b16 v[74:75], v28 offset:4992
  ds_read_b64_tr_b16 v[76:77], v28 offset:448
  s_waitcnt lgkmcnt(14)
  ds_read_b64_tr_b16 v[78:79], v28 offset:5056
  s_waitcnt lgkmcnt(14)
  ds_read_b64_tr_b16 v[80:81], v28 offset:512
  s_waitcnt lgkmcnt(14)
  ds_read_b64_tr_b16 v[82:83], v28 offset:5120
  s_waitcnt lgkmcnt(14)
  ds_read_b64_tr_b16 v[84:85], v28 offset:576
  s_waitcnt lgkmcnt(14)
  ds_read_b64_tr_b16 v[86:87], v28 offset:5184
  s_waitcnt lgkmcnt(14)
  ds_read_b64_tr_b16 v[88:89], v28 offset:640
  s_waitcnt lgkmcnt(14)
  ds_read_b64_tr_b16 v[90:91], v28 offset:5248
  s_waitcnt lgkmcnt(14)
  ds_read_b64_tr_b16 v[92:93], v28 offset:704
  s_waitcnt lgkmcnt(14)
  ds_read_b64_tr_b16 v[94:95], v28 offset:5312
  s_waitcnt lgkmcnt(14)
  ds_read_b64_tr_b16 v[96:97], v28 offset:768
  s_waitcnt lgkmcnt(14)
  ds_read_b64_tr_b16 v[98:99], v28 offset:5376
  s_waitcnt lgkmcnt(14)
  ds_read_b64_tr_b16 v[100:101], v28 offset:832
  s_waitcnt lgkmcnt(14)
  ds_read_b64_tr_b16 v[102:103], v28 offset:5440
  s_waitcnt lgkmcnt(14)
  ds_read_b64_tr_b16 v[104:105], v28 offset:896
  s_waitcnt lgkmcnt(14)
  ds_read_b64_tr_b16 v[106:107], v28 offset:5504
  s_waitcnt lgkmcnt(14)
  ds_read_b64_tr_b16 v[108:109], v28 offset:960
  s_waitcnt lgkmcnt(14)
  ds_read_b64_tr_b16 v[110:111], v28 offset:5568
  s_waitcnt lgkmcnt(14)
  ds_read_b64_tr_b16 v[112:113], v28 offset:1024
  s_waitcnt lgkmcnt(14)
  ds_read_b64_tr_b16 v[114:115], v28 offset:5632
  s_waitcnt lgkmcnt(14)
  ds_read_b64_tr_b16 v[116:117], v28 offset:1088
  s_waitcnt lgkmcnt(14)
  ds_read_b64_tr_b16 v[118:119], v28 offset:5696
  s_add_u32 s33, s30, 0
  buffer_store_dwordx4 v[48:51], v31, s[12:15], s33 offen sc1
  s_add_u32 s33, s30, 1024
  buffer_store_dwordx4 v[52:55], v31, s[12:15], s33 offen sc1
  s_add_u32 s33, s30, 2048
  buffer_store_dwordx4 v[56:59], v31, s[12:15], s33 offen sc1
  s_add_u32 s33, s30, 110592
  buffer_store_dwordx4 v[60:63], v31, s[12:15], s33 offen sc1
  s_add_u32 s33, s30, 111616
  buffer_store_dwordx4 v[64:67], v31, s[12:15], s33 offen sc1
  s_add_u32 s33, s30, 112640
  buffer_store_dwordx4 v[68:71], v31, s[12:15], s33 offen sc1
  s_add_u32 s33, s30, 221184
  buffer_store_dwordx4 v[72:75], v31, s[12:15], s33 offen sc1
  s_add_u32 s33, s30, 222208
  buffer_store_dwordx4 v[76:79], v31, s[12:15], s33 offen sc1
  s_add_u32 s33, s30, 223232
  buffer_store_dwordx4 v[80:83], v31, s[12:15], s33 offen sc1
  s_add_u32 s33, s30, 331776
  buffer_store_dwordx4 v[84:87], v31, s[12:15], s33 offen sc1
  s_add_u32 s33, s30, 332800
  s_waitcnt lgkmcnt(14)
  buffer_store_dwordx4 v[88:91], v31, s[12:15], s33 offen sc1
  s_add_u32 s33, s30, 333824
  s_waitcnt lgkmcnt(12)
  buffer_store_dwordx4 v[92:95], v31, s[12:15], s33 offen sc1
  s_add_u32 s33, s30, 442368
  s_waitcnt lgkmcnt(10)
  buffer_store_dwordx4 v[96:99], v31, s[12:15], s33 offen sc1
  s_add_u32 s33, s30, 443392
  s_waitcnt lgkmcnt(8)
  buffer_store_dwordx4 v[100:103], v31, s[12:15], s33 offen sc1
  s_add_u32 s33, s30, 444416
  s_waitcnt lgkmcnt(6)
  buffer_store_dwordx4 v[104:107], v31, s[12:15], s33 offen sc1
  s_add_u32 s33, s30, 552960
  s_waitcnt lgkmcnt(4)
  buffer_store_dwordx4 v[108:111], v31, s[12:15], s33 offen sc1
  s_add_u32 s33, s30, 553984
  s_waitcnt lgkmcnt(2)
  buffer_store_dwordx4 v[112:115], v31, s[12:15], s33 offen sc1
  s_add_u32 s33, s30, 555008
  s_waitcnt lgkmcnt(0)
  buffer_store_dwordx4 v[116:119], v31, s[12:15], s33 offen sc1
  s_branch prep_kernel_end
prep_kernel_pD:
  v_lshl_add_u32 v26, v20, 3, v21
  v_mul_u32_u24 v26, 576, v26
  v_add_u32 v26, s24, v26
  v_lshl_add_u32 v28, v22, 4, v26
  v_lshl_add_u32 v29, v22, 3, v26
  s_lshr_b32 s29, s20, 1
  s_and_b32 s34, s20, 1
  s_lshl_b32 s33, s26, 1
  s_add_u32 s29, s29, s33
  s_mul_i32 s33, s29, 1821
  s_lshr_b32 s33, s33, 16
  s_mul_i32 s35, s33, 36
  s_sub_u32 s29, s29, s35
  s_lshl_b32 s34, s34, 3
  s_add_u32 s34, s33, s34
  s_mul_i32 s34, s34, 331776
  s_add_u32 s34, s34, 14680064
  s_mul_i32 s60, s29, 7282
  s_lshr_b32 s60, s60, 16
  s_mul_i32 s61, s60, 9
  s_sub_u32 s61, s29, s61
  s_mul_i32 s30, s61, 3
  s_lshr_b32 s30, 55719588, s30
  s_and_b32 s30, s30, 7
  s_mul_i32 s30, s30, s60
  s_mov_b32 s62, 3315351584
  s_mov_b32 s63, 6792
  s_mul_i32 s61, s61, 5
  s_lshr_b64 s[62:63], s[62:63], s61
  s_and_b32 s62, s62, 31
  s_add_u32 s30, s30, s62
  s_mul_i32 s60, s30, 7
  s_mul_i32 s61, s30, 5
  s_add_u32 s61, s61, 0
  s_add_u32 s62, s60, 5
  s_lshl_b32 s63, s30, 1
  s_add_u32 s63, s63, 180
  s_cmp_lt_u32 s30, 0
  s_cselect_b32 s30, s60, s61
  s_cselect_b32 s62, s62, s63
  s_lshl_b32 s30, s30, 10
  s_add_u32 s30, s30, s34
  s_lshl_b32 s62, s62, 10
  s_add_u32 s62, s62, s34
  s_lshl_b32 s35, s29, 11
  s_add_u32 s35, s35, s34
  s_add_u32 s35, s35, 258048
  s_sub_u32 s56, 3, s33
  s_and_b32 s56, s56, 3
  s_lshl_b32 s61, s56, 11
  s_add_u32 s61, s61, s30
  s_cmp_eq_u32 s56, 2
  s_cselect_b32 s61, s62, s61
  s_cmp_eq_u32 s56, 3
  s_cselect_b32 s56, s35, s61
  s_sub_u32 s57, 4, s33
  s_and_b32 s57, s57, 3
  s_lshl_b32 s61, s57, 11
  s_add_u32 s61, s61, s30
  s_cmp_eq_u32 s57, 2
  s_cselect_b32 s61, s62, s61
  s_cmp_eq_u32 s57, 3
  s_cselect_b32 s57, s35, s61
  s_sub_u32 s58, 5, s33
  s_and_b32 s58, s58, 3
  s_lshl_b32 s61, s58, 11
  s_add_u32 s61, s61, s30
  s_cmp_eq_u32 s58, 2
  s_cselect_b32 s61, s62, s61
  s_cmp_eq_u32 s58, 3
  s_cselect_b32 s58, s35, s61
  s_sub_u32 s59, 6, s33
  s_and_b32 s59, s59, 3
  s_lshl_b32 s61, s59, 11
  s_add_u32 s61, s61, s30
  s_cmp_eq_u32 s59, 2
  s_cselect_b32 s61, s62, s61
  s_cmp_eq_u32 s59, 3
  s_cselect_b32 s59, s35, s61
  s_waitcnt vmcnt(0)
prep_kernel_ww3:
  ds_read_b64_tr_b16 v[48:49], v28 offset:0
  ds_read_b64_tr_b16 v[50:51], v28 offset:2304
  ds_read_b64_tr_b16 v[52:53], v28 offset:8
  ds_read_b64_tr_b16 v[54:55], v28 offset:2312
  ds_read_b64_tr_b16 v[56:57], v28 offset:64
  ds_read_b64_tr_b16 v[58:59], v28 offset:2368
  ds_read_b64_tr_b16 v[60:61], v28 offset:72
  ds_read_b64_tr_b16 v[62:63], v28 offset:2376
  ds_read_b64_tr_b16 v[64:65], v28 offset:128
  ds_read_b64_tr_b16 v[66:67], v28 offset:2432
  ds_read_b64_tr_b16 v[68:69], v28 offset:136
  ds_read_b64_tr_b16 v[70:71], v28 offset:2440
  ds_read_b64_tr_b16 v[72:73], v28 offset:192
  ds_read_b64_tr_b16 v[74:75], v28 offset:2496
  ds_read_b64_tr_b16 v[76:77], v28 offset:200
  s_waitcnt lgkmcnt(14)
  ds_read_b64_tr_b16 v[78:79], v28 offset:2504
  s_waitcnt lgkmcnt(14)
  ds_read_b64_tr_b16 v[80:81], v29 offset:256
  s_waitcnt lgkmcnt(14)
  ds_read_b64_tr_b16 v[82:83], v29 offset:2560
  s_waitcnt lgkmcnt(14)
  ds_read_b64_tr_b16 v[84:85], v28 offset:288
  s_waitcnt lgkmcnt(14)
  ds_read_b64_tr_b16 v[86:87], v28 offset:2592
  s_waitcnt lgkmcnt(14)
  ds_read_b64_tr_b16 v[88:89], v28 offset:296
  s_waitcnt lgkmcnt(14)
  ds_read_b64_tr_b16 v[90:91], v28 offset:2600
  s_waitcnt lgkmcnt(14)
  ds_read_b64_tr_b16 v[92:93], v28 offset:352
  s_waitcnt lgkmcnt(14)
  ds_read_b64_tr_b16 v[94:95], v28 offset:2656
  s_waitcnt lgkmcnt(14)
  ds_read_b64_tr_b16 v[96:97], v28 offset:360
  s_waitcnt lgkmcnt(14)
  ds_read_b64_tr_b16 v[98:99], v28 offset:2664
  s_waitcnt lgkmcnt(14)
  ds_read_b64_tr_b16 v[100:101], v28 offset:416
  s_waitcnt lgkmcnt(14)
  ds_read_b64_tr_b16 v[102:103], v28 offset:2720
  s_waitcnt lgkmcnt(14)
  ds_read_b64_tr_b16 v[104:105], v28 offset:424
  s_waitcnt lgkmcnt(14)
  ds_read_b64_tr_b16 v[106:107], v28 offset:2728
  s_waitcnt lgkmcnt(14)
  ds_read_b64_tr_b16 v[108:109], v28 offset:480
  s_waitcnt lgkmcnt(14)
  ds_read_b64_tr_b16 v[110:111], v28 offset:2784
  s_waitcnt lgkmcnt(14)
  ds_read_b64_tr_b16 v[112:113], v28 offset:488
  s_waitcnt lgkmcnt(14)
  ds_read_b64_tr_b16 v[114:115], v28 offset:2792
  s_waitcnt lgkmcnt(14)
  ds_read_b64_tr_b16 v[116:117], v29 offset:544
  s_waitcnt lgkmcnt(14)
  ds_read_b64_tr_b16 v[118:119], v29 offset:2848
  s_add_u32 s33, s56, 0
  buffer_store_dwordx4 v[48:51], v31, s[12:15], s33 offen sc1
  s_add_u32 s33, s56, 1024
  buffer_store_dwordx4 v[52:55], v31, s[12:15], s33 offen sc1
  s_add_u32 s33, s57, 0
  buffer_store_dwordx4 v[56:59], v31, s[12:15], s33 offen sc1
  s_add_u32 s33, s57, 1024
  buffer_store_dwordx4 v[60:63], v31, s[12:15], s33 offen sc1
  s_add_u32 s33, s58, 0
  buffer_store_dwordx4 v[64:67], v31, s[12:15], s33 offen sc1
  s_add_u32 s33, s58, 1024
  buffer_store_dwordx4 v[68:71], v31, s[12:15], s33 offen sc1
  s_add_u32 s33, s59, 0
  buffer_store_dwordx4 v[72:75], v31, s[12:15], s33 offen sc1
  s_add_u32 s33, s59, 1024
  buffer_store_dwordx4 v[76:79], v31, s[12:15], s33 offen sc1
  s_add_u32 s33, s30, 4096
  buffer_store_dwordx4 v[80:83], v31, s[12:15], s33 offen sc1
  s_add_u32 s33, s56, 1327104
  buffer_store_dwordx4 v[84:87], v31, s[12:15], s33 offen sc1
  s_add_u32 s33, s56, 1328128
  s_waitcnt lgkmcnt(14)
  buffer_store_dwordx4 v[88:91], v31, s[12:15], s33 offen sc1
  s_add_u32 s33, s57, 1327104
  s_waitcnt lgkmcnt(12)
  buffer_store_dwordx4 v[92:95], v31, s[12:15], s33 offen sc1
  s_add_u32 s33, s57, 1328128
  s_waitcnt lgkmcnt(10)
  buffer_store_dwordx4 v[96:99], v31, s[12:15], s33 offen sc1
  s_add_u32 s33, s58, 1327104
  s_waitcnt lgkmcnt(8)
  buffer_store_dwordx4 v[100:103], v31, s[12:15], s33 offen sc1
  s_add_u32 s33, s58, 1328128
  s_waitcnt lgkmcnt(6)
  buffer_store_dwordx4 v[104:107], v31, s[12:15], s33 offen sc1
  s_add_u32 s33, s59, 1327104
  s_waitcnt lgkmcnt(4)
  buffer_store_dwordx4 v[108:111], v31, s[12:15], s33 offen sc1
  s_add_u32 s33, s59, 1328128
  s_waitcnt lgkmcnt(2)
  buffer_store_dwordx4 v[112:115], v31, s[12:15], s33 offen sc1
  s_add_u32 s33, s30, 1331200
  s_waitcnt lgkmcnt(0)
  buffer_store_dwordx4 v[116:119], v31, s[12:15], s33 offen sc1
prep_kernel_end:
  s_cmp_lg_u32 s45, 0
  s_cbranch_scc1 prep_kernel_x
  s_min_u32 s33, s44, 255
  s_lshl_b32 s33, s33, 6
  s_add_u32 s33, s33, 83951616
  v_mov_b32 v12, 1
  v_min_u32 v13, 1, v0
  v_lshlrev_b32 v13, 31, v13
  s_waitcnt vmcnt(0)
  s_barrier
  buffer_store_dword v12, v13, s[12:15], s33 offen sc1
  s_branch main_ret
prep_kernel_x:
  v_lshlrev_b32 v6, 9, v4
  v_lshl_add_u32 v6, v3, 4, v6
  s_lshr_b32 s29, s2, 2
  s_mul_i32 s29, s29, 36864
  s_mul_i32 s33, s20, 12288
  s_add_u32 s29, s29, s33
  s_and_b32 s33, s2, 3
  s_lshl_b32 s33, s33, 7
  s_add_u32 s29, s29, s33
  s_cmp_eq_u32 s20, 3
  s_cbranch_scc1 prep_kernel_zf
  s_add_u32 s33, s29, 20971520
  buffer_store_dwordx4 v[120:123], v6, s[12:15], s33 offen sc1
  s_add_u32 s33, s33, 4096
  buffer_store_dwordx4 v[124:127], v6, s[12:15], s33 offen sc1
  s_add_u32 s33, s33, 4096
  buffer_store_dwordx4 v[128:131], v6, s[12:15], s33 offen sc1
  v_mov_b32 v28, 0
  v_mov_b32 v29, 0
  v_dot2c_f32_bf16 v28, s21, v120
  v_dot2c_f32_bf16 v29, v120, v120
  v_dot2c_f32_bf16 v28, s21, v121
  v_dot2c_f32_bf16 v29, v121, v121
  v_dot2c_f32_bf16 v28, s21, v122
  v_dot2c_f32_bf16 v29, v122, v122
  v_dot2c_f32_bf16 v28, s21, v123
  v_dot2c_f32_bf16 v29, v123, v123
  v_dot2c_f32_bf16 v28, s21, v124
  v_dot2c_f32_bf16 v29, v124, v124
  v_dot2c_f32_bf16 v28, s21, v125
  v_dot2c_f32_bf16 v29, v125, v125
  v_dot2c_f32_bf16 v28, s21, v126
  v_dot2c_f32_bf16 v29, v126, v126
  v_dot2c_f32_bf16 v28, s21, v127
  v_dot2c_f32_bf16 v29, v127, v127
  v_dot2c_f32_bf16 v28, s21, v128
  v_dot2c_f32_bf16 v29, v128, v128
  v_dot2c_f32_bf16 v28, s21, v129
  v_dot2c_f32_bf16 v29, v129, v129
  v_dot2c_f32_bf16 v28, s21, v130
  v_dot2c_f32_bf16 v29, v130, v130
  v_dot2c_f32_bf16 v28, s21, v131
  v_dot2c_f32_bf16 v29, v131, v131
  v_min_u32 v7, 1, v4
  v_lshlrev_b32 v7, 31, v7
  v_lshl_or_b32 v7, v3, 3, v7
  s_nop 1
  v_add_f32_dpp v28, v28, v28 row_ror:8 row_mask:0xf bank_mask:0xf
  v_mov_b32 v31, v28
  s_nop 1
  v_permlane16_swap_b32 v31, v28
  v_add_f32 v28, v28, v31
  v_mov_b32 v31, v28
  s_nop 1
  v_permlane32_swap_b32 v31, v28
  v_add_f32 v28, v28, v31
  s_nop 1
  v_add_f32_dpp v29, v29, v29 row_ror:8 row_mask:0xf bank_mask:0xf
  v_mov_b32 v31, v29
  s_nop 1
  v_permlane16_swap_b32 v31, v29
  v_add_f32 v29, v29, v31
  v_mov_b32 v31, v29
  s_nop 1
  v_permlane32_swap_b32 v31, v29
  v_add_f32 v29, v29, v31
  s_lshl_b32 s33, s20, 14
  s_lshl_b32 s34, s2, 6
  s_add_u32 s33, s33, s34
  s_add_u32 s33, s33, 48758784
  buffer_store_dwordx2 v[28:29], v7, s[12:15], s33 offen sc1
  s_branch prep_kernel_fin2
prep_kernel_zf:
  v_mov_b32 v8, 0
  v_mov_b32 v9, 0
  s_cmp_ge_u32 s2, 128
  s_cselect_b32 s33, 66961408, 0
  s_mul_i32 s34, s2, 1152
  s_add_u32 s33, s33, s34
  s_add_u32 s33, s33, 83886080
  s_mul_i32 s34, s2, 18
  v_min_u32 v10, 17, v1
  v_lshlrev_b32 v7, 6, v10
  v_add_u32 v10, s34, v10
  v_subrev_u32 v10, 1024, v10
  v_cmp_gt_u32 vcc, 144, v10
  s_nop 1
  v_cndmask_b32 v12, 0, 1, vcc
  buffer_store_dword v12, v7, s[12:15], s33 offen sc1
  v_lshlrev_b32 v7, 14, v4
  v_lshl_or_b32 v7, v3, 3, v7
  s_lshl_b32 s33, s2, 6
  s_add_u32 s33, s33, 48807936
  s_add_u32 s34, s33, 81920
  buffer_store_dwordx2 v[8:9], v7, s[12:15], s33 offen sc1
  buffer_store_dwordx2 v[8:9], v7, s[12:15], s34 offen sc1
  s_branch prep_kernel_fin2
prep_kernel_fin2:
  s_endpgm
prep_kernel_fin:
.globl main_kernel
.p2align 8
.type main_kernel,@function
main_kernel:
  s_cmp_ge_u32 s2, 256
  s_cbranch_scc1 main_kernel_end
  s_load_dwordx2 s[4:5], s[0:1], 72
  v_and_b32 v1, 63, v0
  v_lshrrev_b32 v2, 6, v0
  v_lshlrev_b32 v3, 4, v1
  v_readfirstlane_b32 s20, v2
  s_mov_b32 s49, 0
  s_mov_b32 s6, 268435456
  s_mov_b32 s7, 0x20000
  s_mov_b32 s10, 268435456
  s_mov_b32 s11, 0x20000
  s_waitcnt lgkmcnt(0)
  s_mov_b32 s8, s4
  s_mov_b32 s9, s5
  s_cmp_ge_u32 s2, 224
  s_cbranch_scc1 main_s1
main_p1:
  s_bfe_u32 s18, s2, 0x20001
  s_lshl_b32 s18, s18, 2
  s_bfe_u32 s19, s2, 0x20003
  s_add_u32 s18, s18, s19
  s_and_b32 s56, s2, 1
  s_mul_i32 s56, s56, 7
  s_lshr_b32 s57, s2, 5
  s_add_u32 s56, s56, s57
  s_mul_i32 s56, s56, 147456
  s_add_u32 s56, s56, 0
  s_mul_i32 s57, s20, 3072
  s_cmp_eq_u32 s20, 0
  s_cbranch_scc1 p1_xw
  s_sub_u32 s58, s20, 1
  s_lshl_b32 s17, s58, 12
  s_add_u32 m0, s17, 0
  s_add_u32 s58, m0, s56
  buffer_load_dwordx4 v3, s[4:7], s58 offen offset:0 lds
  buffer_load_dwordx4 v3, s[4:7], s58 offen offset:1024 lds
  buffer_load_dwordx4 v3, s[4:7], s58 offen offset:2048 lds
  buffer_load_dwordx4 v3, s[4:7], s58 offen offset:3072 lds
  s_add_u32 m0, s17, 12288
  s_add_u32 s58, m0, s56
  buffer_load_dwordx4 v3, s[4:7], s58 offen offset:0 lds
  buffer_load_dwordx4 v3, s[4:7], s58 offen offset:1024 lds
  buffer_load_dwordx4 v3, s[4:7], s58 offen offset:2048 lds
  buffer_load_dwordx4 v3, s[4:7], s58 offen offset:3072 lds
  s_add_u32 m0, s17, 24576
  s_add_u32 s58, m0, s56
  buffer_load_dwordx4 v3, s[4:7], s58 offen offset:0 lds
  buffer_load_dwordx4 v3, s[4:7], s58 offen offset:1024 lds
  buffer_load_dwordx4 v3, s[4:7], s58 offen offset:2048 lds
  buffer_load_dwordx4 v3, s[4:7], s58 offen offset:3072 lds
  s_add_u32 m0, s17, 36864
  s_add_u32 s58, m0, s56
  buffer_load_dwordx4 v3, s[4:7], s58 offen offset:0 lds
  buffer_load_dwordx4 v3, s[4:7], s58 offen offset:1024 lds
  buffer_load_dwordx4 v3, s[4:7], s58 offen offset:2048 lds
  buffer_load_dwordx4 v3, s[4:7], s58 offen offset:3072 lds
  s_add_u32 m0, s17, 49152
  s_add_u32 s58, m0, s56
  buffer_load_dwordx4 v3, s[4:7], s58 offen offset:0 lds
  buffer_load_dwordx4 v3, s[4:7], s58 offen offset:1024 lds
  buffer_load_dwordx4 v3, s[4:7], s58 offen offset:2048 lds
  buffer_load_dwordx4 v3, s[4:7], s58 offen offset:3072 lds
  s_add_u32 m0, s17, 61440
  s_add_u32 s58, m0, s56
  buffer_load_dwordx4 v3, s[4:7], s58 offen offset:0 lds
  buffer_load_dwordx4 v3, s[4:7], s58 offen offset:1024 lds
  buffer_load_dwordx4 v3, s[4:7], s58 offen offset:2048 lds
  buffer_load_dwordx4 v3, s[4:7], s58 offen offset:3072 lds
  s_add_u32 m0, s17, 73728
  s_add_u32 s58, m0, s56
  buffer_load_dwordx4 v3, s[4:7], s58 offen offset:0 lds
  buffer_load_dwordx4 v3, s[4:7], s58 offen offset:1024 lds
  buffer_load_dwordx4 v3, s[4:7], s58 offen offset:2048 lds
  buffer_load_dwordx4 v3, s[4:7], s58 offen offset:3072 lds
  s_add_u32 m0, s17, 86016
  s_add_u32 s58, m0, s56
  buffer_load_dwordx4 v3, s[4:7], s58 offen offset:0 lds
  buffer_load_dwordx4 v3, s[4:7], s58 offen offset:1024 lds
  buffer_load_dwordx4 v3, s[4:7], s58 offen offset:2048 lds
  buffer_load_dwordx4 v3, s[4:7], s58 offen offset:3072 lds
  s_add_u32 m0, s17, 98304
  s_add_u32 s58, m0, s56
  buffer_load_dwordx4 v3, s[4:7], s58 offen offset:0 lds
  buffer_load_dwordx4 v3, s[4:7], s58 offen offset:1024 lds
  buffer_load_dwordx4 v3, s[4:7], s58 offen offset:2048 lds
  buffer_load_dwordx4 v3, s[4:7], s58 offen offset:3072 lds
  s_branch p1_xg
p1_xw:
  s_cmp_eq_u32 s49, 0
  s_cbranch_scc1 p1_xg
  s_lshl_b32 s29, s18, 10
  s_add_u32 s29, s29, 83935232
  v_and_b32 v6, 15, v1
  v_lshlrev_b32 v6, 6, v6
  s_mov_b32 s53, 0
p1_xp:
  s_sleep 2
  buffer_load_dword v16, v6, s[8:11], s29 offen sc1
  s_add_u32 s53, s53, 1
  s_waitcnt vmcnt(0)
  v_cmp_gt_u32 vcc, 1, v16
  s_cmp_gt_u32 s53, 0x8000
  s_cbranch_scc1 p1_xg
  s_cbranch_vccnz p1_xp
p1_xg:
  s_lshl_b32 s18, s18, 2
  s_add_u32 s18, s18, s20
  s_and_b32 s19, s2, 1
  s_mul_i32 s19, s19, 7
  s_lshr_b32 s17, s2, 5
  s_add_u32 s19, s19, s17
  s_mul_i32 s21, s18, 36864
  s_add_u32 s21, s21, 20971520
  v_add_u32 v4, 0x10000, v3
  v_add_u32 v5, 0x20000, v3
  s_lshl_b32 s30, s18, 8
  s_add_u32 s30, s30, 48758784
  s_lshr_b32 s48, s18, 2
  s_lshl_b32 s48, s48, 4
  s_add_u32 s48, s48, s19
  s_lshl_b32 s48, s48, 6
  s_add_u32 s48, s48, 83886080
  s_barrier
  v_and_b32 v6, 31, v1
  v_lshrrev_b32 v7, 5, v1
  v_lshlrev_b32 v8, 17, v7
  v_lshl_or_b32 v8, v6, 3, v8
  buffer_load_dwordx4 a[0:3], v3, s[8:11], s21 offen offset:0 sc1
  buffer_load_dwordx4 a[4:7], v3, s[8:11], s21 offen offset:1024 sc1
  buffer_load_dwordx4 a[8:11], v3, s[8:11], s21 offen offset:2048 sc1
  buffer_load_dwordx4 a[12:15], v3, s[8:11], s21 offen offset:3072 sc1
  s_add_u32 s21, s21, 4096
  buffer_load_dwordx4 a[16:19], v3, s[8:11], s21 offen offset:0 sc1
  buffer_load_dwordx4 a[20:23], v3, s[8:11], s21 offen offset:1024 sc1
  buffer_load_dwordx4 a[24:27], v3, s[8:11], s21 offen offset:2048 sc1
  buffer_load_dwordx4 a[28:31], v3, s[8:11], s21 offen offset:3072 sc1
  s_add_u32 s21, s21, 4096
  s_cmp_ge_u32 s19, 9
  s_cbranch_scc1 p1_v
  s_waitcnt vmcnt(32)
  s_barrier
  ds_read_b128 v[80:83], v3 offset:0
  ds_read_b128 v[84:87], v3 offset:1024
  ds_read_b128 v[88:91], v3 offset:2048
  ds_read_b128 v[92:95], v3 offset:3072
  s_waitcnt vmcnt(7) lgkmcnt(3)
  v_mfma_f32_32x32x16_bf16 v[16:31], v[80:83], a[0:3], 0
  ds_read_b128 v[96:99], v3 offset:4096
  buffer_load_dwordx4 a[32:35], v3, s[8:11], s21 offen offset:0 sc1
  s_waitcnt lgkmcnt(3)
  v_mfma_f32_32x32x16_bf16 v[32:47], v[84:87], a[0:3], 0
  ds_read_b128 v[100:103], v3 offset:5120
  buffer_load_dwordx4 a[36:39], v3, s[8:11], s21 offen offset:1024 sc1
  s_waitcnt vmcnt(8) lgkmcnt(3)
  v_mfma_f32_32x32x16_bf16 v[16:31], v[88:91], a[4:7], v[16:31]
  ds_read_b128 v[80:83], v3 offset:6144
  buffer_load_dwordx4 a[40:43], v3, s[8:11], s21 offen offset:2048 sc1
  s_waitcnt lgkmcnt(3)
  v_mfma_f32_32x32x16_bf16 v[32:47], v[92:95], a[4:7], v[32:47]
  ds_read_b128 v[84:87], v3 offset:7168
  buffer_load_dwordx4 a[44:47], v3, s[8:11], s21 offen offset:3072 sc1
  s_add_u32 s21, s21, 4096
  s_waitcnt vmcnt(9) lgkmcnt(3)
  v_mfma_f32_32x32x16_bf16 v[16:31], v[96:99], a[8:11], v[16:31]
  ds_read_b128 v[88:91], v3 offset:8192
  buffer_load_dwordx4 a[48:51], v3, s[8:11], s21 offen offset:0 sc1
  s_waitcnt lgkmcnt(3)
  v_mfma_f32_32x32x16_bf16 v[32:47], v[100:103], a[8:11], v[32:47]
  ds_read_b128 v[92:95], v3 offset:9216
  buffer_load_dwordx4 a[52:55], v3, s[8:11], s21 offen offset:1024 sc1
  s_waitcnt vmcnt(10) lgkmcnt(3)
  v_mfma_f32_32x32x16_bf16 v[16:31], v[80:83], a[12:15], v[16:31]
  ds_read_b128 v[96:99], v3 offset:10240
  buffer_load_dwordx4 a[56:59], v3, s[8:11], s21 offen offset:2048 sc1
  s_waitcnt lgkmcnt(3)
  v_mfma_f32_32x32x16_bf16 v[32:47], v[84:87], a[12:15], v[32:47]
  ds_read_b128 v[100:103], v3 offset:11264
  buffer_load_dwordx4 a[60:63], v3, s[8:11], s21 offen offset:3072 sc1
  s_add_u32 s21, s21, 4096
  s_waitcnt vmcnt(11) lgkmcnt(3)
  v_mfma_f32_32x32x16_bf16 v[16:31], v[88:91], a[16:19], v[16:31]
  ds_read_b128 v[80:83], v3 offset:12288
  s_waitcnt lgkmcnt(3)
  v_mfma_f32_32x32x16_bf16 v[32:47], v[92:95], a[16:19], v[32:47]
  ds_read_b128 v[84:87], v3 offset:13312
  buffer_load_dwordx4 a[64:67], v3, s[8:11], s21 offen offset:0 sc1
  s_waitcnt vmcnt(11) lgkmcnt(3)
  v_mfma_f32_32x32x16_bf16 v[16:31], v[96:99], a[20:23], v[16:31]
  ds_read_b128 v[88:91], v3 offset:14336
  s_waitcnt lgkmcnt(3)
  v_mfma_f32_32x32x16_bf16 v[32:47], v[100:103], a[20:23], v[32:47]
  ds_read_b128 v[92:95], v3 offset:15360
  buffer_load_dwordx4 a[68:71], v3, s[8:11], s21 offen offset:1024 sc1
  s_waitcnt vmcnt(11) lgkmcnt(3)
  v_mfma_f32_32x32x16_bf16 v[16:31], v[80:83], a[24:27], v[16:31]
  ds_read_b128 v[96:99], v3 offset:16384
  buffer_load_dwordx2 v[152:153], v8, s[8:11], s30 offen sc1
  s_add_u32 s30, s30, 16384
  s_waitcnt lgkmcnt(3)
  v_mfma_f32_32x32x16_bf16 v[32:47], v[84:87], a[24:27], v[32:47]
  ds_read_b128 v[100:103], v3 offset:17408
  buffer_load_dwordx4 a[72:75], v3, s[8:11], s21 offen offset:2048 sc1
  s_waitcnt vmcnt(12) lgkmcnt(3)
  v_mfma_f32_32x32x16_bf16 v[16:31], v[88:91], a[28:31], v[16:31]
  ds_read_b128 v[80:83], v3 offset:18432
  buffer_load_dwordx2 v[154:155], v8, s[8:11], s30 offen sc1
  s_add_u32 s30, s30, 16384
  s_waitcnt lgkmcnt(3)
  v_mfma_f32_32x32x16_bf16 v[32:47], v[92:95], a[28:31], v[32:47]
  ds_read_b128 v[84:87], v3 offset:19456
  buffer_load_dwordx4 a[76:79], v3, s[8:11], s21 offen offset:3072 sc1
  s_add_u32 s21, s21, 4096
  s_waitcnt vmcnt(13) lgkmcnt(3)
  v_mfma_f32_32x32x16_bf16 v[16:31], v[96:99], a[32:35], v[16:31]
  ds_read_b128 v[88:91], v3 offset:20480
  s_waitcnt lgkmcnt(3)
  v_mfma_f32_32x32x16_bf16 v[32:47], v[100:103], a[32:35], v[32:47]
  ds_read_b128 v[92:95], v3 offset:21504
  buffer_load_dwordx4 a[80:83], v3, s[8:11], s21 offen offset:0 sc1
  s_waitcnt vmcnt(13) lgkmcnt(3)
  v_mfma_f32_32x32x16_bf16 v[16:31], v[80:83], a[36:39], v[16:31]
  ds_read_b128 v[96:99], v3 offset:22528
  buffer_load_dwordx2 v[156:157], v8, s[8:11], s30 offen sc1
  s_add_u32 s30, s30, 16384
  s_waitcnt lgkmcnt(3)
  v_mfma_f32_32x32x16_bf16 v[32:47], v[84:87], a[36:39], v[32:47]
  ds_read_b128 v[100:103], v3 offset:23552
  buffer_load_dwordx4 a[84:87], v3, s[8:11], s21 offen offset:1024 sc1
  s_waitcnt vmcnt(14) lgkmcnt(3)
  v_mfma_f32_32x32x16_bf16 v[16:31], v[88:91], a[40:43], v[16:31]
  ds_read_b128 v[80:83], v3 offset:24576
  buffer_load_dwordx2 v[158:159], v8, s[8:11], s30 offen sc1
  s_add_u32 s30, s30, 16384
  s_waitcnt lgkmcnt(3)
  v_mfma_f32_32x32x16_bf16 v[32:47], v[92:95], a[40:43], v[32:47]
  ds_read_b128 v[84:87], v3 offset:25600
  buffer_load_dwordx4 a[88:91], v3, s[8:11], s21 offen offset:2048 sc1
  s_waitcnt vmcnt(15) lgkmcnt(3)
  v_mfma_f32_32x32x16_bf16 v[16:31], v[96:99], a[44:47], v[16:31]
  ds_read_b128 v[88:91], v3 offset:26624
  s_waitcnt lgkmcnt(3)
  v_mfma_f32_32x32x16_bf16 v[32:47], v[100:103], a[44:47], v[32:47]
  ds_read_b128 v[92:95], v3 offset:27648
  buffer_load_dwordx4 a[92:95], v3, s[8:11], s21 offen offset:3072 sc1
  s_add_u32 s21, s21, 4096
  s_waitcnt vmcnt(15) lgkmcnt(3)
  v_mfma_f32_32x32x16_bf16 v[16:31], v[80:83], a[48:51], v[16:31]
  ds_read_b128 v[96:99], v3 offset:28672
  buffer_load_dwordx2 v[160:161], v8, s[8:11], s30 offen sc1
  s_add_u32 s30, s30, 16384
  s_waitcnt lgkmcnt(3)
  v_mfma_f32_32x32x16_bf16 v[32:47], v[84:87], a[48:51], v[32:47]
  ds_read_b128 v[100:103], v3 offset:29696
  buffer_load_dwordx4 a[96:99], v3, s[8:11], s21 offen offset:0 sc1
  s_waitcnt vmcnt(16) lgkmcnt(3)
  v_mfma_f32_32x32x16_bf16 v[16:31], v[88:91], a[52:55], v[16:31]
  ds_read_b128 v[80:83], v3 offset:30720
  buffer_load_dwordx2 v[162:163], v8, s[8:11], s30 offen sc1
  s_add_u32 s30, s30, 16384
  s_waitcnt lgkmcnt(3)
  v_mfma_f32_32x32x16_bf16 v[32:47], v[92:95], a[52:55], v[32:47]
  ds_read_b128 v[84:87], v3 offset:31744
  buffer_load_dwordx4 a[100:103], v3, s[8:11], s21 offen offset:1024 sc1
  s_waitcnt vmcnt(17) lgkmcnt(3)
  v_mfma_f32_32x32x16_bf16 v[16:31], v[96:99], a[56:59], v[16:31]
  ds_read_b128 v[88:91], v3 offset:32768
  s_waitcnt lgkmcnt(3)
  v_mfma_f32_32x32x16_bf16 v[32:47], v[100:103], a[56:59], v[32:47]
  ds_read_b128 v[92:95], v3 offset:33792
  buffer_load_dwordx4 a[104:107], v3, s[8:11], s21 offen offset:2048 sc1
  s_waitcnt vmcnt(17) lgkmcnt(3)
  v_mfma_f32_32x32x16_bf16 v[16:31], v[80:83], a[60:63], v[16:31]
  ds_read_b128 v[96:99], v3 offset:34816
  buffer_load_dwordx2 v[164:165], v8, s[8:11], s30 offen sc1
  s_add_u32 s30, s30, 16384
  s_waitcnt lgkmcnt(3)
  v_mfma_f32_32x32x16_bf16 v[32:47], v[84:87], a[60:63], v[32:47]
  ds_read_b128 v[100:103], v3 offset:35840
  buffer_load_dwordx4 a[108:111], v3, s[8:11], s21 offen offset:3072 sc1
  s_add_u32 s21, s21, 4096
  s_barrier
  s_waitcnt vmcnt(18) lgkmcnt(3)
  v_mfma_f32_32x32x16_bf16 v[16:31], v[88:91], a[64:67], v[16:31]
  ds_read_b128 v[80:83], v3 offset:36864
  buffer_load_dwordx2 v[166:167], v8, s[8:11], s30 offen sc1
  s_add_u32 s30, s30, 16384
  s_waitcnt lgkmcnt(3)
  v_mfma_f32_32x32x16_bf16 v[32:47], v[92:95], a[64:67], v[32:47]
  ds_read_b128 v[84:87], v3 offset:37888
  buffer_load_dwordx4 a[112:115], v3, s[8:11], s21 offen offset:0 sc1
  s_waitcnt vmcnt(19) lgkmcnt(3)
  v_mfma_f32_32x32x16_bf16 v[16:31], v[96:99], a[68:71], v[16:31]
  ds_read_b128 v[88:91], v3 offset:38912
  s_waitcnt lgkmcnt(3)
  v_mfma_f32_32x32x16_bf16 v[32:47], v[100:103], a[68:71], v[32:47]
  ds_read_b128 v[92:95], v3 offset:39936
  buffer_load_dwordx4 a[116:119], v3, s[8:11], s21 offen offset:1024 sc1
  s_waitcnt vmcnt(18) lgkmcnt(3)
  v_mfma_f32_32x32x16_bf16 v[16:31], v[80:83], a[72:75], v[16:31]
  ds_read_b128 v[96:99], v3 offset:40960
  s_waitcnt lgkmcnt(3)
  v_mfma_f32_32x32x16_bf16 v[32:47], v[84:87], a[72:75], v[32:47]
  ds_read_b128 v[100:103], v3 offset:41984
  buffer_load_dwordx4 a[120:123], v3, s[8:11], s21 offen offset:2048 sc1
  s_waitcnt vmcnt(17) lgkmcnt(3)
  v_mfma_f32_32x32x16_bf16 v[16:31], v[88:91], a[76:79], v[16:31]
  ds_read_b128 v[80:83], v3 offset:43008
  s_waitcnt lgkmcnt(3)
  v_mfma_f32_32x32x16_bf16 v[32:47], v[92:95], a[76:79], v[32:47]
  ds_read_b128 v[84:87], v3 offset:44032
  buffer_load_dwordx4 a[124:127], v3, s[8:11], s21 offen offset:3072 sc1
  s_add_u32 s21, s21, 4096
  s_waitcnt vmcnt(17) lgkmcnt(3)
  v_mfma_f32_32x32x16_bf16 v[16:31], v[96:99], a[80:83], v[16:31]
  ds_read_b128 v[88:91], v3 offset:45056
  s_waitcnt lgkmcnt(3)
  v_mfma_f32_32x32x16_bf16 v[32:47], v[100:103], a[80:83], v[32:47]
  ds_read_b128 v[92:95], v3 offset:46080
  buffer_load_dwordx4 a[128:131], v3, s[8:11], s21 offen offset:0 sc1
  s_waitcnt vmcnt(16) lgkmcnt(3)
  v_mfma_f32_32x32x16_bf16 v[16:31], v[80:83], a[84:87], v[16:31]
  ds_read_b128 v[96:99], v3 offset:47104
  s_waitcnt lgkmcnt(3)
  v_mfma_f32_32x32x16_bf16 v[32:47], v[84:87], a[84:87], v[32:47]
  ds_read_b128 v[100:103], v3 offset:48128
  buffer_load_dwordx4 a[132:135], v3, s[8:11], s21 offen offset:1024 sc1
  s_waitcnt vmcnt(15) lgkmcnt(3)
  v_mfma_f32_32x32x16_bf16 v[16:31], v[88:91], a[88:91], v[16:31]
  ds_read_b128 v[80:83], v3 offset:49152
  s_waitcnt lgkmcnt(3)
  v_mfma_f32_32x32x16_bf16 v[32:47], v[92:95], a[88:91], v[32:47]
  ds_read_b128 v[84:87], v3 offset:50176
  buffer_load_dwordx4 a[136:139], v3, s[8:11], s21 offen offset:2048 sc1
  s_waitcnt vmcnt(15) lgkmcnt(3)
  v_mfma_f32_32x32x16_bf16 v[16:31], v[96:99], a[92:95], v[16:31]
  ds_read_b128 v[88:91], v3 offset:51200
  s_waitcnt lgkmcnt(3)
  v_mfma_f32_32x32x16_bf16 v[32:47], v[100:103], a[92:95], v[32:47]
  ds_read_b128 v[92:95], v3 offset:52224
  buffer_load_dwordx4 a[140:143], v3, s[8:11], s21 offen offset:3072 sc1
  s_add_u32 s21, s21, 4096
  s_waitcnt vmcnt(14) lgkmcnt(3)
  v_mfma_f32_32x32x16_bf16 v[16:31], v[80:83], a[96:99], v[16:31]
  ds_read_b128 v[96:99], v3 offset:53248
  s_waitcnt lgkmcnt(3)
  v_mfma_f32_32x32x16_bf16 v[32:47], v[84:87], a[96:99], v[32:47]
  ds_read_b128 v[100:103], v3 offset:54272
  s_waitcnt vmcnt(12) lgkmcnt(3)
  v_mfma_f32_32x32x16_bf16 v[16:31], v[88:91], a[100:103], v[16:31]
  ds_read_b128 v[80:83], v3 offset:55296
  s_waitcnt lgkmcnt(3)
  v_mfma_f32_32x32x16_bf16 v[32:47], v[92:95], a[100:103], v[32:47]
  ds_read_b128 v[84:87], v3 offset:56320
  s_waitcnt vmcnt(11) lgkmcnt(3)
  v_mfma_f32_32x32x16_bf16 v[16:31], v[96:99], a[104:107], v[16:31]
  ds_read_b128 v[88:91], v3 offset:57344
  s_waitcnt lgkmcnt(3)
  v_mfma_f32_32x32x16_bf16 v[32:47], v[100:103], a[104:107], v[32:47]
  ds_read_b128 v[92:95], v3 offset:58368
  s_waitcnt vmcnt(9) lgkmcnt(3)
  v_mfma_f32_32x32x16_bf16 v[16:31], v[80:83], a[108:111], v[16:31]
  ds_read_b128 v[96:99], v3 offset:59392
  s_waitcnt lgkmcnt(3)
  v_mfma_f32_32x32x16_bf16 v[32:47], v[84:87], a[108:111], v[32:47]
  ds_read_b128 v[100:103], v3 offset:60416
  s_waitcnt vmcnt(7) lgkmcnt(3)
  v_mfma_f32_32x32x16_bf16 v[16:31], v[88:91], a[112:115], v[16:31]
  ds_read_b128 v[80:83], v3 offset:61440
  s_waitcnt lgkmcnt(3)
  v_mfma_f32_32x32x16_bf16 v[32:47], v[92:95], a[112:115], v[32:47]
  ds_read_b128 v[84:87], v3 offset:62464
  s_waitcnt vmcnt(6) lgkmcnt(3)
  v_mfma_f32_32x32x16_bf16 v[16:31], v[96:99], a[116:119], v[16:31]
  ds_read_b128 v[88:91], v3 offset:63488
  v_add_f32 v152, v152, v154
  v_add_f32 v153, v153, v155
  s_waitcnt lgkmcnt(3)
  v_mfma_f32_32x32x16_bf16 v[32:47], v[100:103], a[116:119], v[32:47]
  ds_read_b128 v[92:95], v3 offset:64512
  v_add_f32 v152, v152, v156
  v_add_f32 v153, v153, v157
  v_add_f32 v152, v152, v158
  s_waitcnt vmcnt(5) lgkmcnt(3)
  v_mfma_f32_32x32x16_bf16 v[16:31], v[80:83], a[120:123], v[16:31]
  ds_read_b128 v[96:99], v4 offset:0
  s_add_u32 m0, s57, 110592
  s_add_u32 s58, m0, s56
  buffer_load_dwordx4 v3, s[4:7], s58 offen offset:0 lds
  s_waitcnt lgkmcnt(3)
  v_mfma_f32_32x32x16_bf16 v[32:47], v[84:87], a[120:123], v[32:47]
  ds_read_b128 v[100:103], v4 offset:1024
  buffer_load_dwordx4 v3, s[4:7], s58 offen offset:1024 lds
  s_waitcnt vmcnt(6) lgkmcnt(3)
  v_mfma_f32_32x32x16_bf16 v[16:31], v[88:91], a[124:127], v[16:31]
  ds_read_b128 v[80:83], v4 offset:2048
  buffer_load_dwordx4 v3, s[4:7], s58 offen offset:2048 lds
  s_waitcnt lgkmcnt(3)
  v_mfma_f32_32x32x16_bf16 v[32:47], v[92:95], a[124:127], v[32:47]
  ds_read_b128 v[84:87], v4 offset:3072
  s_add_u32 m0, s57, 122880
  s_add_u32 s58, m0, s56
  buffer_load_dwordx4 v3, s[4:7], s58 offen offset:0 lds
  s_waitcnt vmcnt(7) lgkmcnt(3)
  v_mfma_f32_32x32x16_bf16 v[16:31], v[96:99], a[128:131], v[16:31]
  ds_read_b128 v[88:91], v4 offset:4096
  buffer_load_dwordx4 v3, s[4:7], s58 offen offset:1024 lds
  s_waitcnt lgkmcnt(3)
  v_mfma_f32_32x32x16_bf16 v[32:47], v[100:103], a[128:131], v[32:47]
  ds_read_b128 v[92:95], v4 offset:5120
  buffer_load_dwordx4 v3, s[4:7], s58 offen offset:2048 lds
  s_waitcnt vmcnt(8) lgkmcnt(3)
  v_mfma_f32_32x32x16_bf16 v[16:31], v[80:83], a[132:135], v[16:31]
  ds_read_b128 v[96:99], v4 offset:6144
  s_add_u32 m0, s57, 135168
  s_add_u32 s58, m0, s56
  buffer_load_dwordx4 v3, s[4:7], s58 offen offset:0 lds
  s_waitcnt lgkmcnt(3)
  v_mfma_f32_32x32x16_bf16 v[32:47], v[84:87], a[132:135], v[32:47]
  ds_read_b128 v[100:103], v4 offset:7168
  buffer_load_dwordx4 v3, s[4:7], s58 offen offset:1024 lds
  s_barrier
  s_waitcnt vmcnt(9) lgkmcnt(3)
  v_mfma_f32_32x32x16_bf16 v[16:31], v[88:91], a[136:139], v[16:31]
  ds_read_b128 v[80:83], v4 offset:8192
  buffer_load_dwordx4 v3, s[4:7], s58 offen offset:2048 lds
  s_waitcnt lgkmcnt(3)
  v_mfma_f32_32x32x16_bf16 v[32:47], v[92:95], a[136:139], v[32:47]
  ds_read_b128 v[84:87], v4 offset:9216
  v_add_f32 v153, v153, v159
  v_add_f32 v152, v152, v160
  v_add_f32 v153, v153, v161
  s_waitcnt vmcnt(9) lgkmcnt(3)
  v_mfma_f32_32x32x16_bf16 v[16:31], v[96:99], a[140:143], v[16:31]
  ds_read_b128 v[88:91], v4 offset:10240
  v_add_f32 v152, v152, v162
  v_add_f32 v153, v153, v163
  v_add_f32 v152, v152, v164
  s_waitcnt lgkmcnt(3)
  v_mfma_f32_32x32x16_bf16 v[32:47], v[100:103], a[140:143], v[32:47]
  ds_read_b128 v[92:95], v4 offset:11264
  v_add_f32 v153, v153, v165
  v_add_f32 v152, v152, v166
  v_add_f32 v153, v153, v167
  s_waitcnt lgkmcnt(3)
  v_mfma_f32_32x32x16_bf16 v[48:63], v[80:83], a[0:3], 0
  ds_read_b128 v[96:99], v4 offset:12288
  v_mov_b32 v12, v152
  v_mov_b32 v14, v153
  s_nop 1
  s_waitcnt lgkmcnt(3)
  v_mfma_f32_32x32x16_bf16 v[64:79], v[84:87], a[0:3], 0
  ds_read_b128 v[100:103], v4 offset:13312
  v_permlane32_swap_b32 v12, v152
  v_permlane32_swap_b32 v14, v153
  v_add_f32 v12, v12, v152
  s_waitcnt lgkmcnt(3)
  v_mfma_f32_32x32x16_bf16 v[48:63], v[88:91], a[4:7], v[48:63]
  ds_read_b128 v[80:83], v4 offset:14336
  v_add_f32 v14, v14, v153
  v_mul_f32 v12, 0x3ae38e39, v12
  v_mul_f32 v14, 0x3ae38e39, v14
  s_waitcnt lgkmcnt(3)
  v_mfma_f32_32x32x16_bf16 v[64:79], v[92:95], a[4:7], v[64:79]
  ds_read_b128 v[84:87], v4 offset:15360
  v_fma_f32 v14, -v12, v12, v14
  v_max_f32 v14, 0, v14
  v_add_f32 v14, 0x3727c5ac, v14
  s_waitcnt lgkmcnt(3)
  v_mfma_f32_32x32x16_bf16 v[48:63], v[96:99], a[8:11], v[48:63]
  ds_read_b128 v[88:91], v4 offset:16384
  v_rsq_f32 v12, v14
  s_lshr_b32 s24, s19, 2
  s_lshl_b32 s24, s24, 4
  s_waitcnt lgkmcnt(3)
  v_mfma_f32_32x32x16_bf16 v[64:79], v[100:103], a[8:11], v[64:79]
  ds_read_b128 v[92:95], v4 offset:17408
  s_and_b32 s25, s19, 3
  s_lshl_b32 s25, s25, 1
  s_add_u32 s24, s24, s25
  s_waitcnt lgkmcnt(3)
  v_mfma_f32_32x32x16_bf16 v[48:63], v[80:83], a[12:15], v[48:63]
  ds_read_b128 v[96:99], v4 offset:18432
  s_lshl_b32 s24, s24, 17
  s_lshl_b32 s26, s18, 10
  s_add_u32 s24, s24, s26
  s_waitcnt lgkmcnt(3)
  v_mfma_f32_32x32x16_bf16 v[64:79], v[84:87], a[12:15], v[64:79]
  ds_read_b128 v[100:103], v4 offset:19456
  s_add_u32 s24, s24, 36700160
  s_cmp_lt_u32 s19, 4
  s_cselect_b32 s27, 0x3eae1a93, 1.0
  s_waitcnt lgkmcnt(3)
  v_mfma_f32_32x32x16_bf16 v[48:63], v[88:91], a[16:19], v[48:63]
  ds_read_b128 v[80:83], v4 offset:20480
  s_cmp_eq_u32 s19, 8
  s_cselect_b32 s26, 0x3eae1a93, s27
  s_cselect_b32 s25, 2, 8
  s_waitcnt lgkmcnt(3)
  v_mfma_f32_32x32x16_bf16 v[64:79], v[92:95], a[16:19], v[64:79]
  ds_read_b128 v[84:87], v4 offset:21504
  s_lshl_b32 s25, s25, 17
  v_mul_f32 v13, s26, v12
  s_add_u32 s28, s24, 0
  s_waitcnt lgkmcnt(3)
  v_mfma_f32_32x32x16_bf16 v[48:63], v[96:99], a[20:23], v[48:63]
  ds_read_b128 v[88:91], v4 offset:22528
  s_add_u32 s29, s28, 0x10000
  v_mul_f32 v16, v13, v16
  v_mul_f32 v17, v13, v17
  s_waitcnt lgkmcnt(3)
  v_mfma_f32_32x32x16_bf16 v[64:79], v[100:103], a[20:23], v[64:79]
  ds_read_b128 v[92:95], v4 offset:23552
  v_mul_f32 v18, v13, v18
  v_mul_f32 v19, v13, v19
  v_mul_f32 v20, v13, v20
  s_waitcnt lgkmcnt(3)
  v_mfma_f32_32x32x16_bf16 v[48:63], v[80:83], a[24:27], v[48:63]
  ds_read_b128 v[96:99], v4 offset:24576
  v_mul_f32 v21, v13, v21
  v_mul_f32 v22, v13, v22
  v_mul_f32 v23, v13, v23
  s_waitcnt lgkmcnt(3)
  v_mfma_f32_32x32x16_bf16 v[64:79], v[84:87], a[24:27], v[64:79]
  ds_read_b128 v[100:103], v4 offset:25600
  v_cvt_pk_bf16_f32 v104, v16, v17
  v_cvt_pk_bf16_f32 v105, v18, v19
  v_cvt_pk_bf16_f32 v106, v20, v21
  s_waitcnt lgkmcnt(3)
  v_mfma_f32_32x32x16_bf16 v[48:63], v[88:91], a[28:31], v[48:63]
  ds_read_b128 v[80:83], v4 offset:26624
  v_cvt_pk_bf16_f32 v107, v22, v23
  buffer_store_dwordx4 v[104:107], v3, s[8:11], s28 offen sc1
  s_waitcnt lgkmcnt(3)
  v_mfma_f32_32x32x16_bf16 v[64:79], v[92:95], a[28:31], v[64:79]
  ds_read_b128 v[84:87], v4 offset:27648
  v_mul_f32 v24, v13, v24
  v_mul_f32 v25, v13, v25
  v_mul_f32 v26, v13, v26
  s_waitcnt lgkmcnt(3)
  v_mfma_f32_32x32x16_bf16 v[48:63], v[96:99], a[32:35], v[48:63]
  ds_read_b128 v[88:91], v4 offset:28672
  v_mul_f32 v27, v13, v27
  v_mul_f32 v28, v13, v28
  v_mul_f32 v29, v13, v29
  s_waitcnt lgkmcnt(3)
  v_mfma_f32_32x32x16_bf16 v[64:79], v[100:103], a[32:35], v[64:79]
  ds_read_b128 v[92:95], v4 offset:29696
  v_mul_f32 v30, v13, v30
  v_mul_f32 v31, v13, v31
  v_cvt_pk_bf16_f32 v108, v24, v25
  s_waitcnt lgkmcnt(3)
  v_mfma_f32_32x32x16_bf16 v[48:63], v[80:83], a[36:39], v[48:63]
  ds_read_b128 v[96:99], v4 offset:30720
  v_cvt_pk_bf16_f32 v109, v26, v27
  v_cvt_pk_bf16_f32 v110, v28, v29
  v_cvt_pk_bf16_f32 v111, v30, v31
  s_waitcnt lgkmcnt(3)
  v_mfma_f32_32x32x16_bf16 v[64:79], v[84:87], a[36:39], v[64:79]
  ds_read_b128 v[100:103], v4 offset:31744
  buffer_store_dwordx4 v[108:111], v3, s[8:11], s29 offen sc1
  v_mul_f32 v13, s27, v12
  s_waitcnt lgkmcnt(3)
  v_mfma_f32_32x32x16_bf16 v[48:63], v[88:91], a[40:43], v[48:63]
  ds_read_b128 v[80:83], v4 offset:32768
  s_add_u32 s28, s24, 131072
  s_add_u32 s29, s28, 0x10000
  v_mul_f32 v32, v13, v32
  s_waitcnt lgkmcnt(3)
  v_mfma_f32_32x32x16_bf16 v[64:79], v[92:95], a[40:43], v[64:79]
  ds_read_b128 v[84:87], v4 offset:33792
  v_mul_f32 v33, v13, v33
  v_mul_f32 v34, v13, v34
  v_mul_f32 v35, v13, v35
  s_waitcnt lgkmcnt(3)
  v_mfma_f32_32x32x16_bf16 v[48:63], v[96:99], a[44:47], v[48:63]
  ds_read_b128 v[88:91], v4 offset:34816
  v_mul_f32 v36, v13, v36
  v_mul_f32 v37, v13, v37
  v_mul_f32 v38, v13, v38
  s_waitcnt lgkmcnt(3)
  v_mfma_f32_32x32x16_bf16 v[64:79], v[100:103], a[44:47], v[64:79]
  ds_read_b128 v[92:95], v4 offset:35840
  v_mul_f32 v39, v13, v39
  v_cvt_pk_bf16_f32 v112, v32, v33
  v_cvt_pk_bf16_f32 v113, v34, v35
  s_waitcnt lgkmcnt(3)
  v_mfma_f32_32x32x16_bf16 v[48:63], v[80:83], a[48:51], v[48:63]
  ds_read_b128 v[96:99], v4 offset:36864
  v_cvt_pk_bf16_f32 v114, v36, v37
  v_cvt_pk_bf16_f32 v115, v38, v39
  s_waitcnt lgkmcnt(3)
  v_mfma_f32_32x32x16_bf16 v[64:79], v[84:87], a[48:51], v[64:79]
  ds_read_b128 v[100:103], v4 offset:37888
  buffer_store_dwordx4 v[112:115], v3, s[8:11], s28 offen sc1
  v_mul_f32 v40, v13, v40
  s_waitcnt lgkmcnt(3)
  v_mfma_f32_32x32x16_bf16 v[48:63], v[88:91], a[52:55], v[48:63]
  ds_read_b128 v[80:83], v4 offset:38912
  v_mul_f32 v41, v13, v41
  v_mul_f32 v42, v13, v42
  v_mul_f32 v43, v13, v43
  s_waitcnt lgkmcnt(3)
  v_mfma_f32_32x32x16_bf16 v[64:79], v[92:95], a[52:55], v[64:79]
  ds_read_b128 v[84:87], v4 offset:39936
  v_mul_f32 v44, v13, v44
  v_mul_f32 v45, v13, v45
  v_mul_f32 v46, v13, v46
  s_waitcnt lgkmcnt(3)
  v_mfma_f32_32x32x16_bf16 v[48:63], v[96:99], a[56:59], v[48:63]
  ds_read_b128 v[88:91], v4 offset:40960
  v_mul_f32 v47, v13, v47
  v_cvt_pk_bf16_f32 v116, v40, v41
  v_cvt_pk_bf16_f32 v117, v42, v43
  s_waitcnt lgkmcnt(3)
  v_mfma_f32_32x32x16_bf16 v[64:79], v[100:103], a[56:59], v[64:79]
  ds_read_b128 v[92:95], v4 offset:41984
  v_cvt_pk_bf16_f32 v118, v44, v45
  v_cvt_pk_bf16_f32 v119, v46, v47
  s_waitcnt lgkmcnt(3)
  v_mfma_f32_32x32x16_bf16 v[48:63], v[80:83], a[60:63], v[48:63]
  ds_read_b128 v[96:99], v4 offset:43008
  buffer_store_dwordx4 v[116:119], v3, s[8:11], s29 offen sc1
  s_waitcnt lgkmcnt(3)
  v_mfma_f32_32x32x16_bf16 v[64:79], v[84:87], a[60:63], v[64:79]
  ds_read_b128 v[100:103], v4 offset:44032
  s_waitcnt vmcnt(10)
  s_barrier
  s_waitcnt lgkmcnt(3)
  v_mfma_f32_32x32x16_bf16 v[48:63], v[88:91], a[64:67], v[48:63]
  ds_read_b128 v[80:83], v4 offset:45056
  s_waitcnt lgkmcnt(3)
  v_mfma_f32_32x32x16_bf16 v[64:79], v[92:95], a[64:67], v[64:79]
  ds_read_b128 v[84:87], v4 offset:46080
  s_waitcnt lgkmcnt(3)
  v_mfma_f32_32x32x16_bf16 v[48:63], v[96:99], a[68:71], v[48:63]
  ds_read_b128 v[88:91], v4 offset:47104
  s_waitcnt lgkmcnt(3)
  v_mfma_f32_32x32x16_bf16 v[64:79], v[100:103], a[68:71], v[64:79]
  ds_read_b128 v[92:95], v4 offset:48128
  s_waitcnt lgkmcnt(3)
  v_mfma_f32_32x32x16_bf16 v[48:63], v[80:83], a[72:75], v[48:63]
  ds_read_b128 v[96:99], v4 offset:49152
  s_waitcnt lgkmcnt(3)
  v_mfma_f32_32x32x16_bf16 v[64:79], v[84:87], a[72:75], v[64:79]
  ds_read_b128 v[100:103], v4 offset:50176
  s_waitcnt lgkmcnt(3)
  v_mfma_f32_32x32x16_bf16 v[48:63], v[88:91], a[76:79], v[48:63]
  ds_read_b128 v[80:83], v4 offset:51200
  s_waitcnt lgkmcnt(3)
  v_mfma_f32_32x32x16_bf16 v[64:79], v[92:95], a[76:79], v[64:79]
  ds_read_b128 v[84:87], v4 offset:52224
  s_waitcnt lgkmcnt(3)
  v_mfma_f32_32x32x16_bf16 v[48:63], v[96:99], a[80:83], v[48:63]
  ds_read_b128 v[88:91], v4 offset:53248
  s_waitcnt lgkmcnt(3)
  v_mfma_f32_32x32x16_bf16 v[64:79], v[100:103], a[80:83], v[64:79]
  ds_read_b128 v[92:95], v4 offset:54272
  s_waitcnt lgkmcnt(3)
  v_mfma_f32_32x32x16_bf16 v[48:63], v[80:83], a[84:87], v[48:63]
  ds_read_b128 v[96:99], v4 offset:55296
  s_waitcnt lgkmcnt(3)
  v_mfma_f32_32x32x16_bf16 v[64:79], v[84:87], a[84:87], v[64:79]
  ds_read_b128 v[100:103], v4 offset:56320
  v_mov_b32 v10, 1
  v_min_u32 v11, 1, v0
  v_lshlrev_b32 v11, 31, v11
  s_waitcnt vmcnt(0)
  s_barrier
  buffer_store_dword v10, v11, s[8:11], s48 offen sc1
  s_waitcnt lgkmcnt(3)
  v_mfma_f32_32x32x16_bf16 v[48:63], v[88:91], a[88:91], v[48:63]
  ds_read_b128 v[80:83], v4 offset:57344
  s_bfe_u32 s31, s2, 0x40003
  s_waitcnt lgkmcnt(3)
  v_mfma_f32_32x32x16_bf16 v[64:79], v[92:95], a[88:91], v[64:79]
  ds_read_b128 v[84:87], v4 offset:58368
  s_lshr_b32 s33, s2, 7
  s_and_b32 s32, s2, 7
  s_lshl_b32 s32, s32, 1
  s_waitcnt lgkmcnt(3)
  v_mfma_f32_32x32x16_bf16 v[48:63], v[96:99], a[92:95], v[48:63]
  ds_read_b128 v[88:91], v4 offset:59392
  s_add_u32 s32, s32, s33
  s_lshr_b32 s35, s32, 2
  s_mul_i32 s34, s35, 0x1010001
  s_waitcnt lgkmcnt(3)
  v_mfma_f32_32x32x16_bf16 v[64:79], v[100:103], a[92:95], v[64:79]
  ds_read_b128 v[92:95], v4 offset:60416
  s_add_u32 s34, s34, 0x80809984
  s_mul_i32 s36, s32, 18
  s_lshr_b32 s35, s36, 6
  s_waitcnt lgkmcnt(3)
  v_mfma_f32_32x32x16_bf16 v[48:63], v[80:83], a[96:99], v[48:63]
  ds_read_b128 v[96:99], v4 offset:61440
  s_lshl_b32 s35, s35, 8
  s_add_u32 s34, s34, s35
  s_add_u32 s36, s36, 17
  s_waitcnt lgkmcnt(3)
  v_mfma_f32_32x32x16_bf16 v[64:79], v[84:87], a[96:99], v[64:79]
  ds_read_b128 v[100:103], v4 offset:62464
  s_lshr_b32 s36, s36, 6
  s_lshl_b32 s36, s36, 12
  s_add_u32 s34, s34, s36
  s_waitcnt lgkmcnt(3)
  v_mfma_f32_32x32x16_bf16 v[48:63], v[88:91], a[100:103], v[48:63]
  ds_read_b128 v[80:83], v4 offset:63488
  v_bfe_u32 v184, v1, 2, 2
  v_and_b32 v185, 3, v1
  v_cmp_eq_u32 vcc, 3, v184
  s_waitcnt lgkmcnt(3)
  v_mfma_f32_32x32x16_bf16 v[64:79], v[92:95], a[100:103], v[64:79]
  ds_read_b128 v[84:87], v4 offset:64512
  v_min_u32 v184, 2, v184
  v_add_u32 v186, 4, v185
  v_cndmask_b32 v185, v185, v186, vcc
  s_waitcnt lgkmcnt(3)
  v_mfma_f32_32x32x16_bf16 v[48:63], v[96:99], a[104:107], v[48:63]
  ds_read_b128 v[88:91], v5 offset:0
  v_lshlrev_b32 v185, 2, v185
  v_bfe_u32 v185, s34, v185, 4
  s_sub_u32 s35, s31, 2
  s_waitcnt lgkmcnt(3)
  v_mfma_f32_32x32x16_bf16 v[64:79], v[100:103], a[104:107], v[64:79]
  ds_read_b128 v[92:95], v5 offset:1024
  v_add_u32 v184, s35, v184
  v_max_i32 v184, 0, v184
  v_lshl_add_u32 v184, v184, 4, v185
  s_waitcnt lgkmcnt(3)
  v_mfma_f32_32x32x16_bf16 v[48:63], v[80:83], a[108:111], v[48:63]
  ds_read_b128 v[96:99], v5 offset:2048
  v_lshlrev_b32 v184, 6, v184
  s_mov_b32 s40, 83886080
  s_lshl_b32 s34, s31, 2
  s_waitcnt lgkmcnt(3)
  v_mfma_f32_32x32x16_bf16 v[64:79], v[84:87], a[108:111], v[64:79]
  ds_read_b128 v[100:103], v5 offset:3072
  s_add_u32 s33, s34, s20
  v_and_b32 v191, 31, v1
  v_lshrrev_b32 v192, 5, v1
  s_barrier
  s_waitcnt lgkmcnt(3)
  v_mfma_f32_32x32x16_bf16 v[48:63], v[88:91], a[112:115], v[48:63]
  ds_read_b128 v[80:83], v5 offset:4096
  s_mul_i32 s35, s20, 3
  s_waitcnt lgkmcnt(3)
  v_mfma_f32_32x32x16_bf16 v[64:79], v[92:95], a[112:115], v[64:79]
  ds_read_b128 v[84:87], v5 offset:5120
  s_add_u32 s34, s34, s35
  s_sub_u32 s34, s34, 8
  s_lshl_b32 s41, s32, 16
  s_waitcnt lgkmcnt(3)
  v_mfma_f32_32x32x16_bf16 v[48:63], v[96:99], a[116:119], v[48:63]
  ds_read_b128 v[88:91], v5 offset:6144
  s_add_u32 s42, s41, 36700160
  s_add_u32 s41, s41, 38797312
  s_lshl_b32 s35, s33, 10
  s_waitcnt lgkmcnt(3)
  v_mfma_f32_32x32x16_bf16 v[64:79], v[100:103], a[116:119], v[64:79]
  ds_read_b128 v[92:95], v5 offset:7168
  s_add_u32 s42, s42, s35
  s_bfe_u32 s43, s32, 0x10002
  s_lshl_b32 s43, s43, 16
  s_waitcnt lgkmcnt(3)
  v_mfma_f32_32x32x16_bf16 v[48:63], v[80:83], a[120:123], v[48:63]
  ds_read_b128 v[96:99], v5 offset:8192
  s_bfe_u32 s44, s32, 0x10003
  s_lshl_b32 s44, s44, 9
  s_add_u32 s43, s43, s44
  s_waitcnt lgkmcnt(3)
  v_mfma_f32_32x32x16_bf16 v[64:79], v[84:87], a[120:123], v[64:79]
  ds_read_b128 v[100:103], v5 offset:9216
  s_and_b32 s44, s32, 3
  s_lshl_b32 s44, s44, 2
  s_add_u32 s43, s43, s44
  s_waitcnt lgkmcnt(3)
  v_mfma_f32_32x32x16_bf16 v[48:63], v[88:91], a[124:127], v[48:63]
  ds_read_b128 v[80:83], v5 offset:10240
  s_add_u32 s43, s43, 40894464
  s_add_u32 s44, s43, s35
  s_add_u32 s43, s43, 0x20000
  s_waitcnt lgkmcnt(3)
  v_mfma_f32_32x32x16_bf16 v[64:79], v[92:95], a[124:127], v[64:79]
  ds_read_b128 v[84:87], v5 offset:11264
  s_lshl_b32 s35, s34, 10
  v_add_u32 v186, s35, v3
  v_lshlrev_b32 v187, 4, v191
  s_waitcnt lgkmcnt(3)
  v_mfma_f32_32x32x16_bf16 v[48:63], v[96:99], a[128:131], v[48:63]
  ds_read_b128 v[88:91], v5 offset:12288
  v_lshl_add_u32 v188, v192, 10, v187
  v_add_u32 v188, s35, v188
  s_add_u32 s12, s8, 41943040
  s_waitcnt lgkmcnt(3)
  v_mfma_f32_32x32x16_bf16 v[64:79], v[100:103], a[128:131], v[64:79]
  ds_read_b128 v[92:95], v5 offset:13312
  s_addc_u32 s13, s9, 0
  s_mov_b32 s14, 2359360
  s_mov_b32 s15, 0x20000
  s_waitcnt lgkmcnt(3)
  v_mfma_f32_32x32x16_bf16 v[48:63], v[80:83], a[132:135], v[48:63]
  ds_read_b128 v[96:99], v5 offset:14336
  s_mul_i32 s34, s34, 36864
  s_mul_i32 s36, s32, 288
  s_add_u32 s34, s34, s36
  s_waitcnt lgkmcnt(3)
  v_mfma_f32_32x32x16_bf16 v[64:79], v[84:87], a[132:135], v[64:79]
  ds_read_b128 v[100:103], v5 offset:15360
  v_mul_u32_u24 v189, 9216, v192
  v_add_u32 v189, v189, v187
  v_cmp_gt_u32 vcc, 18, v191
  s_waitcnt lgkmcnt(3)
  v_mfma_f32_32x32x16_bf16 v[48:63], v[88:91], a[136:139], v[48:63]
  v_add_u32 v189, s34, v189
  v_mov_b32 v190, 2359296
  v_lshl_or_b32 v187, v192, 31, v187
  v_cndmask_b32 v189, v190, v189, vcc
  s_waitcnt lgkmcnt(2)
  v_mfma_f32_32x32x16_bf16 v[64:79], v[92:95], a[136:139], v[64:79]
  v_mov_b32 v190, 18432
  s_mul_i32 s35, s20, 3072
  v_cndmask_b32 v190, 0, v190, vcc
  s_mul_i32 s37, s20, 384
  s_waitcnt lgkmcnt(1)
  v_mfma_f32_32x32x16_bf16 v[48:63], v[96:99], a[140:143], v[48:63]
  s_add_u32 s37, s37, 24576
  s_mul_i32 s38, s20, 6144
  s_add_u32 s38, s38, 28672
  s_waitcnt lgkmcnt(0)
  v_mfma_f32_32x32x16_bf16 v[64:79], v[100:103], a[140:143], v[64:79]
  buffer_load_dword v185, v184, s[8:11], s40 offen sc1
  s_waitcnt vmcnt(0)
  s_mov_b32 s53, 0
  s_branch p2_eqc
p2_eqp:
  buffer_load_dword v185, v184, s[8:11], s40 offen sc1
  s_add_u32 s53, s53, 1
  s_waitcnt vmcnt(0)
p2_eqc:
  v_cmp_gt_u32 vcc, 1, v185
  s_cmp_gt_u32 s53, 0x8000
  s_cbranch_scc1 p2_eqg
  s_cbranch_vccz p2_eqg
  s_sleep 2
  s_branch p2_eqp
p2_eqg:
  s_add_u32 m0, s35, 0
  s_nop 0
  buffer_load_dwordx4 v186, s[8:11], s41 offen sc1 lds
  s_add_u32 m0, s35, 1024
  v_add_u32 v186, 1024, v186
  buffer_load_dwordx4 v186, s[8:11], s41 offen sc1 lds
  s_add_u32 m0, s35, 2048
  v_add_u32 v186, 1024, v186
  buffer_load_dwordx4 v186, s[8:11], s41 offen sc1 lds
  s_add_u32 m0, s37, 0
  s_nop 0
  buffer_load_dword v188, s[8:11], s43 offen sc1 lds
  s_add_u32 m0, s37, 256
  v_add_u32 v188, 2048, v188
  buffer_load_dword v188, s[8:11], s43 offen sc1 lds
  buffer_load_dwordx4 v[124:127], v3, s[8:11], s42 offen sc1
  buffer_load_dword v128, v187, s[8:11], s44 offen sc1
  s_add_u32 m0, s38, 0
  s_nop 0
  buffer_load_dwordx4 v189, s[12:15], 0 offen sc1 lds
  s_add_u32 m0, s38, 1024
  v_add_u32 v189, v189, v190
  buffer_load_dwordx4 v189, s[12:15], 0 offen sc1 lds
  s_add_u32 m0, s38, 2048
  v_add_u32 v189, v189, v190
  buffer_load_dwordx4 v189, s[12:15], 0 offen sc1 lds
  s_add_u32 m0, s38, 3072
  v_add_u32 v189, v189, v190
  buffer_load_dwordx4 v189, s[12:15], 0 offen sc1 lds
  s_add_u32 m0, s38, 4096
  v_add_u32 v189, v189, v190
  buffer_load_dwordx4 v189, s[12:15], 0 offen sc1 lds
  s_add_u32 m0, s38, 5120
  v_add_u32 v189, v189, v190
  buffer_load_dwordx4 v189, s[12:15], 0 offen sc1 lds
  s_nop 7
  v_mul_f32 v13, s26, v12
  s_add_u32 s28, s24, 0
  s_add_u32 s28, s28, s25
  s_add_u32 s29, s28, 0x10000
  v_mul_f32 v48, v13, v48
  v_mul_f32 v49, v13, v49
  v_mul_f32 v50, v13, v50
  v_mul_f32 v51, v13, v51
  v_mul_f32 v52, v13, v52
  v_mul_f32 v53, v13, v53
  v_mul_f32 v54, v13, v54
  v_mul_f32 v55, v13, v55
  v_cvt_pk_bf16_f32 v104, v48, v49
  v_cvt_pk_bf16_f32 v105, v50, v51
  v_cvt_pk_bf16_f32 v106, v52, v53
  v_cvt_pk_bf16_f32 v107, v54, v55
  buffer_store_dwordx4 v[104:107], v3, s[8:11], s28 offen sc1
  v_mul_f32 v56, v13, v56
  v_mul_f32 v57, v13, v57
  v_mul_f32 v58, v13, v58
  v_mul_f32 v59, v13, v59
  v_mul_f32 v60, v13, v60
  v_mul_f32 v61, v13, v61
  v_mul_f32 v62, v13, v62
  v_mul_f32 v63, v13, v63
  v_cvt_pk_bf16_f32 v108, v56, v57
  v_cvt_pk_bf16_f32 v109, v58, v59
  v_cvt_pk_bf16_f32 v110, v60, v61
  v_cvt_pk_bf16_f32 v111, v62, v63
  buffer_store_dwordx4 v[108:111], v3, s[8:11], s29 offen sc1
  v_mul_f32 v13, s27, v12
  s_add_u32 s28, s24, 131072
  s_add_u32 s28, s28, s25
  s_add_u32 s29, s28, 0x10000
  v_mul_f32 v64, v13, v64
  v_mul_f32 v65, v13, v65
  v_mul_f32 v66, v13, v66
  v_mul_f32 v67, v13, v67
  v_mul_f32 v68, v13, v68
  v_mul_f32 v69, v13, v69
  v_mul_f32 v70, v13, v70
  v_mul_f32 v71, v13, v71
  v_cvt_pk_bf16_f32 v112, v64, v65
  v_cvt_pk_bf16_f32 v113, v66, v67
  v_cvt_pk_bf16_f32 v114, v68, v69
  v_cvt_pk_bf16_f32 v115, v70, v71
  buffer_store_dwordx4 v[112:115], v3, s[8:11], s28 offen sc1
  v_mul_f32 v72, v13, v72
  v_mul_f32 v73, v13, v73
  v_mul_f32 v74, v13, v74
  v_mul_f32 v75, v13, v75
  v_mul_f32 v76, v13, v76
  v_mul_f32 v77, v13, v77
  v_mul_f32 v78, v13, v78
  v_mul_f32 v79, v13, v79
  v_cvt_pk_bf16_f32 v116, v72, v73
  v_cvt_pk_bf16_f32 v117, v74, v75
  v_cvt_pk_bf16_f32 v118, v76, v77
  v_cvt_pk_bf16_f32 v119, v78, v79
  buffer_store_dwordx4 v[116:119], v3, s[8:11], s29 offen sc1
  s_branch p1_1e
p1_v:
  s_waitcnt vmcnt(32)
  s_barrier
  ds_read_b128 v[80:83], v3 offset:0
  ds_read_b128 v[84:87], v3 offset:1024
  ds_read_b128 v[88:91], v3 offset:2048
  ds_read_b128 v[92:95], v3 offset:3072
  s_waitcnt vmcnt(7) lgkmcnt(3)
  v_mfma_f32_32x32x16_bf16 v[16:31], a[0:3], v[80:83], 0
  ds_read_b128 v[96:99], v3 offset:4096
  buffer_load_dwordx4 a[32:35], v3, s[8:11], s21 offen offset:0 sc1
  s_waitcnt lgkmcnt(3)
  v_mfma_f32_32x32x16_bf16 v[32:47], a[0:3], v[84:87], 0
  ds_read_b128 v[100:103], v3 offset:5120
  buffer_load_dwordx4 a[36:39], v3, s[8:11], s21 offen offset:1024 sc1
  s_waitcnt vmcnt(8) lgkmcnt(3)
  v_mfma_f32_32x32x16_bf16 v[16:31], a[4:7], v[88:91], v[16:31]
  ds_read_b128 v[80:83], v3 offset:6144
  buffer_load_dwordx4 a[40:43], v3, s[8:11], s21 offen offset:2048 sc1
  s_waitcnt lgkmcnt(3)
  v_mfma_f32_32x32x16_bf16 v[32:47], a[4:7], v[92:95], v[32:47]
  ds_read_b128 v[84:87], v3 offset:7168
  buffer_load_dwordx4 a[44:47], v3, s[8:11], s21 offen offset:3072 sc1
  s_add_u32 s21, s21, 4096
  s_waitcnt vmcnt(9) lgkmcnt(3)
  v_mfma_f32_32x32x16_bf16 v[16:31], a[8:11], v[96:99], v[16:31]
  ds_read_b128 v[88:91], v3 offset:8192
  buffer_load_dwordx4 a[48:51], v3, s[8:11], s21 offen offset:0 sc1
  s_waitcnt lgkmcnt(3)
  v_mfma_f32_32x32x16_bf16 v[32:47], a[8:11], v[100:103], v[32:47]
  ds_read_b128 v[92:95], v3 offset:9216
  buffer_load_dwordx4 a[52:55], v3, s[8:11], s21 offen offset:1024 sc1
  s_waitcnt vmcnt(10) lgkmcnt(3)
  v_mfma_f32_32x32x16_bf16 v[16:31], a[12:15], v[80:83], v[16:31]
  ds_read_b128 v[96:99], v3 offset:10240
  buffer_load_dwordx4 a[56:59], v3, s[8:11], s21 offen offset:2048 sc1
  s_waitcnt lgkmcnt(3)
  v_mfma_f32_32x32x16_bf16 v[32:47], a[12:15], v[84:87], v[32:47]
  ds_read_b128 v[100:103], v3 offset:11264
  buffer_load_dwordx4 a[60:63], v3, s[8:11], s21 offen offset:3072 sc1
  s_add_u32 s21, s21, 4096
  s_waitcnt vmcnt(11) lgkmcnt(3)
  v_mfma_f32_32x32x16_bf16 v[16:31], a[16:19], v[88:91], v[16:31]
  ds_read_b128 v[80:83], v3 offset:12288
  s_waitcnt lgkmcnt(3)
  v_mfma_f32_32x32x16_bf16 v[32:47], a[16:19], v[92:95], v[32:47]
  ds_read_b128 v[84:87], v3 offset:13312
  buffer_load_dwordx4 a[64:67], v3, s[8:11], s21 offen offset:0 sc1
  s_waitcnt vmcnt(11) lgkmcnt(3)
  v_mfma_f32_32x32x16_bf16 v[16:31], a[20:23], v[96:99], v[16:31]
  ds_read_b128 v[88:91], v3 offset:14336
  s_waitcnt lgkmcnt(3)
  v_mfma_f32_32x32x16_bf16 v[32:47], a[20:23], v[100:103], v[32:47]
  ds_read_b128 v[92:95], v3 offset:15360
  buffer_load_dwordx4 a[68:71], v3, s[8:11], s21 offen offset:1024 sc1
  s_waitcnt vmcnt(11) lgkmcnt(3)
  v_mfma_f32_32x32x16_bf16 v[16:31], a[24:27], v[80:83], v[16:31]
  ds_read_b128 v[96:99], v3 offset:16384
  buffer_load_dwordx2 v[152:153], v8, s[8:11], s30 offen sc1
  s_add_u32 s30, s30, 16384
  s_waitcnt lgkmcnt(3)
  v_mfma_f32_32x32x16_bf16 v[32:47], a[24:27], v[84:87], v[32:47]
  ds_read_b128 v[100:103], v3 offset:17408
  buffer_load_dwordx4 a[72:75], v3, s[8:11], s21 offen offset:2048 sc1
  s_waitcnt vmcnt(12) lgkmcnt(3)
  v_mfma_f32_32x32x16_bf16 v[16:31], a[28:31], v[88:91], v[16:31]
  ds_read_b128 v[80:83], v3 offset:18432
  buffer_load_dwordx2 v[154:155], v8, s[8:11], s30 offen sc1
  s_add_u32 s30, s30, 16384
  s_waitcnt lgkmcnt(3)
  v_mfma_f32_32x32x16_bf16 v[32:47], a[28:31], v[92:95], v[32:47]
  ds_read_b128 v[84:87], v3 offset:19456
  buffer_load_dwordx4 a[76:79], v3, s[8:11], s21 offen offset:3072 sc1
  s_add_u32 s21, s21, 4096
  s_waitcnt vmcnt(13) lgkmcnt(3)
  v_mfma_f32_32x32x16_bf16 v[16:31], a[32:35], v[96:99], v[16:31]
  ds_read_b128 v[88:91], v3 offset:20480
  s_waitcnt lgkmcnt(3)
  v_mfma_f32_32x32x16_bf16 v[32:47], a[32:35], v[100:103], v[32:47]
  ds_read_b128 v[92:95], v3 offset:21504
  buffer_load_dwordx4 a[80:83], v3, s[8:11], s21 offen offset:0 sc1
  s_waitcnt vmcnt(13) lgkmcnt(3)
  v_mfma_f32_32x32x16_bf16 v[16:31], a[36:39], v[80:83], v[16:31]
  ds_read_b128 v[96:99], v3 offset:22528
  buffer_load_dwordx2 v[156:157], v8, s[8:11], s30 offen sc1
  s_add_u32 s30, s30, 16384
  s_waitcnt lgkmcnt(3)
  v_mfma_f32_32x32x16_bf16 v[32:47], a[36:39], v[84:87], v[32:47]
  ds_read_b128 v[100:103], v3 offset:23552
  buffer_load_dwordx4 a[84:87], v3, s[8:11], s21 offen offset:1024 sc1
  s_waitcnt vmcnt(14) lgkmcnt(3)
  v_mfma_f32_32x32x16_bf16 v[16:31], a[40:43], v[88:91], v[16:31]
  ds_read_b128 v[80:83], v3 offset:24576
  buffer_load_dwordx2 v[158:159], v8, s[8:11], s30 offen sc1
  s_add_u32 s30, s30, 16384
  s_waitcnt lgkmcnt(3)
  v_mfma_f32_32x32x16_bf16 v[32:47], a[40:43], v[92:95], v[32:47]
  ds_read_b128 v[84:87], v3 offset:25600
  buffer_load_dwordx4 a[88:91], v3, s[8:11], s21 offen offset:2048 sc1
  s_waitcnt vmcnt(15) lgkmcnt(3)
  v_mfma_f32_32x32x16_bf16 v[16:31], a[44:47], v[96:99], v[16:31]
  ds_read_b128 v[88:91], v3 offset:26624
  s_waitcnt lgkmcnt(3)
  v_mfma_f32_32x32x16_bf16 v[32:47], a[44:47], v[100:103], v[32:47]
  ds_read_b128 v[92:95], v3 offset:27648
  buffer_load_dwordx4 a[92:95], v3, s[8:11], s21 offen offset:3072 sc1
  s_add_u32 s21, s21, 4096
  s_waitcnt vmcnt(15) lgkmcnt(3)
  v_mfma_f32_32x32x16_bf16 v[16:31], a[48:51], v[80:83], v[16:31]
  ds_read_b128 v[96:99], v3 offset:28672
  buffer_load_dwordx2 v[160:161], v8, s[8:11], s30 offen sc1
  s_add_u32 s30, s30, 16384
  s_waitcnt lgkmcnt(3)
  v_mfma_f32_32x32x16_bf16 v[32:47], a[48:51], v[84:87], v[32:47]
  ds_read_b128 v[100:103], v3 offset:29696
  buffer_load_dwordx4 a[96:99], v3, s[8:11], s21 offen offset:0 sc1
  s_waitcnt vmcnt(16) lgkmcnt(3)
  v_mfma_f32_32x32x16_bf16 v[16:31], a[52:55], v[88:91], v[16:31]
  ds_read_b128 v[80:83], v3 offset:30720
  buffer_load_dwordx2 v[162:163], v8, s[8:11], s30 offen sc1
  s_add_u32 s30, s30, 16384
  s_waitcnt lgkmcnt(3)
  v_mfma_f32_32x32x16_bf16 v[32:47], a[52:55], v[92:95], v[32:47]
  ds_read_b128 v[84:87], v3 offset:31744
  buffer_load_dwordx4 a[100:103], v3, s[8:11], s21 offen offset:1024 sc1
  s_waitcnt vmcnt(17) lgkmcnt(3)
  v_mfma_f32_32x32x16_bf16 v[16:31], a[56:59], v[96:99], v[16:31]
  ds_read_b128 v[88:91], v3 offset:32768
  s_waitcnt lgkmcnt(3)
  v_mfma_f32_32x32x16_bf16 v[32:47], a[56:59], v[100:103], v[32:47]
  ds_read_b128 v[92:95], v3 offset:33792
  buffer_load_dwordx4 a[104:107], v3, s[8:11], s21 offen offset:2048 sc1
  s_waitcnt vmcnt(17) lgkmcnt(3)
  v_mfma_f32_32x32x16_bf16 v[16:31], a[60:63], v[80:83], v[16:31]
  ds_read_b128 v[96:99], v3 offset:34816
  buffer_load_dwordx2 v[164:165], v8, s[8:11], s30 offen sc1
  s_add_u32 s30, s30, 16384
  s_waitcnt lgkmcnt(3)
  v_mfma_f32_32x32x16_bf16 v[32:47], a[60:63], v[84:87], v[32:47]
  ds_read_b128 v[100:103], v3 offset:35840
  buffer_load_dwordx4 a[108:111], v3, s[8:11], s21 offen offset:3072 sc1
  s_add_u32 s21, s21, 4096
  s_barrier
  s_waitcnt vmcnt(18) lgkmcnt(3)
  v_mfma_f32_32x32x16_bf16 v[16:31], a[64:67], v[88:91], v[16:31]
  ds_read_b128 v[80:83], v3 offset:36864
  buffer_load_dwordx2 v[166:167], v8, s[8:11], s30 offen sc1
  s_add_u32 s30, s30, 16384
  s_waitcnt lgkmcnt(3)
  v_mfma_f32_32x32x16_bf16 v[32:47], a[64:67], v[92:95], v[32:47]
  ds_read_b128 v[84:87], v3 offset:37888
  buffer_load_dwordx4 a[112:115], v3, s[8:11], s21 offen offset:0 sc1
  s_waitcnt vmcnt(19) lgkmcnt(3)
  v_mfma_f32_32x32x16_bf16 v[16:31], a[68:71], v[96:99], v[16:31]
  ds_read_b128 v[88:91], v3 offset:38912
  s_waitcnt lgkmcnt(3)
  v_mfma_f32_32x32x16_bf16 v[32:47], a[68:71], v[100:103], v[32:47]
  ds_read_b128 v[92:95], v3 offset:39936
  buffer_load_dwordx4 a[116:119], v3, s[8:11], s21 offen offset:1024 sc1
  s_waitcnt vmcnt(18) lgkmcnt(3)
  v_mfma_f32_32x32x16_bf16 v[16:31], a[72:75], v[80:83], v[16:31]
  ds_read_b128 v[96:99], v3 offset:40960
  s_waitcnt lgkmcnt(3)
  v_mfma_f32_32x32x16_bf16 v[32:47], a[72:75], v[84:87], v[32:47]
  ds_read_b128 v[100:103], v3 offset:41984
  buffer_load_dwordx4 a[120:123], v3, s[8:11], s21 offen offset:2048 sc1
  s_waitcnt vmcnt(17) lgkmcnt(3)
  v_mfma_f32_32x32x16_bf16 v[16:31], a[76:79], v[88:91], v[16:31]
  ds_read_b128 v[80:83], v3 offset:43008
  s_waitcnt lgkmcnt(3)
  v_mfma_f32_32x32x16_bf16 v[32:47], a[76:79], v[92:95], v[32:47]
  ds_read_b128 v[84:87], v3 offset:44032
  buffer_load_dwordx4 a[124:127], v3, s[8:11], s21 offen offset:3072 sc1
  s_add_u32 s21, s21, 4096
  s_waitcnt vmcnt(17) lgkmcnt(3)
  v_mfma_f32_32x32x16_bf16 v[16:31], a[80:83], v[96:99], v[16:31]
  ds_read_b128 v[88:91], v3 offset:45056
  s_waitcnt lgkmcnt(3)
  v_mfma_f32_32x32x16_bf16 v[32:47], a[80:83], v[100:103], v[32:47]
  ds_read_b128 v[92:95], v3 offset:46080
  buffer_load_dwordx4 a[128:131], v3, s[8:11], s21 offen offset:0 sc1
  s_waitcnt vmcnt(16) lgkmcnt(3)
  v_mfma_f32_32x32x16_bf16 v[16:31], a[84:87], v[80:83], v[16:31]
  ds_read_b128 v[96:99], v3 offset:47104
  s_waitcnt lgkmcnt(3)
  v_mfma_f32_32x32x16_bf16 v[32:47], a[84:87], v[84:87], v[32:47]
  ds_read_b128 v[100:103], v3 offset:48128
  buffer_load_dwordx4 a[132:135], v3, s[8:11], s21 offen offset:1024 sc1
  s_waitcnt vmcnt(15) lgkmcnt(3)
  v_mfma_f32_32x32x16_bf16 v[16:31], a[88:91], v[88:91], v[16:31]
  ds_read_b128 v[80:83], v3 offset:49152
  s_waitcnt lgkmcnt(3)
  v_mfma_f32_32x32x16_bf16 v[32:47], a[88:91], v[92:95], v[32:47]
  ds_read_b128 v[84:87], v3 offset:50176
  buffer_load_dwordx4 a[136:139], v3, s[8:11], s21 offen offset:2048 sc1
  s_waitcnt vmcnt(15) lgkmcnt(3)
  v_mfma_f32_32x32x16_bf16 v[16:31], a[92:95], v[96:99], v[16:31]
  ds_read_b128 v[88:91], v3 offset:51200
  s_waitcnt lgkmcnt(3)
  v_mfma_f32_32x32x16_bf16 v[32:47], a[92:95], v[100:103], v[32:47]
  ds_read_b128 v[92:95], v3 offset:52224
  buffer_load_dwordx4 a[140:143], v3, s[8:11], s21 offen offset:3072 sc1
  s_add_u32 s21, s21, 4096
  s_waitcnt vmcnt(14) lgkmcnt(3)
  v_mfma_f32_32x32x16_bf16 v[16:31], a[96:99], v[80:83], v[16:31]
  ds_read_b128 v[96:99], v3 offset:53248
  s_waitcnt lgkmcnt(3)
  v_mfma_f32_32x32x16_bf16 v[32:47], a[96:99], v[84:87], v[32:47]
  ds_read_b128 v[100:103], v3 offset:54272
  s_waitcnt vmcnt(12) lgkmcnt(3)
  v_mfma_f32_32x32x16_bf16 v[16:31], a[100:103], v[88:91], v[16:31]
  ds_read_b128 v[80:83], v3 offset:55296
  s_waitcnt lgkmcnt(3)
  v_mfma_f32_32x32x16_bf16 v[32:47], a[100:103], v[92:95], v[32:47]
  ds_read_b128 v[84:87], v3 offset:56320
  s_waitcnt vmcnt(11) lgkmcnt(3)
  v_mfma_f32_32x32x16_bf16 v[16:31], a[104:107], v[96:99], v[16:31]
  ds_read_b128 v[88:91], v3 offset:57344
  s_waitcnt lgkmcnt(3)
  v_mfma_f32_32x32x16_bf16 v[32:47], a[104:107], v[100:103], v[32:47]
  ds_read_b128 v[92:95], v3 offset:58368
  s_waitcnt vmcnt(9) lgkmcnt(3)
  v_mfma_f32_32x32x16_bf16 v[16:31], a[108:111], v[80:83], v[16:31]
  ds_read_b128 v[96:99], v3 offset:59392
  s_waitcnt lgkmcnt(3)
  v_mfma_f32_32x32x16_bf16 v[32:47], a[108:111], v[84:87], v[32:47]
  ds_read_b128 v[100:103], v3 offset:60416
  s_waitcnt vmcnt(7) lgkmcnt(3)
  v_mfma_f32_32x32x16_bf16 v[16:31], a[112:115], v[88:91], v[16:31]
  ds_read_b128 v[80:83], v3 offset:61440
  s_waitcnt lgkmcnt(3)
  v_mfma_f32_32x32x16_bf16 v[32:47], a[112:115], v[92:95], v[32:47]
  ds_read_b128 v[84:87], v3 offset:62464
  s_waitcnt vmcnt(6) lgkmcnt(3)
  v_mfma_f32_32x32x16_bf16 v[16:31], a[116:119], v[96:99], v[16:31]
  ds_read_b128 v[88:91], v3 offset:63488
  v_add_f32 v152, v152, v154
  v_add_f32 v153, v153, v155
  s_waitcnt lgkmcnt(3)
  v_mfma_f32_32x32x16_bf16 v[32:47], a[116:119], v[100:103], v[32:47]
  ds_read_b128 v[92:95], v3 offset:64512
  v_add_f32 v152, v152, v156
  v_add_f32 v153, v153, v157
  v_add_f32 v152, v152, v158
  s_waitcnt vmcnt(5) lgkmcnt(3)
  v_mfma_f32_32x32x16_bf16 v[16:31], a[120:123], v[80:83], v[16:31]
  ds_read_b128 v[96:99], v4 offset:0
  s_add_u32 m0, s57, 110592
  s_add_u32 s58, m0, s56
  buffer_load_dwordx4 v3, s[4:7], s58 offen offset:0 lds
  s_waitcnt lgkmcnt(3)
  v_mfma_f32_32x32x16_bf16 v[32:47], a[120:123], v[84:87], v[32:47]
  ds_read_b128 v[100:103], v4 offset:1024
  buffer_load_dwordx4 v3, s[4:7], s58 offen offset:1024 lds
  s_waitcnt vmcnt(6) lgkmcnt(3)
  v_mfma_f32_32x32x16_bf16 v[16:31], a[124:127], v[88:91], v[16:31]
  ds_read_b128 v[80:83], v4 offset:2048
  buffer_load_dwordx4 v3, s[4:7], s58 offen offset:2048 lds
  s_waitcnt lgkmcnt(3)
  v_mfma_f32_32x32x16_bf16 v[32:47], a[124:127], v[92:95], v[32:47]
  ds_read_b128 v[84:87], v4 offset:3072
  s_add_u32 m0, s57, 122880
  s_add_u32 s58, m0, s56
  buffer_load_dwordx4 v3, s[4:7], s58 offen offset:0 lds
  s_waitcnt vmcnt(7) lgkmcnt(3)
  v_mfma_f32_32x32x16_bf16 v[16:31], a[128:131], v[96:99], v[16:31]
  ds_read_b128 v[88:91], v4 offset:4096
  buffer_load_dwordx4 v3, s[4:7], s58 offen offset:1024 lds
  s_waitcnt lgkmcnt(3)
  v_mfma_f32_32x32x16_bf16 v[32:47], a[128:131], v[100:103], v[32:47]
  ds_read_b128 v[92:95], v4 offset:5120
  buffer_load_dwordx4 v3, s[4:7], s58 offen offset:2048 lds
  s_waitcnt vmcnt(8) lgkmcnt(3)
  v_mfma_f32_32x32x16_bf16 v[16:31], a[132:135], v[80:83], v[16:31]
  ds_read_b128 v[96:99], v4 offset:6144
  s_add_u32 m0, s57, 135168
  s_add_u32 s58, m0, s56
  buffer_load_dwordx4 v3, s[4:7], s58 offen offset:0 lds
  s_waitcnt lgkmcnt(3)
  v_mfma_f32_32x32x16_bf16 v[32:47], a[132:135], v[84:87], v[32:47]
  ds_read_b128 v[100:103], v4 offset:7168
  buffer_load_dwordx4 v3, s[4:7], s58 offen offset:1024 lds
  s_barrier
  s_waitcnt vmcnt(9) lgkmcnt(3)
  v_mfma_f32_32x32x16_bf16 v[16:31], a[136:139], v[88:91], v[16:31]
  ds_read_b128 v[80:83], v4 offset:8192
  buffer_load_dwordx4 v3, s[4:7], s58 offen offset:2048 lds
  s_waitcnt lgkmcnt(3)
  v_mfma_f32_32x32x16_bf16 v[32:47], a[136:139], v[92:95], v[32:47]
  ds_read_b128 v[84:87], v4 offset:9216
  v_add_f32 v153, v153, v159
  v_add_f32 v152, v152, v160
  v_add_f32 v153, v153, v161
  s_waitcnt vmcnt(9) lgkmcnt(3)
  v_mfma_f32_32x32x16_bf16 v[16:31], a[140:143], v[96:99], v[16:31]
  ds_read_b128 v[88:91], v4 offset:10240
  v_add_f32 v152, v152, v162
  v_add_f32 v153, v153, v163
  v_add_f32 v152, v152, v164
  s_waitcnt lgkmcnt(3)
  v_mfma_f32_32x32x16_bf16 v[32:47], a[140:143], v[100:103], v[32:47]
  ds_read_b128 v[92:95], v4 offset:11264
  v_add_f32 v153, v153, v165
  v_add_f32 v152, v152, v166
  v_add_f32 v153, v153, v167
  s_waitcnt lgkmcnt(3)
  v_mfma_f32_32x32x16_bf16 v[48:63], a[0:3], v[80:83], 0
  ds_read_b128 v[96:99], v4 offset:12288
  v_mov_b32 v12, v152
  v_mov_b32 v14, v153
  s_nop 1
  s_waitcnt lgkmcnt(3)
  v_mfma_f32_32x32x16_bf16 v[64:79], a[0:3], v[84:87], 0
  ds_read_b128 v[100:103], v4 offset:13312
  v_permlane32_swap_b32 v12, v152
  v_permlane32_swap_b32 v14, v153
  v_add_f32 v12, v12, v152
  s_waitcnt lgkmcnt(3)
  v_mfma_f32_32x32x16_bf16 v[48:63], a[4:7], v[88:91], v[48:63]
  ds_read_b128 v[80:83], v4 offset:14336
  v_add_f32 v14, v14, v153
  v_mul_f32 v12, 0x3ae38e39, v12
  v_mul_f32 v14, 0x3ae38e39, v14
  s_waitcnt lgkmcnt(3)
  v_mfma_f32_32x32x16_bf16 v[64:79], a[4:7], v[92:95], v[64:79]
  ds_read_b128 v[84:87], v4 offset:15360
  v_fma_f32 v14, -v12, v12, v14
  v_max_f32 v14, 0, v14
  v_add_f32 v14, 0x3727c5ac, v14
  s_waitcnt lgkmcnt(3)
  v_mfma_f32_32x32x16_bf16 v[48:63], a[8:11], v[96:99], v[48:63]
  ds_read_b128 v[88:91], v4 offset:16384
  v_rsq_f32 v12, v14
  s_lshl_b32 s28, s20, 7
  s_add_u32 s28, s28, 147456
  s_waitcnt lgkmcnt(3)
  v_mfma_f32_32x32x16_bf16 v[64:79], a[8:11], v[100:103], v[64:79]
  ds_read_b128 v[92:95], v4 offset:17408
  v_lshl_add_u32 v8, v6, 2, s28
  ds_write_b32 v8, v12
  v_lshl_add_u32 v9, v7, 4, s28
  s_waitcnt lgkmcnt(4)
  v_mfma_f32_32x32x16_bf16 v[48:63], a[12:15], v[80:83], v[48:63]
  ds_read_b128 v[96:99], v4 offset:18432
  ds_read_b128 v[136:139], v9 offset:0
  ds_read_b128 v[140:143], v9 offset:32
  ds_read_b128 v[144:147], v9 offset:64
  s_waitcnt lgkmcnt(7)
  v_mfma_f32_32x32x16_bf16 v[64:79], a[12:15], v[84:87], v[64:79]
  ds_read_b128 v[100:103], v4 offset:19456
  ds_read_b128 v[148:151], v9 offset:96
  v_mul_u32_u24 v7, 9216, v7
  v_lshl_add_u32 v7, v6, 4, v7
  s_waitcnt lgkmcnt(8)
  v_mfma_f32_32x32x16_bf16 v[48:63], a[16:19], v[88:91], v[48:63]
  ds_read_b128 v[80:83], v4 offset:20480
  s_mul_i32 s28, s18, 36864
  s_add_u32 s28, s28, 41933824
  s_lshl_b32 s24, s19, 10
  s_waitcnt lgkmcnt(8)
  v_mfma_f32_32x32x16_bf16 v[64:79], a[16:19], v[92:95], v[64:79]
  ds_read_b128 v[84:87], v4 offset:21504
  s_add_u32 s28, s28, s24
  s_add_u32 s29, s28, 18432
  s_cmp_eq_u32 s19, 13
  s_waitcnt lgkmcnt(7)
  v_mfma_f32_32x32x16_bf16 v[48:63], a[20:23], v[96:99], v[48:63]
  ds_read_b128 v[88:91], v4 offset:22528
  s_cselect_b32 s26, 268435456, s28
  s_cselect_b32 s27, 268435456, s29
  s_waitcnt lgkmcnt(3)
  v_mfma_f32_32x32x16_bf16 v[64:79], a[20:23], v[100:103], v[64:79]
  ds_read_b128 v[92:95], v4 offset:23552
  v_mul_f32 v16, v136, v16
  v_mul_f32 v17, v137, v17
  v_mul_f32 v18, v138, v18
  v_mul_f32 v19, v139, v19
  s_waitcnt lgkmcnt(3)
  v_mfma_f32_32x32x16_bf16 v[48:63], a[24:27], v[80:83], v[48:63]
  ds_read_b128 v[96:99], v4 offset:24576
  v_mul_f32 v20, v140, v20
  v_mul_f32 v21, v141, v21
  v_mul_f32 v22, v142, v22
  s_waitcnt lgkmcnt(3)
  v_mfma_f32_32x32x16_bf16 v[64:79], a[24:27], v[84:87], v[64:79]
  ds_read_b128 v[100:103], v4 offset:25600
  v_mul_f32 v23, v143, v23
  v_cvt_pk_bf16_f32 v104, v16, v17
  v_cvt_pk_bf16_f32 v105, v18, v19
  s_waitcnt lgkmcnt(3)
  v_mfma_f32_32x32x16_bf16 v[48:63], a[28:31], v[88:91], v[48:63]
  ds_read_b128 v[80:83], v4 offset:26624
  v_cvt_pk_bf16_f32 v106, v20, v21
  v_cvt_pk_bf16_f32 v107, v22, v23
  s_waitcnt lgkmcnt(3)
  v_mfma_f32_32x32x16_bf16 v[64:79], a[28:31], v[92:95], v[64:79]
  ds_read_b128 v[84:87], v4 offset:27648
  buffer_store_dwordx4 v[104:107], v7, s[8:11], s28 offen offset:0 sc1
  v_mul_f32 v24, v144, v24
  s_waitcnt lgkmcnt(3)
  v_mfma_f32_32x32x16_bf16 v[48:63], a[32:35], v[96:99], v[48:63]
  ds_read_b128 v[88:91], v4 offset:28672
  v_mul_f32 v25, v145, v25
  v_mul_f32 v26, v146, v26
  v_mul_f32 v27, v147, v27
  s_waitcnt lgkmcnt(3)
  v_mfma_f32_32x32x16_bf16 v[64:79], a[32:35], v[100:103], v[64:79]
  ds_read_b128 v[92:95], v4 offset:29696
  v_mul_f32 v28, v148, v28
  v_mul_f32 v29, v149, v29
  v_mul_f32 v30, v150, v30
  s_waitcnt lgkmcnt(3)
  v_mfma_f32_32x32x16_bf16 v[48:63], a[36:39], v[80:83], v[48:63]
  ds_read_b128 v[96:99], v4 offset:30720
  v_mul_f32 v31, v151, v31
  v_cvt_pk_bf16_f32 v108, v24, v25
  v_cvt_pk_bf16_f32 v109, v26, v27
  s_waitcnt lgkmcnt(3)
  v_mfma_f32_32x32x16_bf16 v[64:79], a[36:39], v[84:87], v[64:79]
  ds_read_b128 v[100:103], v4 offset:31744
  v_cvt_pk_bf16_f32 v110, v28, v29
  v_cvt_pk_bf16_f32 v111, v30, v31
  s_waitcnt lgkmcnt(3)
  v_mfma_f32_32x32x16_bf16 v[48:63], a[40:43], v[88:91], v[48:63]
  ds_read_b128 v[80:83], v4 offset:32768
  buffer_store_dwordx4 v[108:111], v7, s[8:11], s29 offen offset:0 sc1
  v_mul_f32 v32, v136, v32
  s_waitcnt lgkmcnt(3)
  v_mfma_f32_32x32x16_bf16 v[64:79], a[40:43], v[92:95], v[64:79]
  ds_read_b128 v[84:87], v4 offset:33792
  v_mul_f32 v33, v137, v33
  v_mul_f32 v34, v138, v34
  v_mul_f32 v35, v139, v35
  s_waitcnt lgkmcnt(3)
  v_mfma_f32_32x32x16_bf16 v[48:63], a[44:47], v[96:99], v[48:63]
  ds_read_b128 v[88:91], v4 offset:34816
  v_mul_f32 v36, v140, v36
  v_mul_f32 v37, v141, v37
  v_mul_f32 v38, v142, v38
  s_waitcnt lgkmcnt(3)
  v_mfma_f32_32x32x16_bf16 v[64:79], a[44:47], v[100:103], v[64:79]
  ds_read_b128 v[92:95], v4 offset:35840
  v_mul_f32 v39, v143, v39
  v_cvt_pk_bf16_f32 v112, v32, v33
  v_cvt_pk_bf16_f32 v113, v34, v35
  s_waitcnt lgkmcnt(3)
  v_mfma_f32_32x32x16_bf16 v[48:63], a[48:51], v[80:83], v[48:63]
  ds_read_b128 v[96:99], v4 offset:36864
  v_cvt_pk_bf16_f32 v114, v36, v37
  v_cvt_pk_bf16_f32 v115, v38, v39
  s_waitcnt lgkmcnt(3)
  v_mfma_f32_32x32x16_bf16 v[64:79], a[48:51], v[84:87], v[64:79]
  ds_read_b128 v[100:103], v4 offset:37888
  buffer_store_dwordx4 v[112:115], v7, s[8:11], s26 offen offset:512 sc1
  v_mul_f32 v40, v144, v40
  s_waitcnt lgkmcnt(3)
  v_mfma_f32_32x32x16_bf16 v[48:63], a[52:55], v[88:91], v[48:63]
  ds_read_b128 v[80:83], v4 offset:38912
  v_mul_f32 v41, v145, v41
  v_mul_f32 v42, v146, v42
  v_mul_f32 v43, v147, v43
  s_waitcnt lgkmcnt(3)
  v_mfma_f32_32x32x16_bf16 v[64:79], a[52:55], v[92:95], v[64:79]
  ds_read_b128 v[84:87], v4 offset:39936
  v_mul_f32 v44, v148, v44
  v_mul_f32 v45, v149, v45
  v_mul_f32 v46, v150, v46
  s_waitcnt lgkmcnt(3)
  v_mfma_f32_32x32x16_bf16 v[48:63], a[56:59], v[96:99], v[48:63]
  ds_read_b128 v[88:91], v4 offset:40960
  v_mul_f32 v47, v151, v47
  v_cvt_pk_bf16_f32 v116, v40, v41
  v_cvt_pk_bf16_f32 v117, v42, v43
  s_waitcnt lgkmcnt(3)
  v_mfma_f32_32x32x16_bf16 v[64:79], a[56:59], v[100:103], v[64:79]
  ds_read_b128 v[92:95], v4 offset:41984
  v_cvt_pk_bf16_f32 v118, v44, v45
  v_cvt_pk_bf16_f32 v119, v46, v47
  s_waitcnt lgkmcnt(3)
  v_mfma_f32_32x32x16_bf16 v[48:63], a[60:63], v[80:83], v[48:63]
  ds_read_b128 v[96:99], v4 offset:43008
  buffer_store_dwordx4 v[116:119], v7, s[8:11], s27 offen offset:512 sc1
  s_waitcnt lgkmcnt(3)
  v_mfma_f32_32x32x16_bf16 v[64:79], a[60:63], v[84:87], v[64:79]
  ds_read_b128 v[100:103], v4 offset:44032
  s_waitcnt vmcnt(10)
  s_barrier
  s_waitcnt lgkmcnt(3)
  v_mfma_f32_32x32x16_bf16 v[48:63], a[64:67], v[88:91], v[48:63]
  ds_read_b128 v[80:83], v4 offset:45056
  s_waitcnt lgkmcnt(3)
  v_mfma_f32_32x32x16_bf16 v[64:79], a[64:67], v[92:95], v[64:79]
  ds_read_b128 v[84:87], v4 offset:46080
  s_waitcnt lgkmcnt(3)
  v_mfma_f32_32x32x16_bf16 v[48:63], a[68:71], v[96:99], v[48:63]
  ds_read_b128 v[88:91], v4 offset:47104
  s_waitcnt lgkmcnt(3)
  v_mfma_f32_32x32x16_bf16 v[64:79], a[68:71], v[100:103], v[64:79]
  ds_read_b128 v[92:95], v4 offset:48128
  s_waitcnt lgkmcnt(3)
  v_mfma_f32_32x32x16_bf16 v[48:63], a[72:75], v[80:83], v[48:63]
  ds_read_b128 v[96:99], v4 offset:49152
  s_waitcnt lgkmcnt(3)
  v_mfma_f32_32x32x16_bf16 v[64:79], a[72:75], v[84:87], v[64:79]
  ds_read_b128 v[100:103], v4 offset:50176
  s_waitcnt lgkmcnt(3)
  v_mfma_f32_32x32x16_bf16 v[48:63], a[76:79], v[88:91], v[48:63]
  ds_read_b128 v[80:83], v4 offset:51200
  s_waitcnt lgkmcnt(3)
  v_mfma_f32_32x32x16_bf16 v[64:79], a[76:79], v[92:95], v[64:79]
  ds_read_b128 v[84:87], v4 offset:52224
  s_waitcnt lgkmcnt(3)
  v_mfma_f32_32x32x16_bf16 v[48:63], a[80:83], v[96:99], v[48:63]
  ds_read_b128 v[88:91], v4 offset:53248
  s_waitcnt lgkmcnt(3)
  v_mfma_f32_32x32x16_bf16 v[64:79], a[80:83], v[100:103], v[64:79]
  ds_read_b128 v[92:95], v4 offset:54272
  s_waitcnt lgkmcnt(3)
  v_mfma_f32_32x32x16_bf16 v[48:63], a[84:87], v[80:83], v[48:63]
  ds_read_b128 v[96:99], v4 offset:55296
  s_waitcnt lgkmcnt(3)
  v_mfma_f32_32x32x16_bf16 v[64:79], a[84:87], v[84:87], v[64:79]
  ds_read_b128 v[100:103], v4 offset:56320
  v_mov_b32 v10, 1
  v_min_u32 v11, 1, v0
  v_lshlrev_b32 v11, 31, v11
  s_waitcnt vmcnt(0)
  s_barrier
  buffer_store_dword v10, v11, s[8:11], s48 offen sc1
  s_waitcnt lgkmcnt(3)
  v_mfma_f32_32x32x16_bf16 v[48:63], a[88:91], v[88:91], v[48:63]
  ds_read_b128 v[80:83], v4 offset:57344
  s_bfe_u32 s31, s2, 0x40003
  s_waitcnt lgkmcnt(3)
  v_mfma_f32_32x32x16_bf16 v[64:79], a[88:91], v[92:95], v[64:79]
  ds_read_b128 v[84:87], v4 offset:58368
  s_lshr_b32 s33, s2, 7
  s_and_b32 s32, s2, 7
  s_lshl_b32 s32, s32, 1
  s_waitcnt lgkmcnt(3)
  v_mfma_f32_32x32x16_bf16 v[48:63], a[92:95], v[96:99], v[48:63]
  ds_read_b128 v[88:91], v4 offset:59392
  s_add_u32 s32, s32, s33
  s_lshr_b32 s35, s32, 2
  s_mul_i32 s34, s35, 0x1010001
  s_waitcnt lgkmcnt(3)
  v_mfma_f32_32x32x16_bf16 v[64:79], a[92:95], v[100:103], v[64:79]
  ds_read_b128 v[92:95], v4 offset:60416
  s_add_u32 s34, s34, 0x80809984
  s_mul_i32 s36, s32, 18
  s_lshr_b32 s35, s36, 6
  s_waitcnt lgkmcnt(3)
  v_mfma_f32_32x32x16_bf16 v[48:63], a[96:99], v[80:83], v[48:63]
  ds_read_b128 v[96:99], v4 offset:61440
  s_lshl_b32 s35, s35, 8
  s_add_u32 s34, s34, s35
  s_add_u32 s36, s36, 17
  s_waitcnt lgkmcnt(3)
  v_mfma_f32_32x32x16_bf16 v[64:79], a[96:99], v[84:87], v[64:79]
  ds_read_b128 v[100:103], v4 offset:62464
  s_lshr_b32 s36, s36, 6
  s_lshl_b32 s36, s36, 12
  s_add_u32 s34, s34, s36
  s_waitcnt lgkmcnt(3)
  v_mfma_f32_32x32x16_bf16 v[48:63], a[100:103], v[88:91], v[48:63]
  ds_read_b128 v[80:83], v4 offset:63488
  v_bfe_u32 v184, v1, 2, 2
  v_and_b32 v185, 3, v1
  v_cmp_eq_u32 vcc, 3, v184
  s_waitcnt lgkmcnt(3)
  v_mfma_f32_32x32x16_bf16 v[64:79], a[100:103], v[92:95], v[64:79]
  ds_read_b128 v[84:87], v4 offset:64512
  v_min_u32 v184, 2, v184
  v_add_u32 v186, 4, v185
  v_cndmask_b32 v185, v185, v186, vcc
  s_waitcnt lgkmcnt(3)
  v_mfma_f32_32x32x16_bf16 v[48:63], a[104:107], v[96:99], v[48:63]
  ds_read_b128 v[88:91], v5 offset:0
  v_lshlrev_b32 v185, 2, v185
  v_bfe_u32 v185, s34, v185, 4
  s_sub_u32 s35, s31, 2
  s_waitcnt lgkmcnt(3)
  v_mfma_f32_32x32x16_bf16 v[64:79], a[104:107], v[100:103], v[64:79]
  ds_read_b128 v[92:95], v5 offset:1024
  v_add_u32 v184, s35, v184
  v_max_i32 v184, 0, v184
  v_lshl_add_u32 v184, v184, 4, v185
  s_waitcnt lgkmcnt(3)
  v_mfma_f32_32x32x16_bf16 v[48:63], a[108:111], v[80:83], v[48:63]
  ds_read_b128 v[96:99], v5 offset:2048
  v_lshlrev_b32 v184, 6, v184
  s_mov_b32 s40, 83886080
  s_lshl_b32 s34, s31, 2
  s_waitcnt lgkmcnt(3)
  v_mfma_f32_32x32x16_bf16 v[64:79], a[108:111], v[84:87], v[64:79]
  ds_read_b128 v[100:103], v5 offset:3072
  s_add_u32 s33, s34, s20
  v_and_b32 v191, 31, v1
  v_lshrrev_b32 v192, 5, v1
  s_barrier
  s_waitcnt lgkmcnt(3)
  v_mfma_f32_32x32x16_bf16 v[48:63], a[112:115], v[88:91], v[48:63]
  ds_read_b128 v[80:83], v5 offset:4096
  s_mul_i32 s35, s20, 3
  s_waitcnt lgkmcnt(3)
  v_mfma_f32_32x32x16_bf16 v[64:79], a[112:115], v[92:95], v[64:79]
  ds_read_b128 v[84:87], v5 offset:5120
  s_add_u32 s34, s34, s35
  s_sub_u32 s34, s34, 8
  s_lshl_b32 s41, s32, 16
  s_waitcnt lgkmcnt(3)
  v_mfma_f32_32x32x16_bf16 v[48:63], a[116:119], v[96:99], v[48:63]
  ds_read_b128 v[88:91], v5 offset:6144
  s_add_u32 s42, s41, 36700160
  s_add_u32 s41, s41, 38797312
  s_lshl_b32 s35, s33, 10
  s_waitcnt lgkmcnt(3)
  v_mfma_f32_32x32x16_bf16 v[64:79], a[116:119], v[100:103], v[64:79]
  ds_read_b128 v[92:95], v5 offset:7168
  s_add_u32 s42, s42, s35
  s_bfe_u32 s43, s32, 0x10002
  s_lshl_b32 s43, s43, 16
  s_waitcnt lgkmcnt(3)
  v_mfma_f32_32x32x16_bf16 v[48:63], a[120:123], v[80:83], v[48:63]
  ds_read_b128 v[96:99], v5 offset:8192
  s_bfe_u32 s44, s32, 0x10003
  s_lshl_b32 s44, s44, 9
  s_add_u32 s43, s43, s44
  s_waitcnt lgkmcnt(3)
  v_mfma_f32_32x32x16_bf16 v[64:79], a[120:123], v[84:87], v[64:79]
  ds_read_b128 v[100:103], v5 offset:9216
  s_and_b32 s44, s32, 3
  s_lshl_b32 s44, s44, 2
  s_add_u32 s43, s43, s44
  s_waitcnt lgkmcnt(3)
  v_mfma_f32_32x32x16_bf16 v[48:63], a[124:127], v[88:91], v[48:63]
  ds_read_b128 v[80:83], v5 offset:10240
  s_add_u32 s43, s43, 40894464
  s_add_u32 s44, s43, s35
  s_add_u32 s43, s43, 0x20000
  s_waitcnt lgkmcnt(3)
  v_mfma_f32_32x32x16_bf16 v[64:79], a[124:127], v[92:95], v[64:79]
  ds_read_b128 v[84:87], v5 offset:11264
  s_lshl_b32 s35, s34, 10
  v_add_u32 v186, s35, v3
  v_lshlrev_b32 v187, 4, v191
  s_waitcnt lgkmcnt(3)
  v_mfma_f32_32x32x16_bf16 v[48:63], a[128:131], v[96:99], v[48:63]
  ds_read_b128 v[88:91], v5 offset:12288
  v_lshl_add_u32 v188, v192, 10, v187
  v_add_u32 v188, s35, v188
  s_add_u32 s12, s8, 41943040
  s_waitcnt lgkmcnt(3)
  v_mfma_f32_32x32x16_bf16 v[64:79], a[128:131], v[100:103], v[64:79]
  ds_read_b128 v[92:95], v5 offset:13312
  s_addc_u32 s13, s9, 0
  s_mov_b32 s14, 2359360
  s_mov_b32 s15, 0x20000
  s_waitcnt lgkmcnt(3)
  v_mfma_f32_32x32x16_bf16 v[48:63], a[132:135], v[80:83], v[48:63]
  ds_read_b128 v[96:99], v5 offset:14336
  s_mul_i32 s34, s34, 36864
  s_mul_i32 s36, s32, 288
  s_add_u32 s34, s34, s36
  s_waitcnt lgkmcnt(3)
  v_mfma_f32_32x32x16_bf16 v[64:79], a[132:135], v[84:87], v[64:79]
  ds_read_b128 v[100:103], v5 offset:15360
  v_mul_u32_u24 v189, 9216, v192
  v_add_u32 v189, v189, v187
  v_cmp_gt_u32 vcc, 18, v191
  s_waitcnt lgkmcnt(3)
  v_mfma_f32_32x32x16_bf16 v[48:63], a[136:139], v[88:91], v[48:63]
  v_add_u32 v189, s34, v189
  v_mov_b32 v190, 2359296
  v_lshl_or_b32 v187, v192, 31, v187
  v_cndmask_b32 v189, v190, v189, vcc
  s_waitcnt lgkmcnt(2)
  v_mfma_f32_32x32x16_bf16 v[64:79], a[136:139], v[92:95], v[64:79]
  v_mov_b32 v190, 18432
  s_mul_i32 s35, s20, 3072
  v_cndmask_b32 v190, 0, v190, vcc
  s_mul_i32 s37, s20, 384
  s_waitcnt lgkmcnt(1)
  v_mfma_f32_32x32x16_bf16 v[48:63], a[140:143], v[96:99], v[48:63]
  s_add_u32 s37, s37, 24576
  s_mul_i32 s38, s20, 6144
  s_add_u32 s38, s38, 28672
  s_waitcnt lgkmcnt(0)
  v_mfma_f32_32x32x16_bf16 v[64:79], a[140:143], v[100:103], v[64:79]
  buffer_load_dword v185, v184, s[8:11], s40 offen sc1
  s_waitcnt vmcnt(0)
  s_mov_b32 s53, 0
  s_branch p2_evc
p2_evp:
  buffer_load_dword v185, v184, s[8:11], s40 offen sc1
  s_add_u32 s53, s53, 1
  s_waitcnt vmcnt(0)
p2_evc:
  v_cmp_gt_u32 vcc, 1, v185
  s_cmp_gt_u32 s53, 0x8000
  s_cbranch_scc1 p2_evg
  s_cbranch_vccz p2_evg
  s_sleep 2
  s_branch p2_evp
p2_evg:
  s_add_u32 m0, s35, 0
  s_nop 0
  buffer_load_dwordx4 v186, s[8:11], s41 offen sc1 lds
  s_add_u32 m0, s35, 1024
  v_add_u32 v186, 1024, v186
  buffer_load_dwordx4 v186, s[8:11], s41 offen sc1 lds
  s_add_u32 m0, s35, 2048
  v_add_u32 v186, 1024, v186
  buffer_load_dwordx4 v186, s[8:11], s41 offen sc1 lds
  s_add_u32 m0, s37, 0
  s_nop 0
  buffer_load_dword v188, s[8:11], s43 offen sc1 lds
  s_add_u32 m0, s37, 256
  v_add_u32 v188, 2048, v188
  buffer_load_dword v188, s[8:11], s43 offen sc1 lds
  buffer_load_dwordx4 v[124:127], v3, s[8:11], s42 offen sc1
  buffer_load_dword v128, v187, s[8:11], s44 offen sc1
  s_add_u32 m0, s38, 0
  s_nop 0
  buffer_load_dwordx4 v189, s[12:15], 0 offen sc1 lds
  s_add_u32 m0, s38, 1024
  v_add_u32 v189, v189, v190
  buffer_load_dwordx4 v189, s[12:15], 0 offen sc1 lds
  s_add_u32 m0, s38, 2048
  v_add_u32 v189, v189, v190
  buffer_load_dwordx4 v189, s[12:15], 0 offen sc1 lds
  s_add_u32 m0, s38, 3072
  v_add_u32 v189, v189, v190
  buffer_load_dwordx4 v189, s[12:15], 0 offen sc1 lds
  s_add_u32 m0, s38, 4096
  v_add_u32 v189, v189, v190
  buffer_load_dwordx4 v189, s[12:15], 0 offen sc1 lds
  s_add_u32 m0, s38, 5120
  v_add_u32 v189, v189, v190
  buffer_load_dwordx4 v189, s[12:15], 0 offen sc1 lds
  s_nop 7
  s_add_u32 s26, s26, 4608
  s_add_u32 s27, s27, 4608
  s_add_u32 s28, s28, 4608
  s_add_u32 s29, s29, 4608
  v_mul_f32 v48, v136, v48
  v_mul_f32 v49, v137, v49
  v_mul_f32 v50, v138, v50
  v_mul_f32 v51, v139, v51
  v_mul_f32 v52, v140, v52
  v_mul_f32 v53, v141, v53
  v_mul_f32 v54, v142, v54
  v_mul_f32 v55, v143, v55
  v_cvt_pk_bf16_f32 v104, v48, v49
  v_cvt_pk_bf16_f32 v105, v50, v51
  v_cvt_pk_bf16_f32 v106, v52, v53
  v_cvt_pk_bf16_f32 v107, v54, v55
  buffer_store_dwordx4 v[104:107], v7, s[8:11], s28 offen offset:0 sc1
  v_mul_f32 v56, v144, v56
  v_mul_f32 v57, v145, v57
  v_mul_f32 v58, v146, v58
  v_mul_f32 v59, v147, v59
  v_mul_f32 v60, v148, v60
  v_mul_f32 v61, v149, v61
  v_mul_f32 v62, v150, v62
  v_mul_f32 v63, v151, v63
  v_cvt_pk_bf16_f32 v108, v56, v57
  v_cvt_pk_bf16_f32 v109, v58, v59
  v_cvt_pk_bf16_f32 v110, v60, v61
  v_cvt_pk_bf16_f32 v111, v62, v63
  buffer_store_dwordx4 v[108:111], v7, s[8:11], s29 offen offset:0 sc1
  v_mul_f32 v64, v136, v64
  v_mul_f32 v65, v137, v65
  v_mul_f32 v66, v138, v66
  v_mul_f32 v67, v139, v67
  v_mul_f32 v68, v140, v68
  v_mul_f32 v69, v141, v69
  v_mul_f32 v70, v142, v70
  v_mul_f32 v71, v143, v71
  v_cvt_pk_bf16_f32 v112, v64, v65
  v_cvt_pk_bf16_f32 v113, v66, v67
  v_cvt_pk_bf16_f32 v114, v68, v69
  v_cvt_pk_bf16_f32 v115, v70, v71
  buffer_store_dwordx4 v[112:115], v7, s[8:11], s26 offen offset:512 sc1
  v_mul_f32 v72, v144, v72
  v_mul_f32 v73, v145, v73
  v_mul_f32 v74, v146, v74
  v_mul_f32 v75, v147, v75
  v_mul_f32 v76, v148, v76
  v_mul_f32 v77, v149, v77
  v_mul_f32 v78, v150, v78
  v_mul_f32 v79, v151, v79
  v_cvt_pk_bf16_f32 v116, v72, v73
  v_cvt_pk_bf16_f32 v117, v74, v75
  v_cvt_pk_bf16_f32 v118, v76, v77
  v_cvt_pk_bf16_f32 v119, v78, v79
  buffer_store_dwordx4 v[116:119], v7, s[8:11], s27 offen offset:512 sc1
p1_1e:
main_p2:
  s_lshr_b32 s59, s2, 3
  s_lshl_b32 s59, s59, 2
  s_add_u32 s59, s59, s20
  s_cmp_ge_u32 s59, 4
  s_cbranch_scc1 cp_p2_skip
  s_getpc_b64 s[60:61]
cp_p2:
  s_lshl_b32 s62, s59, 13
  s_add_u32 s62, s62, p3_code-cp_p2
  s_add_u32 s60, s60, s62
  s_addc_u32 s61, s61, 0
  v_lshlrev_b32 v250, 7, v1
  v_mov_b32 v251, s61
  v_add_co_u32 v250, vcc, s60, v250
  s_nop 1
  v_addc_co_u32 v251, vcc, 0, v251, vcc
  global_load_dword v252, v[250:251], off
cp_p2_skip:
  v_mov_b32 v2, v184
  v_mov_b32 v7, v185
  v_mov_b32 v9, v186
  v_mov_b32 v10, v187
  v_mov_b32 v11, v188
  v_mov_b32 v14, v189
  v_mov_b32 v15, v190
  v_mov_b32 v4, v191
  v_mov_b32 v5, v192
  s_mov_b32 s18, s31
  s_mov_b32 s19, s32
  s_mov_b32 s25, s33
  s_mov_b32 s47, s48
  v_lshlrev_b32 v243, v4, 2
  v_add_u32 v243, -1, v243
  v_lshlrev_b32 v240, 2, v5
  v_lshrrev_b32 v12, v240, v243
  s_mov_b32 s36, 0xffff
  v_bfe_i32 v136, v12, 0, 1
  v_bfe_i32 v137, v12, 1, 1
  v_bfe_i32 v138, v12, 2, 1
  v_bfe_i32 v139, v12, 3, 1
  v_bfe_i32 v140, v12, 8, 1
  v_bfe_i32 v141, v12, 9, 1
  v_bfe_i32 v142, v12, 10, 1
  v_bfe_i32 v143, v12, 11, 1
  v_bfe_i32 v144, v12, 16, 1
  v_bfe_i32 v145, v12, 17, 1
  v_bfe_i32 v146, v12, 18, 1
  v_bfe_i32 v147, v12, 19, 1
  v_bfe_i32 v148, v12, 24, 1
  v_bfe_i32 v149, v12, 25, 1
  v_bfe_i32 v150, v12, 26, 1
  v_bfe_i32 v151, v12, 27, 1
  v_bfi_b32 v216, s36, v136, v137
  v_bfi_b32 v217, s36, v138, v139
  v_bfi_b32 v218, s36, v140, v141
  v_bfi_b32 v219, s36, v142, v143
  v_bfi_b32 v220, s36, v144, v145
  v_bfi_b32 v221, s36, v146, v147
  v_bfi_b32 v222, s36, v148, v149
  v_bfi_b32 v223, s36, v150, v151
  v_sub_u32 v240, 1, v5
  v_mul_u32_u24 v129, 0x3f80, v240
  v_mov_b32 v135, v129
  s_cmp_lt_u32 s25, 8
  s_cselect_b32 s36, 0xfe80, 0
  v_mov_b32 v53, s36
  v_mov_b32 v107, s36
  s_cmp_lt_u32 s25, 7
  s_cselect_b32 s36, 0xfe80, 0
  v_mov_b32 v55, s36
  v_mov_b32 v109, s36
  s_cmp_lt_u32 s25, 6
  s_cselect_b32 s36, 0xfe80, 0
  v_mov_b32 v57, s36
  v_mov_b32 v111, s36
  s_cmp_lt_u32 s25, 5
  s_cselect_b32 s36, 0xfe80, 0
  v_mov_b32 v59, s36
  v_mov_b32 v113, s36
  s_cmp_lt_u32 s25, 4
  s_cselect_b32 s36, 0xfe80, 0
  v_mov_b32 v61, s36
  v_mov_b32 v115, s36
  s_cmp_lt_u32 s25, 3
  s_cselect_b32 s36, 0xfe80, 0
  v_mov_b32 v63, s36
  v_mov_b32 v117, s36
  s_cmp_lt_u32 s25, 2
  s_cselect_b32 s36, 0xfe80, 0
  v_mov_b32 v65, s36
  v_mov_b32 v119, s36
  s_cmp_lt_u32 s25, 1
  s_cselect_b32 s36, 0xfe80, 0
  v_mov_b32 v67, s36
  v_mov_b32 v121, s36
  s_cmp_lt_u32 s25, 0
  s_cselect_b32 s36, 0xfe80, 0
  v_mov_b32 v69, s36
  v_mov_b32 v123, s36
  v_mov_b32 v184, 0
  v_mov_b32 v185, 0
  v_mov_b32 v186, 0
  v_mov_b32 v187, 0
  v_mov_b32 v188, 0
  v_mov_b32 v189, 0
  v_mov_b32 v190, 0
  v_mov_b32 v191, 0
  v_mov_b32 v192, 0
  v_mov_b32 v193, 0
  v_mov_b32 v194, 0
  v_mov_b32 v195, 0
  v_mov_b32 v196, 0
  v_mov_b32 v197, 0
  v_mov_b32 v198, 0
  v_mov_b32 v199, 0
  v_mov_b32 v200, 0
  v_mov_b32 v201, 0
  v_mov_b32 v202, 0
  v_mov_b32 v203, 0
  v_mov_b32 v204, 0
  v_mov_b32 v205, 0
  v_mov_b32 v206, 0
  v_mov_b32 v207, 0
  v_mov_b32 v208, 0
  v_mov_b32 v209, 0
  v_mov_b32 v210, 0
  v_mov_b32 v211, 0
  v_mov_b32 v212, 0
  v_mov_b32 v213, 0
  v_mov_b32 v214, 0
  v_mov_b32 v215, 0
  s_lshl_b32 s36, s20, 10
  v_add_u32 v6, s36, v3
  s_lshl_b32 s36, s20, 7
  s_add_u32 s36, s36, 24576
  v_lshl_add_u32 v13, v4, 2, s36
  s_mov_b32 s39, 0x45610000
  s_mul_i32 s26, s25, 36864
  s_add_u32 s26, s26, 45088768
  s_lshl_b32 s27, s19, 10
  s_add_u32 s26, s26, s27
  s_add_u32 s27, s26, 16384
  s_lshl_b32 s28, s19, 14
  s_lshl_b32 s29, s25, 8
  s_add_u32 s28, s28, s29
  s_add_u32 s28, s28, 41418752
  s_lshl_b32 s48, s18, 4
  s_add_u32 s48, s48, s19
  s_lshl_b32 s48, s48, 6
  s_add_u32 s48, s48, 83902464
  v_lshlrev_b32 v8, 4, v4
  v_lshl_add_u32 v8, v5, 9, v8
  s_lshl_b32 s36, s20, 11
  s_add_u32 s36, s36, 28672
  v_add_u32 v4, s36, v8
  s_waitcnt vmcnt(10)
  v_dot2_f32_bf16 v177, v128, v128, 0
  v_dot2_f32_bf16 v177, v124, v124, v177
  v_dot2_f32_bf16 v177, v125, v125, v177
  v_dot2_f32_bf16 v177, v126, v126, v177
  v_dot2_f32_bf16 v177, v127, v127, v177
  s_barrier
  ds_read_b128 v[16:19], v6 offset:0
  ds_read_b32 v52, v13 offset:0
  ds_read_b128 v[20:23], v6 offset:1024
  ds_read_b32 v54, v13 offset:128
  ds_read_b128 v[24:27], v6 offset:2048
  ds_read_b32 v56, v13 offset:256
  ds_read_b128 v[28:31], v6 offset:3072
  ds_read_b32 v58, v13 offset:384
  ds_read_b128 v[32:35], v6 offset:4096
  ds_read_b32 v60, v13 offset:512
  v_mov_b32 v178, v177
  s_nop 1
  v_permlane32_swap_b32 v178, v177
  v_add_f32 v177, v177, v178
  s_waitcnt lgkmcnt(8)
  v_dot2_f32_bf16 v168, v52, v52, 0
  ds_read_b128 v[36:39], v6 offset:5120
  ds_read_b32 v62, v13 offset:640
  v_dot2_f32_bf16 v168, v16, v16, v168
  v_dot2_f32_bf16 v168, v17, v17, v168
  v_dot2_f32_bf16 v168, v18, v18, v168
  v_dot2_f32_bf16 v168, v19, v19, v168
  s_waitcnt lgkmcnt(8)
  v_dot2_f32_bf16 v169, v54, v54, 0
  ds_read_b128 v[40:43], v6 offset:6144
  ds_read_b32 v64, v13 offset:768
  v_dot2_f32_bf16 v169, v20, v20, v169
  v_dot2_f32_bf16 v169, v21, v21, v169
  v_dot2_f32_bf16 v169, v22, v22, v169
  v_dot2_f32_bf16 v169, v23, v23, v169
  s_waitcnt lgkmcnt(8)
  v_dot2_f32_bf16 v170, v56, v56, 0
  ds_read_b128 v[44:47], v6 offset:7168
  ds_read_b32 v66, v13 offset:896
  v_dot2_f32_bf16 v170, v24, v24, v170
  v_dot2_f32_bf16 v170, v25, v25, v170
  v_dot2_f32_bf16 v170, v26, v26, v170
  v_dot2_f32_bf16 v170, v27, v27, v170
  s_waitcnt lgkmcnt(8)
  v_dot2_f32_bf16 v171, v58, v58, 0
  ds_read_b128 v[48:51], v6 offset:8192
  ds_read_b32 v68, v13 offset:1024
  v_dot2_f32_bf16 v171, v28, v28, v171
  v_dot2_f32_bf16 v171, v29, v29, v171
  v_dot2_f32_bf16 v171, v30, v30, v171
  v_dot2_f32_bf16 v171, v31, v31, v171
  s_waitcnt lgkmcnt(8)
  v_dot2_f32_bf16 v172, v60, v60, 0
  v_dot2_f32_bf16 v172, v32, v32, v172
  v_dot2_f32_bf16 v172, v33, v33, v172
  v_dot2_f32_bf16 v172, v34, v34, v172
  v_dot2_f32_bf16 v172, v35, v35, v172
  s_waitcnt lgkmcnt(6)
  v_dot2_f32_bf16 v173, v62, v62, 0
  v_dot2_f32_bf16 v173, v36, v36, v173
  v_dot2_f32_bf16 v173, v37, v37, v173
  v_dot2_f32_bf16 v173, v38, v38, v173
  v_dot2_f32_bf16 v173, v39, v39, v173
  s_waitcnt lgkmcnt(4)
  v_dot2_f32_bf16 v174, v64, v64, 0
  v_dot2_f32_bf16 v174, v40, v40, v174
  v_dot2_f32_bf16 v174, v41, v41, v174
  v_dot2_f32_bf16 v174, v42, v42, v174
  v_dot2_f32_bf16 v174, v43, v43, v174
  s_waitcnt lgkmcnt(2)
  v_dot2_f32_bf16 v175, v66, v66, 0
  v_dot2_f32_bf16 v175, v44, v44, v175
  v_dot2_f32_bf16 v175, v45, v45, v175
  v_dot2_f32_bf16 v175, v46, v46, v175
  v_dot2_f32_bf16 v175, v47, v47, v175
  s_waitcnt lgkmcnt(0)
  v_dot2_f32_bf16 v176, v68, v68, 0
  v_dot2_f32_bf16 v176, v48, v48, v176
  v_dot2_f32_bf16 v176, v49, v49, v176
  v_dot2_f32_bf16 v176, v50, v50, v176
  v_dot2_f32_bf16 v176, v51, v51, v176
  v_max3_f32 v168, v168, v169, v170
  v_max3_f32 v171, v171, v172, v173
  s_nop 0
  v_max3_f32 v174, v174, v175, v176
  v_max3_f32 v168, v168, v171, v174
  s_nop 1
  v_max_f32_dpp v168, v168, v168 row_ror:1 row_mask:0xf bank_mask:0xf
  s_nop 1
  v_max_f32_dpp v168, v168, v168 row_ror:2 row_mask:0xf bank_mask:0xf
  s_nop 1
  v_max_f32_dpp v168, v168, v168 row_ror:4 row_mask:0xf bank_mask:0xf
  s_nop 1
  v_max_f32_dpp v168, v168, v168 row_ror:8 row_mask:0xf bank_mask:0xf
  v_mov_b32 v169, v168
  s_nop 1
  v_permlane16_swap_b32 v169, v168
  v_max_f32 v168, v168, v169
  v_mov_b32 v169, v168
  s_nop 1
  v_permlane32_swap_b32 v169, v168
  v_add_f32 v168, v168, v169
  v_mul_f32 v168, v168, v177
  v_cmp_nge_f32 vcc, s39, v168
  s_nop 1
  s_cbranch_vccz p2_go0
  v_not_b32 v240, v12
  v_bfe_i32 v136, v12, 0, 1
  v_bfe_i32 v184, v240, 0, 1
  v_bfe_i32 v137, v12, 1, 1
  v_bfe_i32 v185, v240, 1, 1
  v_bfe_i32 v138, v12, 2, 1
  v_bfe_i32 v186, v240, 2, 1
  v_bfe_i32 v139, v12, 3, 1
  v_bfe_i32 v187, v240, 3, 1
  v_bfe_i32 v140, v12, 8, 1
  v_bfe_i32 v188, v240, 8, 1
  v_bfe_i32 v141, v12, 9, 1
  v_bfe_i32 v189, v240, 9, 1
  v_bfe_i32 v142, v12, 10, 1
  v_bfe_i32 v190, v240, 10, 1
  v_bfe_i32 v143, v12, 11, 1
  v_bfe_i32 v191, v240, 11, 1
  v_bfe_i32 v144, v12, 16, 1
  v_bfe_i32 v192, v240, 16, 1
  v_bfe_i32 v145, v12, 17, 1
  v_bfe_i32 v193, v240, 17, 1
  v_bfe_i32 v146, v12, 18, 1
  v_bfe_i32 v194, v240, 18, 1
  v_bfe_i32 v147, v12, 19, 1
  v_bfe_i32 v195, v240, 19, 1
  v_bfe_i32 v148, v12, 24, 1
  v_bfe_i32 v196, v240, 24, 1
  v_bfe_i32 v149, v12, 25, 1
  v_bfe_i32 v197, v240, 25, 1
  v_bfe_i32 v150, v12, 26, 1
  v_bfe_i32 v198, v240, 26, 1
  v_bfe_i32 v151, v12, 27, 1
  v_bfe_i32 v199, v240, 27, 1
  v_mov_b32 v240, 4269801472
  v_mov_b32 v241, 4269801472
  v_mfma_f32_32x32x16_bf16 v[136:151], v[16:19], v[124:127], v[136:151]
  v_mfma_f32_32x32x8_bf16 v[136:151], v[52:53], v[128:129], v[136:151]
  v_mfma_f32_32x32x16_bf16 v[152:167], v[20:23], v[124:127], 0
  v_mfma_f32_32x32x8_bf16 v[152:167], v[54:55], v[128:129], v[152:167]
  v_mfma_f32_32x32x16_bf16 v[168:183], v[24:27], v[124:127], 0
  v_mfma_f32_32x32x8_bf16 v[168:183], v[56:57], v[128:129], v[168:183]
  s_nop 7
  v_max3_f32 v240, v240, v136, v137
  v_max3_f32 v241, v241, v138, v139
  v_max3_f32 v240, v240, v140, v141
  v_max3_f32 v241, v241, v142, v143
  v_max3_f32 v240, v240, v144, v145
  v_max3_f32 v241, v241, v146, v147
  v_max3_f32 v240, v240, v148, v149
  v_max3_f32 v241, v241, v150, v151
  v_mfma_f32_32x32x16_bf16 v[136:151], v[28:31], v[124:127], 0
  v_mfma_f32_32x32x8_bf16 v[136:151], v[58:59], v[128:129], v[136:151]
  v_max3_f32 v240, v240, v152, v153
  v_max3_f32 v241, v241, v154, v155
  v_max3_f32 v240, v240, v156, v157
  v_max3_f32 v241, v241, v158, v159
  v_max3_f32 v240, v240, v160, v161
  v_max3_f32 v241, v241, v162, v163
  v_max3_f32 v240, v240, v164, v165
  v_max3_f32 v241, v241, v166, v167
  v_mfma_f32_32x32x16_bf16 v[152:167], v[32:35], v[124:127], 0
  v_mfma_f32_32x32x8_bf16 v[152:167], v[60:61], v[128:129], v[152:167]
  v_max3_f32 v240, v240, v168, v169
  v_max3_f32 v241, v241, v170, v171
  v_max3_f32 v240, v240, v172, v173
  v_max3_f32 v241, v241, v174, v175
  v_max3_f32 v240, v240, v176, v177
  v_max3_f32 v241, v241, v178, v179
  v_max3_f32 v240, v240, v180, v181
  v_max3_f32 v241, v241, v182, v183
  v_mfma_f32_32x32x16_bf16 v[168:183], v[36:39], v[124:127], 0
  v_mfma_f32_32x32x8_bf16 v[168:183], v[62:63], v[128:129], v[168:183]
  v_max3_f32 v240, v240, v136, v137
  v_max3_f32 v241, v241, v138, v139
  v_max3_f32 v240, v240, v140, v141
  v_max3_f32 v241, v241, v142, v143
  v_max3_f32 v240, v240, v144, v145
  v_max3_f32 v241, v241, v146, v147
  v_max3_f32 v240, v240, v148, v149
  v_max3_f32 v241, v241, v150, v151
  v_mfma_f32_32x32x16_bf16 v[136:151], v[40:43], v[124:127], 0
  v_mfma_f32_32x32x8_bf16 v[136:151], v[64:65], v[128:129], v[136:151]
  v_max3_f32 v240, v240, v152, v153
  v_max3_f32 v241, v241, v154, v155
  v_max3_f32 v240, v240, v156, v157
  v_max3_f32 v241, v241, v158, v159
  v_max3_f32 v240, v240, v160, v161
  v_max3_f32 v241, v241, v162, v163
  v_max3_f32 v240, v240, v164, v165
  v_max3_f32 v241, v241, v166, v167
  v_mfma_f32_32x32x16_bf16 v[152:167], v[44:47], v[124:127], 0
  v_mfma_f32_32x32x8_bf16 v[152:167], v[66:67], v[128:129], v[152:167]
  v_max3_f32 v240, v240, v168, v169
  v_max3_f32 v241, v241, v170, v171
  v_max3_f32 v240, v240, v172, v173
  v_max3_f32 v241, v241, v174, v175
  v_max3_f32 v240, v240, v176, v177
  v_max3_f32 v241, v241, v178, v179
  v_max3_f32 v240, v240, v180, v181
  v_max3_f32 v241, v241, v182, v183
  v_mfma_f32_32x32x16_bf16 v[168:183], v[48:51], v[124:127], v[184:199]
  v_mfma_f32_32x32x8_bf16 v[168:183], v[68:69], v[128:129], v[168:183]
  v_max3_f32 v240, v240, v136, v137
  v_max3_f32 v241, v241, v138, v139
  v_max3_f32 v240, v240, v140, v141
  v_max3_f32 v241, v241, v142, v143
  v_max3_f32 v240, v240, v144, v145
  v_max3_f32 v241, v241, v146, v147
  v_max3_f32 v240, v240, v148, v149
  v_max3_f32 v241, v241, v150, v151
  s_nop 1
  v_max3_f32 v240, v240, v152, v153
  v_max3_f32 v241, v241, v154, v155
  v_max3_f32 v240, v240, v156, v157
  v_max3_f32 v241, v241, v158, v159
  v_max3_f32 v240, v240, v160, v161
  v_max3_f32 v241, v241, v162, v163
  v_max3_f32 v240, v240, v164, v165
  v_max3_f32 v241, v241, v166, v167
  s_nop 1
  v_max3_f32 v240, v240, v168, v169
  v_max3_f32 v241, v241, v170, v171
  v_max3_f32 v240, v240, v172, v173
  v_max3_f32 v241, v241, v174, v175
  v_max3_f32 v240, v240, v176, v177
  v_max3_f32 v241, v241, v178, v179
  v_max3_f32 v240, v240, v180, v181
  v_max3_f32 v241, v241, v182, v183
  v_max_f32 v240, v240, v241
  v_mov_b32 v241, v240
  s_nop 1
  v_permlane32_swap_b32 v241, v240
  v_max_f32 v240, v240, v241
  v_mul_f32 v184, -1.0, v240
  v_mul_f32 v185, -1.0, v240
  v_mul_f32 v186, -1.0, v240
  v_mul_f32 v187, -1.0, v240
  v_mul_f32 v188, -1.0, v240
  v_mul_f32 v189, -1.0, v240
  v_mul_f32 v190, -1.0, v240
  v_mul_f32 v191, -1.0, v240
  v_mul_f32 v192, -1.0, v240
  v_mul_f32 v193, -1.0, v240
  v_mul_f32 v194, -1.0, v240
  v_mul_f32 v195, -1.0, v240
  v_mul_f32 v196, -1.0, v240
  v_mul_f32 v197, -1.0, v240
  v_mul_f32 v198, -1.0, v240
  v_mul_f32 v199, -1.0, v240
  s_nop 1
p2_go0:
  v_mfma_f32_32x32x16_bf16 v[136:151], v[16:19], v[124:127], v[184:199]
  v_mfma_f32_32x32x8_bf16 v[136:151], v[52:53], v[128:129], v[136:151]
  s_nop 10
  v_mfma_f32_32x32x16_bf16 v[152:167], v[20:23], v[124:127], v[184:199]
  v_exp_f32 v136, v136
  v_exp_f32 v137, v137
  v_exp_f32 v138, v138
  v_exp_f32 v139, v139
  v_cvt_pk_bf16_f32 v224, v136, v137
  v_cvt_pk_bf16_f32 v225, v138, v139
  v_bfi_b32 v224, v216, 0, v224
  v_bfi_b32 v225, v217, 0, v225
  v_exp_f32 v140, v140
  v_exp_f32 v141, v141
  v_exp_f32 v142, v142
  v_exp_f32 v143, v143
  v_cvt_pk_bf16_f32 v226, v140, v141
  v_cvt_pk_bf16_f32 v227, v142, v143
  v_bfi_b32 v226, v218, 0, v226
  v_bfi_b32 v227, v219, 0, v227
  v_mfma_f32_32x32x8_bf16 v[152:167], v[54:55], v[128:129], v[152:167]
  v_exp_f32 v144, v144
  v_exp_f32 v145, v145
  v_exp_f32 v146, v146
  v_exp_f32 v147, v147
  v_cvt_pk_bf16_f32 v228, v144, v145
  v_cvt_pk_bf16_f32 v229, v146, v147
  v_bfi_b32 v228, v220, 0, v228
  v_bfi_b32 v229, v221, 0, v229
  v_exp_f32 v148, v148
  v_exp_f32 v149, v149
  v_exp_f32 v150, v150
  v_exp_f32 v151, v151
  v_cvt_pk_bf16_f32 v230, v148, v149
  v_cvt_pk_bf16_f32 v231, v150, v151
  v_bfi_b32 v230, v222, 0, v230
  v_bfi_b32 v231, v223, 0, v231
  v_mov_b32 v8, 2
  v_min_u32 v240, 1, v0
  v_lshlrev_b32 v240, 31, v240
  s_cmp_lt_u32 s2, 224
  s_cselect_b32 s47, s47, 268435456
  s_waitcnt vmcnt(0)
  s_barrier
  buffer_store_dword v8, v240, s[8:11], s47 offen sc1
  ds_read_b128 v[240:243], v4 offset:0
  ds_read_b128 v[244:247], v4 offset:1024
  ds_read_b128 v[248:251], v4 offset:2048
  ds_read_b128 v[252:255], v4 offset:3072
  v_mfma_f32_32x32x16_bf16 v[136:151], v[24:27], v[124:127], v[184:199]
  v_exp_f32 v152, v152
  v_exp_f32 v153, v153
  v_exp_f32 v154, v154
  v_exp_f32 v155, v155
  v_cvt_pk_bf16_f32 v232, v152, v153
  v_cvt_pk_bf16_f32 v233, v154, v155
  v_mfma_f32_32x32x8_bf16 v[136:151], v[56:57], v[128:129], v[136:151]
  v_exp_f32 v156, v156
  v_exp_f32 v157, v157
  v_exp_f32 v158, v158
  v_exp_f32 v159, v159
  v_cvt_pk_bf16_f32 v234, v156, v157
  v_cvt_pk_bf16_f32 v235, v158, v159
  s_waitcnt lgkmcnt(2)
  v_mfma_f32_32x32x16_bf16 a[0:15], v[240:243], v[224:227], 0
  v_exp_f32 v160, v160
  v_exp_f32 v161, v161
  v_exp_f32 v162, v162
  v_exp_f32 v163, v163
  v_cvt_pk_bf16_f32 v236, v160, v161
  v_cvt_pk_bf16_f32 v237, v162, v163
  v_mfma_f32_32x32x16_bf16 a[0:15], v[244:247], v[228:231], a[0:15]
  v_exp_f32 v164, v164
  v_exp_f32 v165, v165
  v_exp_f32 v166, v166
  v_exp_f32 v167, v167
  v_cvt_pk_bf16_f32 v238, v164, v165
  v_cvt_pk_bf16_f32 v239, v166, v167
  ds_read_b128 v[240:243], v4 offset:4096
  ds_read_b128 v[244:247], v4 offset:5120
  v_mfma_f32_32x32x16_bf16 v[152:167], v[28:31], v[124:127], v[184:199]
  v_exp_f32 v136, v136
  v_exp_f32 v137, v137
  v_exp_f32 v138, v138
  v_exp_f32 v139, v139
  v_cvt_pk_bf16_f32 v224, v136, v137
  v_cvt_pk_bf16_f32 v225, v138, v139
  v_mfma_f32_32x32x8_bf16 v[152:167], v[58:59], v[128:129], v[152:167]
  v_exp_f32 v140, v140
  v_exp_f32 v141, v141
  v_exp_f32 v142, v142
  v_exp_f32 v143, v143
  v_cvt_pk_bf16_f32 v226, v140, v141
  v_cvt_pk_bf16_f32 v227, v142, v143
  s_waitcnt lgkmcnt(2)
  v_mfma_f32_32x32x16_bf16 a[0:15], v[248:251], v[232:235], a[0:15]
  v_exp_f32 v144, v144
  v_exp_f32 v145, v145
  v_exp_f32 v146, v146
  v_exp_f32 v147, v147
  v_cvt_pk_bf16_f32 v228, v144, v145
  v_cvt_pk_bf16_f32 v229, v146, v147
  v_mfma_f32_32x32x16_bf16 a[0:15], v[252:255], v[236:239], a[0:15]
  v_exp_f32 v148, v148
  v_exp_f32 v149, v149
  v_exp_f32 v150, v150
  v_exp_f32 v151, v151
  v_cvt_pk_bf16_f32 v230, v148, v149
  v_cvt_pk_bf16_f32 v231, v150, v151
  ds_read_b128 v[248:251], v4 offset:6144
  ds_read_b128 v[252:255], v4 offset:7168
  s_cmp_lg_u32 s20, 0
  s_cbranch_scc1 p2_l0
  buffer_load_dword v7, v2, s[8:11], s40 offen sc1
p2_l0:
  v_mfma_f32_32x32x16_bf16 v[136:151], v[32:35], v[124:127], v[184:199]
  v_exp_f32 v152, v152
  v_exp_f32 v153, v153
  v_exp_f32 v154, v154
  v_exp_f32 v155, v155
  v_cvt_pk_bf16_f32 v232, v152, v153
  v_cvt_pk_bf16_f32 v233, v154, v155
  v_mfma_f32_32x32x8_bf16 v[136:151], v[60:61], v[128:129], v[136:151]
  v_exp_f32 v156, v156
  v_exp_f32 v157, v157
  v_exp_f32 v158, v158
  v_exp_f32 v159, v159
  v_cvt_pk_bf16_f32 v234, v156, v157
  v_cvt_pk_bf16_f32 v235, v158, v159
  s_waitcnt lgkmcnt(2)
  v_mfma_f32_32x32x16_bf16 a[0:15], v[240:243], v[224:227], a[0:15]
  v_exp_f32 v160, v160
  v_exp_f32 v161, v161
  v_exp_f32 v162, v162
  v_exp_f32 v163, v163
  v_cvt_pk_bf16_f32 v236, v160, v161
  v_cvt_pk_bf16_f32 v237, v162, v163
  v_mfma_f32_32x32x16_bf16 a[0:15], v[244:247], v[228:231], a[0:15]
  v_exp_f32 v164, v164
  v_exp_f32 v165, v165
  v_exp_f32 v166, v166
  v_exp_f32 v167, v167
  v_cvt_pk_bf16_f32 v238, v164, v165
  v_cvt_pk_bf16_f32 v239, v166, v167
  ds_read_b128 v[240:243], v4 offset:8192
  ds_read_b128 v[244:247], v4 offset:9216
  v_mfma_f32_32x32x16_bf16 v[152:167], v[36:39], v[124:127], v[184:199]
  v_exp_f32 v136, v136
  v_exp_f32 v137, v137
  v_exp_f32 v138, v138
  v_exp_f32 v139, v139
  v_cvt_pk_bf16_f32 v224, v136, v137
  v_cvt_pk_bf16_f32 v225, v138, v139
  v_mfma_f32_32x32x8_bf16 v[152:167], v[62:63], v[128:129], v[152:167]
  v_exp_f32 v140, v140
  v_exp_f32 v141, v141
  v_exp_f32 v142, v142
  v_exp_f32 v143, v143
  v_cvt_pk_bf16_f32 v226, v140, v141
  v_cvt_pk_bf16_f32 v227, v142, v143
  s_waitcnt lgkmcnt(2)
  v_mfma_f32_32x32x16_bf16 a[0:15], v[248:251], v[232:235], a[0:15]
  v_exp_f32 v144, v144
  v_exp_f32 v145, v145
  v_exp_f32 v146, v146
  v_exp_f32 v147, v147
  v_cvt_pk_bf16_f32 v228, v144, v145
  v_cvt_pk_bf16_f32 v229, v146, v147
  v_mfma_f32_32x32x16_bf16 a[0:15], v[252:255], v[236:239], a[0:15]
  v_exp_f32 v148, v148
  v_exp_f32 v149, v149
  v_exp_f32 v150, v150
  v_exp_f32 v151, v151
  v_cvt_pk_bf16_f32 v230, v148, v149
  v_cvt_pk_bf16_f32 v231, v150, v151
  ds_read_b128 v[248:251], v4 offset:10240
  ds_read_b128 v[252:255], v4 offset:11264
  s_cmp_lg_u32 s20, 0
  s_cbranch_scc1 p2_lg
  s_waitcnt vmcnt(0)
  s_mov_b32 s53, 0
  s_branch p2_lc
p2_lp:
  buffer_load_dword v7, v2, s[8:11], s40 offen sc1
  s_add_u32 s53, s53, 1
  s_waitcnt vmcnt(0)
p2_lc:
  v_cmp_gt_u32 vcc, 2, v7
  s_cmp_gt_u32 s53, 0x8000
  s_cbranch_scc1 p2_lg
  s_cbranch_vccz p2_lg
  s_sleep 2
  s_branch p2_lp
p2_lg:
  s_barrier
  v_mfma_f32_32x32x16_bf16 v[136:151], v[40:43], v[124:127], v[184:199]
  s_add_u32 s41, s41, 0x100000
  v_add_u32 v9, -2048, v9
  s_add_u32 m0, s35, 12288
  s_nop 0
  buffer_load_dwordx4 v9, s[8:11], s41 offen sc1 lds
  v_exp_f32 v152, v152
  v_exp_f32 v153, v153
  v_exp_f32 v154, v154
  v_exp_f32 v155, v155
  v_cvt_pk_bf16_f32 v232, v152, v153
  v_cvt_pk_bf16_f32 v233, v154, v155
  v_mfma_f32_32x32x8_bf16 v[136:151], v[64:65], v[128:129], v[136:151]
  s_add_u32 m0, s35, 13312
  v_add_u32 v9, 1024, v9
  buffer_load_dwordx4 v9, s[8:11], s41 offen sc1 lds
  v_exp_f32 v156, v156
  v_exp_f32 v157, v157
  v_exp_f32 v158, v158
  v_exp_f32 v159, v159
  v_cvt_pk_bf16_f32 v234, v156, v157
  v_cvt_pk_bf16_f32 v235, v158, v159
  s_waitcnt lgkmcnt(2)
  v_mfma_f32_32x32x16_bf16 a[0:15], v[240:243], v[224:227], a[0:15]
  s_add_u32 m0, s35, 14336
  v_add_u32 v9, 1024, v9
  buffer_load_dwordx4 v9, s[8:11], s41 offen sc1 lds
  v_exp_f32 v160, v160
  v_exp_f32 v161, v161
  v_exp_f32 v162, v162
  v_exp_f32 v163, v163
  v_cvt_pk_bf16_f32 v236, v160, v161
  v_cvt_pk_bf16_f32 v237, v162, v163
  v_mfma_f32_32x32x16_bf16 a[0:15], v[244:247], v[228:231], a[0:15]
  s_add_u32 s43, s43, 0x40000
  s_add_u32 m0, s37, 2048
  v_add_u32 v11, -2048, v11
  buffer_load_dword v11, s[8:11], s43 offen sc1 lds
  v_exp_f32 v164, v164
  v_exp_f32 v165, v165
  v_exp_f32 v166, v166
  v_exp_f32 v167, v167
  v_cvt_pk_bf16_f32 v238, v164, v165
  v_cvt_pk_bf16_f32 v239, v166, v167
  ds_read_b128 v[240:243], v4 offset:12288
  ds_read_b128 v[244:247], v4 offset:13312
  v_mfma_f32_32x32x16_bf16 v[152:167], v[44:47], v[124:127], v[184:199]
  s_add_u32 m0, s37, 2304
  v_add_u32 v11, 2048, v11
  buffer_load_dword v11, s[8:11], s43 offen sc1 lds
  v_exp_f32 v136, v136
  v_exp_f32 v137, v137
  v_exp_f32 v138, v138
  v_exp_f32 v139, v139
  v_cvt_pk_bf16_f32 v224, v136, v137
  v_cvt_pk_bf16_f32 v225, v138, v139
  v_mfma_f32_32x32x8_bf16 v[152:167], v[66:67], v[128:129], v[152:167]
  s_add_u32 s42, s42, 0x100000
  s_add_u32 s44, s44, 0x40000
  buffer_load_dwordx4 v[130:133], v3, s[8:11], s42 offen sc1
  v_exp_f32 v140, v140
  v_exp_f32 v141, v141
  v_exp_f32 v142, v142
  v_exp_f32 v143, v143
  v_cvt_pk_bf16_f32 v226, v140, v141
  v_cvt_pk_bf16_f32 v227, v142, v143
  s_waitcnt lgkmcnt(2)
  v_mfma_f32_32x32x16_bf16 a[0:15], v[248:251], v[232:235], a[0:15]
  buffer_load_dword v134, v10, s[8:11], s44 offen sc1
  v_exp_f32 v144, v144
  v_exp_f32 v145, v145
  v_exp_f32 v146, v146
  v_exp_f32 v147, v147
  v_cvt_pk_bf16_f32 v228, v144, v145
  v_cvt_pk_bf16_f32 v229, v146, v147
  v_mfma_f32_32x32x16_bf16 a[0:15], v[252:255], v[236:239], a[0:15]
  s_add_u32 m0, s38, 24576
  v_mul_u32_u24 v8, 19, v15
  v_lshrrev_b32 v8, 2, v8
  v_sub_u32 v14, v14, v8
  buffer_load_dwordx4 v14, s[12:15], 0 offen sc1 lds
  v_exp_f32 v148, v148
  v_exp_f32 v149, v149
  v_exp_f32 v150, v150
  v_exp_f32 v151, v151
  v_cvt_pk_bf16_f32 v230, v148, v149
  v_cvt_pk_bf16_f32 v231, v150, v151
  ds_read_b128 v[248:251], v4 offset:14336
  ds_read_b128 v[252:255], v4 offset:15360
  v_mfma_f32_32x32x16_bf16 v[136:151], v[48:51], v[124:127], v[184:199]
  s_add_u32 m0, s38, 25600
  v_add_u32 v14, v14, v15
  buffer_load_dwordx4 v14, s[12:15], 0 offen sc1 lds
  v_exp_f32 v152, v152
  v_exp_f32 v153, v153
  v_exp_f32 v154, v154
  v_exp_f32 v155, v155
  v_cvt_pk_bf16_f32 v232, v152, v153
  v_cvt_pk_bf16_f32 v233, v154, v155
  v_mfma_f32_32x32x8_bf16 v[136:151], v[68:69], v[128:129], v[136:151]
  s_add_u32 m0, s38, 26624
  v_add_u32 v14, v14, v15
  buffer_load_dwordx4 v14, s[12:15], 0 offen sc1 lds
  v_exp_f32 v156, v156
  v_exp_f32 v157, v157
  v_exp_f32 v158, v158
  v_exp_f32 v159, v159
  v_cvt_pk_bf16_f32 v234, v156, v157
  v_cvt_pk_bf16_f32 v235, v158, v159
  s_waitcnt lgkmcnt(2)
  v_mfma_f32_32x32x16_bf16 a[0:15], v[240:243], v[224:227], a[0:15]
  s_add_u32 m0, s38, 27648
  v_add_u32 v14, v14, v15
  buffer_load_dwordx4 v14, s[12:15], 0 offen sc1 lds
  v_exp_f32 v160, v160
  v_exp_f32 v161, v161
  v_exp_f32 v162, v162
  v_exp_f32 v163, v163
  v_cvt_pk_bf16_f32 v236, v160, v161
  v_cvt_pk_bf16_f32 v237, v162, v163
  v_mfma_f32_32x32x16_bf16 a[0:15], v[244:247], v[228:231], a[0:15]
  s_add_u32 m0, s38, 28672
  v_add_u32 v14, v14, v15
  buffer_load_dwordx4 v14, s[12:15], 0 offen sc1 lds
  v_exp_f32 v164, v164
  v_exp_f32 v165, v165
  v_exp_f32 v166, v166
  v_exp_f32 v167, v167
  v_cvt_pk_bf16_f32 v238, v164, v165
  v_cvt_pk_bf16_f32 v239, v166, v167
  ds_read_b128 v[240:243], v4 offset:16384
  ds_read_b128 v[244:247], v4 offset:17408
  s_add_u32 m0, s38, 29696
  v_add_u32 v14, v14, v15
  buffer_load_dwordx4 v14, s[12:15], 0 offen sc1 lds
  s_waitcnt vmcnt(0)
  v_dot2_f32_bf16 v177, v134, v134, 0
  v_dot2_f32_bf16 v177, v130, v130, v177
  v_dot2_f32_bf16 v177, v131, v131, v177
  v_dot2_f32_bf16 v177, v132, v132, v177
  v_dot2_f32_bf16 v177, v133, v133, v177
  s_barrier
  ds_read_b128 v[70:73], v6 offset:12288
  ds_read_b32 v106, v13 offset:2048
  ds_read_b128 v[74:77], v6 offset:13312
  ds_read_b32 v108, v13 offset:2176
  ds_read_b128 v[78:81], v6 offset:14336
  ds_read_b32 v110, v13 offset:2304
  ds_read_b128 v[82:85], v6 offset:15360
  ds_read_b32 v112, v13 offset:2432
  ds_read_b128 v[86:89], v6 offset:16384
  ds_read_b32 v114, v13 offset:2560
  v_mov_b32 v178, v177
  s_nop 1
  v_permlane32_swap_b32 v178, v177
  v_add_f32 v177, v177, v178
  s_waitcnt lgkmcnt(8)
  v_dot2_f32_bf16 v168, v106, v106, 0
  ds_read_b128 v[90:93], v6 offset:17408
  ds_read_b32 v116, v13 offset:2688
  v_dot2_f32_bf16 v168, v70, v70, v168
  v_dot2_f32_bf16 v168, v71, v71, v168
  v_dot2_f32_bf16 v168, v72, v72, v168
  v_dot2_f32_bf16 v168, v73, v73, v168
  s_waitcnt lgkmcnt(8)
  v_dot2_f32_bf16 v169, v108, v108, 0
  ds_read_b128 v[94:97], v6 offset:18432
  ds_read_b32 v118, v13 offset:2816
  v_dot2_f32_bf16 v169, v74, v74, v169
  v_dot2_f32_bf16 v169, v75, v75, v169
  v_dot2_f32_bf16 v169, v76, v76, v169
  v_dot2_f32_bf16 v169, v77, v77, v169
  s_waitcnt lgkmcnt(8)
  v_dot2_f32_bf16 v170, v110, v110, 0
  ds_read_b128 v[98:101], v6 offset:19456
  ds_read_b32 v120, v13 offset:2944
  v_dot2_f32_bf16 v170, v78, v78, v170
  v_dot2_f32_bf16 v170, v79, v79, v170
  v_dot2_f32_bf16 v170, v80, v80, v170
  v_dot2_f32_bf16 v170, v81, v81, v170
  s_waitcnt lgkmcnt(8)
  v_dot2_f32_bf16 v171, v112, v112, 0
  ds_read_b128 v[102:105], v6 offset:20480
  ds_read_b32 v122, v13 offset:3072
  v_dot2_f32_bf16 v171, v82, v82, v171
  v_dot2_f32_bf16 v171, v83, v83, v171
  v_dot2_f32_bf16 v171, v84, v84, v171
  v_dot2_f32_bf16 v171, v85, v85, v171
  s_waitcnt lgkmcnt(8)
  v_dot2_f32_bf16 v172, v114, v114, 0
  v_dot2_f32_bf16 v172, v86, v86, v172
  v_dot2_f32_bf16 v172, v87, v87, v172
  v_dot2_f32_bf16 v172, v88, v88, v172
  v_dot2_f32_bf16 v172, v89, v89, v172
  s_waitcnt lgkmcnt(6)
  v_dot2_f32_bf16 v173, v116, v116, 0
  v_dot2_f32_bf16 v173, v90, v90, v173
  v_dot2_f32_bf16 v173, v91, v91, v173
  v_dot2_f32_bf16 v173, v92, v92, v173
  v_dot2_f32_bf16 v173, v93, v93, v173
  s_waitcnt lgkmcnt(4)
  v_dot2_f32_bf16 v174, v118, v118, 0
  v_dot2_f32_bf16 v174, v94, v94, v174
  v_dot2_f32_bf16 v174, v95, v95, v174
  v_dot2_f32_bf16 v174, v96, v96, v174
  v_dot2_f32_bf16 v174, v97, v97, v174
  s_waitcnt lgkmcnt(2)
  v_dot2_f32_bf16 v175, v120, v120, 0
  v_dot2_f32_bf16 v175, v98, v98, v175
  v_dot2_f32_bf16 v175, v99, v99, v175
  v_dot2_f32_bf16 v175, v100, v100, v175
  v_dot2_f32_bf16 v175, v101, v101, v175
  s_waitcnt lgkmcnt(0)
  v_dot2_f32_bf16 v176, v122, v122, 0
  v_dot2_f32_bf16 v176, v102, v102, v176
  v_dot2_f32_bf16 v176, v103, v103, v176
  v_dot2_f32_bf16 v176, v104, v104, v176
  v_dot2_f32_bf16 v176, v105, v105, v176
  v_max3_f32 v168, v168, v169, v170
  v_max3_f32 v171, v171, v172, v173
  s_nop 0
  v_max3_f32 v174, v174, v175, v176
  v_max3_f32 v168, v168, v171, v174
  s_nop 1
  v_max_f32_dpp v168, v168, v168 row_ror:1 row_mask:0xf bank_mask:0xf
  s_nop 1
  v_max_f32_dpp v168, v168, v168 row_ror:2 row_mask:0xf bank_mask:0xf
  s_nop 1
  v_max_f32_dpp v168, v168, v168 row_ror:4 row_mask:0xf bank_mask:0xf
  s_nop 1
  v_max_f32_dpp v168, v168, v168 row_ror:8 row_mask:0xf bank_mask:0xf
  v_mov_b32 v169, v168
  s_nop 1
  v_permlane16_swap_b32 v169, v168
  v_max_f32 v168, v168, v169
  v_mov_b32 v169, v168
  s_nop 1
  v_permlane32_swap_b32 v169, v168
  v_add_f32 v168, v168, v169
  v_mul_f32 v168, v168, v177
  v_cmp_nge_f32 vcc, s39, v168
  s_nop 1
  s_cbranch_vccz p2_go1
  v_not_b32 v64, v12
  v_bfe_i32 v16, v12, 0, 1
  v_bfe_i32 v200, v64, 0, 1
  v_bfe_i32 v17, v12, 1, 1
  v_bfe_i32 v201, v64, 1, 1
  v_bfe_i32 v18, v12, 2, 1
  v_bfe_i32 v202, v64, 2, 1
  v_bfe_i32 v19, v12, 3, 1
  v_bfe_i32 v203, v64, 3, 1
  v_bfe_i32 v20, v12, 8, 1
  v_bfe_i32 v204, v64, 8, 1
  v_bfe_i32 v21, v12, 9, 1
  v_bfe_i32 v205, v64, 9, 1
  v_bfe_i32 v22, v12, 10, 1
  v_bfe_i32 v206, v64, 10, 1
  v_bfe_i32 v23, v12, 11, 1
  v_bfe_i32 v207, v64, 11, 1
  v_bfe_i32 v24, v12, 16, 1
  v_bfe_i32 v208, v64, 16, 1
  v_bfe_i32 v25, v12, 17, 1
  v_bfe_i32 v209, v64, 17, 1
  v_bfe_i32 v26, v12, 18, 1
  v_bfe_i32 v210, v64, 18, 1
  v_bfe_i32 v27, v12, 19, 1
  v_bfe_i32 v211, v64, 19, 1
  v_bfe_i32 v28, v12, 24, 1
  v_bfe_i32 v212, v64, 24, 1
  v_bfe_i32 v29, v12, 25, 1
  v_bfe_i32 v213, v64, 25, 1
  v_bfe_i32 v30, v12, 26, 1
  v_bfe_i32 v214, v64, 26, 1
  v_bfe_i32 v31, v12, 27, 1
  v_bfe_i32 v215, v64, 27, 1
  v_mov_b32 v64, 4269801472
  v_mov_b32 v65, 4269801472
  v_mfma_f32_32x32x16_bf16 v[16:31], v[70:73], v[130:133], v[16:31]
  v_mfma_f32_32x32x8_bf16 v[16:31], v[106:107], v[134:135], v[16:31]
  v_mfma_f32_32x32x16_bf16 v[32:47], v[74:77], v[130:133], 0
  v_mfma_f32_32x32x8_bf16 v[32:47], v[108:109], v[134:135], v[32:47]
  v_mfma_f32_32x32x16_bf16 v[48:63], v[78:81], v[130:133], 0
  v_mfma_f32_32x32x8_bf16 v[48:63], v[110:111], v[134:135], v[48:63]
  s_nop 7
  v_max3_f32 v64, v64, v16, v17
  v_max3_f32 v65, v65, v18, v19
  v_max3_f32 v64, v64, v20, v21
  v_max3_f32 v65, v65, v22, v23
  v_max3_f32 v64, v64, v24, v25
  v_max3_f32 v65, v65, v26, v27
  v_max3_f32 v64, v64, v28, v29
  v_max3_f32 v65, v65, v30, v31
  v_mfma_f32_32x32x16_bf16 v[16:31], v[82:85], v[130:133], 0
  v_mfma_f32_32x32x8_bf16 v[16:31], v[112:113], v[134:135], v[16:31]
  v_max3_f32 v64, v64, v32, v33
  v_max3_f32 v65, v65, v34, v35
  v_max3_f32 v64, v64, v36, v37
  v_max3_f32 v65, v65, v38, v39
  v_max3_f32 v64, v64, v40, v41
  v_max3_f32 v65, v65, v42, v43
  v_max3_f32 v64, v64, v44, v45
  v_max3_f32 v65, v65, v46, v47
  v_mfma_f32_32x32x16_bf16 v[32:47], v[86:89], v[130:133], 0
  v_mfma_f32_32x32x8_bf16 v[32:47], v[114:115], v[134:135], v[32:47]
  v_max3_f32 v64, v64, v48, v49
  v_max3_f32 v65, v65, v50, v51
  v_max3_f32 v64, v64, v52, v53
  v_max3_f32 v65, v65, v54, v55
  v_max3_f32 v64, v64, v56, v57
  v_max3_f32 v65, v65, v58, v59
  v_max3_f32 v64, v64, v60, v61
  v_max3_f32 v65, v65, v62, v63
  v_mfma_f32_32x32x16_bf16 v[48:63], v[90:93], v[130:133], 0
  v_mfma_f32_32x32x8_bf16 v[48:63], v[116:117], v[134:135], v[48:63]
  v_max3_f32 v64, v64, v16, v17
  v_max3_f32 v65, v65, v18, v19
  v_max3_f32 v64, v64, v20, v21
  v_max3_f32 v65, v65, v22, v23
  v_max3_f32 v64, v64, v24, v25
  v_max3_f32 v65, v65, v26, v27
  v_max3_f32 v64, v64, v28, v29
  v_max3_f32 v65, v65, v30, v31
  v_mfma_f32_32x32x16_bf16 v[16:31], v[94:97], v[130:133], 0
  v_mfma_f32_32x32x8_bf16 v[16:31], v[118:119], v[134:135], v[16:31]
  v_max3_f32 v64, v64, v32, v33
  v_max3_f32 v65, v65, v34, v35
  v_max3_f32 v64, v64, v36, v37
  v_max3_f32 v65, v65, v38, v39
  v_max3_f32 v64, v64, v40, v41
  v_max3_f32 v65, v65, v42, v43
  v_max3_f32 v64, v64, v44, v45
  v_max3_f32 v65, v65, v46, v47
  v_mfma_f32_32x32x16_bf16 v[32:47], v[98:101], v[130:133], 0
  v_mfma_f32_32x32x8_bf16 v[32:47], v[120:121], v[134:135], v[32:47]
  v_max3_f32 v64, v64, v48, v49
  v_max3_f32 v65, v65, v50, v51
  v_max3_f32 v64, v64, v52, v53
  v_max3_f32 v65, v65, v54, v55
  v_max3_f32 v64, v64, v56, v57
  v_max3_f32 v65, v65, v58, v59
  v_max3_f32 v64, v64, v60, v61
  v_max3_f32 v65, v65, v62, v63
  v_mfma_f32_32x32x16_bf16 v[48:63], v[102:105], v[130:133], v[200:215]
  v_mfma_f32_32x32x8_bf16 v[48:63], v[122:123], v[134:135], v[48:63]
  v_max3_f32 v64, v64, v16, v17
  v_max3_f32 v65, v65, v18, v19
  v_max3_f32 v64, v64, v20, v21
  v_max3_f32 v65, v65, v22, v23
  v_max3_f32 v64, v64, v24, v25
  v_max3_f32 v65, v65, v26, v27
  v_max3_f32 v64, v64, v28, v29
  v_max3_f32 v65, v65, v30, v31
  s_nop 1
  v_max3_f32 v64, v64, v32, v33
  v_max3_f32 v65, v65, v34, v35
  v_max3_f32 v64, v64, v36, v37
  v_max3_f32 v65, v65, v38, v39
  v_max3_f32 v64, v64, v40, v41
  v_max3_f32 v65, v65, v42, v43
  v_max3_f32 v64, v64, v44, v45
  v_max3_f32 v65, v65, v46, v47
  s_nop 1
  v_max3_f32 v64, v64, v48, v49
  v_max3_f32 v65, v65, v50, v51
  v_max3_f32 v64, v64, v52, v53
  v_max3_f32 v65, v65, v54, v55
  v_max3_f32 v64, v64, v56, v57
  v_max3_f32 v65, v65, v58, v59
  v_max3_f32 v64, v64, v60, v61
  v_max3_f32 v65, v65, v62, v63
  v_max_f32 v64, v64, v65
  v_mov_b32 v65, v64
  s_nop 1
  v_permlane32_swap_b32 v65, v64
  v_max_f32 v64, v64, v65
  v_mul_f32 v200, -1.0, v64
  v_mul_f32 v201, -1.0, v64
  v_mul_f32 v202, -1.0, v64
  v_mul_f32 v203, -1.0, v64
  v_mul_f32 v204, -1.0, v64
  v_mul_f32 v205, -1.0, v64
  v_mul_f32 v206, -1.0, v64
  v_mul_f32 v207, -1.0, v64
  v_mul_f32 v208, -1.0, v64
  v_mul_f32 v209, -1.0, v64
  v_mul_f32 v210, -1.0, v64
  v_mul_f32 v211, -1.0, v64
  v_mul_f32 v212, -1.0, v64
  v_mul_f32 v213, -1.0, v64
  v_mul_f32 v214, -1.0, v64
  v_mul_f32 v215, -1.0, v64
  s_nop 1
p2_go1:
  v_mfma_f32_32x32x16_bf16 v[152:167], v[70:73], v[130:133], v[200:215]
  v_exp_f32 v136, v136
  v_exp_f32 v137, v137
  v_exp_f32 v138, v138
  v_exp_f32 v139, v139
  v_cvt_pk_bf16_f32 v224, v136, v137
  v_cvt_pk_bf16_f32 v225, v138, v139
  v_and_b32 v224, v216, v224
  v_and_b32 v225, v217, v225
  v_mfma_f32_32x32x8_bf16 v[152:167], v[106:107], v[134:135], v[152:167]
  v_exp_f32 v140, v140
  v_exp_f32 v141, v141
  v_exp_f32 v142, v142
  v_exp_f32 v143, v143
  v_cvt_pk_bf16_f32 v226, v140, v141
  v_cvt_pk_bf16_f32 v227, v142, v143
  v_and_b32 v226, v218, v226
  v_and_b32 v227, v219, v227
  v_mfma_f32_32x32x16_bf16 a[0:15], v[248:251], v[232:235], a[0:15]
  v_exp_f32 v144, v144
  v_exp_f32 v145, v145
  v_exp_f32 v146, v146
  v_exp_f32 v147, v147
  v_cvt_pk_bf16_f32 v228, v144, v145
  v_cvt_pk_bf16_f32 v229, v146, v147
  v_and_b32 v228, v220, v228
  v_and_b32 v229, v221, v229
  v_mfma_f32_32x32x16_bf16 a[0:15], v[252:255], v[236:239], a[0:15]
  v_exp_f32 v148, v148
  v_exp_f32 v149, v149
  v_exp_f32 v150, v150
  v_exp_f32 v151, v151
  v_cvt_pk_bf16_f32 v230, v148, v149
  v_cvt_pk_bf16_f32 v231, v150, v151
  v_and_b32 v230, v222, v230
  v_and_b32 v231, v223, v231
  ds_read_b128 v[248:251], v4 offset:24576
  ds_read_b128 v[252:255], v4 offset:25600
  v_mfma_f32_32x32x16_bf16 v[136:151], v[74:77], v[130:133], v[200:215]
  v_exp_f32 v152, v152
  v_exp_f32 v153, v153
  v_exp_f32 v154, v154
  v_exp_f32 v155, v155
  v_cvt_pk_bf16_f32 v232, v152, v153
  v_cvt_pk_bf16_f32 v233, v154, v155
  v_bfi_b32 v232, v216, 0, v232
  v_bfi_b32 v233, v217, 0, v233
  v_mfma_f32_32x32x8_bf16 v[136:151], v[108:109], v[134:135], v[136:151]
  v_exp_f32 v156, v156
  v_exp_f32 v157, v157
  v_exp_f32 v158, v158
  v_exp_f32 v159, v159
  v_cvt_pk_bf16_f32 v234, v156, v157
  v_cvt_pk_bf16_f32 v235, v158, v159
  v_bfi_b32 v234, v218, 0, v234
  v_bfi_b32 v235, v219, 0, v235
  v_mfma_f32_32x32x16_bf16 a[0:15], v[240:243], v[224:227], a[0:15]
  v_exp_f32 v160, v160
  v_exp_f32 v161, v161
  v_exp_f32 v162, v162
  v_exp_f32 v163, v163
  v_cvt_pk_bf16_f32 v236, v160, v161
  v_cvt_pk_bf16_f32 v237, v162, v163
  v_bfi_b32 v236, v220, 0, v236
  v_bfi_b32 v237, v221, 0, v237
  v_mfma_f32_32x32x16_bf16 a[0:15], v[244:247], v[228:231], a[0:15]
  v_exp_f32 v164, v164
  v_exp_f32 v165, v165
  v_exp_f32 v166, v166
  v_exp_f32 v167, v167
  v_cvt_pk_bf16_f32 v238, v164, v165
  v_cvt_pk_bf16_f32 v239, v166, v167
  v_bfi_b32 v238, v222, 0, v238
  v_bfi_b32 v239, v223, 0, v239
  ds_read_b128 v[240:243], v4 offset:26624
  ds_read_b128 v[244:247], v4 offset:27648
  v_mfma_f32_32x32x16_bf16 v[152:167], v[78:81], v[130:133], v[200:215]
  v_exp_f32 v136, v136
  v_exp_f32 v137, v137
  v_exp_f32 v138, v138
  v_exp_f32 v139, v139
  v_cvt_pk_bf16_f32 v224, v136, v137
  v_cvt_pk_bf16_f32 v225, v138, v139
  v_mfma_f32_32x32x8_bf16 v[152:167], v[110:111], v[134:135], v[152:167]
  v_exp_f32 v140, v140
  v_exp_f32 v141, v141
  v_exp_f32 v142, v142
  v_exp_f32 v143, v143
  v_cvt_pk_bf16_f32 v226, v140, v141
  v_cvt_pk_bf16_f32 v227, v142, v143
  s_waitcnt lgkmcnt(2)
  v_mfma_f32_32x32x16_bf16 a[16:31], v[248:251], v[232:235], 0
  v_exp_f32 v144, v144
  v_exp_f32 v145, v145
  v_exp_f32 v146, v146
  v_exp_f32 v147, v147
  v_cvt_pk_bf16_f32 v228, v144, v145
  v_cvt_pk_bf16_f32 v229, v146, v147
  v_mfma_f32_32x32x16_bf16 a[16:31], v[252:255], v[236:239], a[16:31]
  v_exp_f32 v148, v148
  v_exp_f32 v149, v149
  v_exp_f32 v150, v150
  v_exp_f32 v151, v151
  v_cvt_pk_bf16_f32 v230, v148, v149
  v_cvt_pk_bf16_f32 v231, v150, v151
  ds_read_b128 v[248:251], v4 offset:28672
  ds_read_b128 v[252:255], v4 offset:29696
  v_accvgpr_read_b32 v16, a0
  v_accvgpr_read_b32 v17, a1
  v_accvgpr_read_b32 v18, a2
  v_accvgpr_read_b32 v19, a3
  v_accvgpr_read_b32 v20, a4
  v_accvgpr_read_b32 v21, a5
  v_accvgpr_read_b32 v22, a6
  v_accvgpr_read_b32 v23, a7
  v_accvgpr_read_b32 v24, a8
  v_accvgpr_read_b32 v25, a9
  v_accvgpr_read_b32 v26, a10
  v_rcp_f32 v8, v26
  s_nop 0
  v_mul_f32 v16, v16, v8
  v_mul_f32 v17, v17, v8
  v_mul_f32 v18, v18, v8
  v_mul_f32 v19, v19, v8
  v_mul_f32 v20, v20, v8
  v_mul_f32 v21, v21, v8
  v_mul_f32 v22, v22, v8
  v_mul_f32 v23, v23, v8
  v_mul_f32 v24, v24, v8
  v_mul_f32 v25, v25, v8
  v_cvt_pk_bf16_f32 v28, v16, v17
  v_cvt_pk_bf16_f32 v29, v18, v19
  v_cvt_pk_bf16_f32 v30, v20, v21
  v_cvt_pk_bf16_f32 v31, v22, v23
  v_cvt_pk_bf16_f32 v14, v24, v25
  buffer_store_dwordx4 v[28:31], v3, s[8:11], s26 offen sc1
  v_mfma_f32_32x32x16_bf16 v[136:151], v[82:85], v[130:133], v[200:215]
  s_lshr_b32 s45, s2, 5
  s_mul_i32 s45, s45, 110592
  s_mul_i32 s46, s20, 3072
  s_add_u32 s45, s45, s46
  s_add_u32 s45, s45, 2097152
  s_cmp_lt_u32 s2, 192
  s_cselect_b32 s45, s45, 268435456
  s_mul_i32 s46, s20, 5120
  v_exp_f32 v152, v152
  v_exp_f32 v153, v153
  v_exp_f32 v154, v154
  v_exp_f32 v155, v155
  v_cvt_pk_bf16_f32 v232, v152, v153
  v_cvt_pk_bf16_f32 v233, v154, v155
  v_mfma_f32_32x32x8_bf16 v[136:151], v[112:113], v[134:135], v[136:151]
  s_add_u32 s47, s45, 0
  s_add_u32 m0, s46, 83968
  s_nop 0
  buffer_load_dwordx4 v3, s[4:7], s47 offen offset:0 lds
  v_exp_f32 v156, v156
  v_exp_f32 v157, v157
  v_exp_f32 v158, v158
  v_exp_f32 v159, v159
  v_cvt_pk_bf16_f32 v234, v156, v157
  v_cvt_pk_bf16_f32 v235, v158, v159
  s_waitcnt lgkmcnt(2)
  v_mfma_f32_32x32x16_bf16 a[16:31], v[240:243], v[224:227], a[16:31]
  s_add_u32 m0, s46, 83968
  s_nop 0
  buffer_load_dwordx4 v3, s[4:7], s47 offen offset:1024 lds
  v_exp_f32 v160, v160
  v_exp_f32 v161, v161
  v_exp_f32 v162, v162
  v_exp_f32 v163, v163
  v_cvt_pk_bf16_f32 v236, v160, v161
  v_cvt_pk_bf16_f32 v237, v162, v163
  v_mfma_f32_32x32x16_bf16 a[16:31], v[244:247], v[228:231], a[16:31]
  s_add_u32 m0, s46, 83968
  s_nop 0
  buffer_load_dwordx4 v3, s[4:7], s47 offen offset:2048 lds
  v_exp_f32 v164, v164
  v_exp_f32 v165, v165
  v_exp_f32 v166, v166
  v_exp_f32 v167, v167
  v_cvt_pk_bf16_f32 v238, v164, v165
  v_cvt_pk_bf16_f32 v239, v166, v167
  ds_read_b128 v[240:243], v4 offset:30720
  ds_read_b128 v[244:247], v4 offset:31744
  v_mfma_f32_32x32x16_bf16 v[152:167], v[86:89], v[130:133], v[200:215]
  s_add_u32 s47, s45, 12288
  s_add_u32 m0, s46, 104448
  s_nop 0
  buffer_load_dwordx4 v3, s[4:7], s47 offen offset:0 lds
  v_exp_f32 v136, v136
  v_exp_f32 v137, v137
  v_exp_f32 v138, v138
  v_exp_f32 v139, v139
  v_cvt_pk_bf16_f32 v224, v136, v137
  v_cvt_pk_bf16_f32 v225, v138, v139
  v_mfma_f32_32x32x8_bf16 v[152:167], v[114:115], v[134:135], v[152:167]
  s_add_u32 m0, s46, 104448
  s_nop 0
  buffer_load_dwordx4 v3, s[4:7], s47 offen offset:1024 lds
  v_exp_f32 v140, v140
  v_exp_f32 v141, v141
  v_exp_f32 v142, v142
  v_exp_f32 v143, v143
  v_cvt_pk_bf16_f32 v226, v140, v141
  v_cvt_pk_bf16_f32 v227, v142, v143
  s_waitcnt lgkmcnt(2)
  v_mfma_f32_32x32x16_bf16 a[16:31], v[248:251], v[232:235], a[16:31]
  s_add_u32 m0, s46, 104448
  s_nop 0
  buffer_load_dwordx4 v3, s[4:7], s47 offen offset:2048 lds
  v_exp_f32 v144, v144
  v_exp_f32 v145, v145
  v_exp_f32 v146, v146
  v_exp_f32 v147, v147
  v_cvt_pk_bf16_f32 v228, v144, v145
  v_cvt_pk_bf16_f32 v229, v146, v147
  v_mfma_f32_32x32x16_bf16 a[16:31], v[252:255], v[236:239], a[16:31]
  s_add_u32 s47, s45, 24576
  s_add_u32 m0, s46, 124928
  s_nop 0
  buffer_load_dwordx4 v3, s[4:7], s47 offen offset:0 lds
  v_exp_f32 v148, v148
  v_exp_f32 v149, v149
  v_exp_f32 v150, v150
  v_exp_f32 v151, v151
  v_cvt_pk_bf16_f32 v230, v148, v149
  v_cvt_pk_bf16_f32 v231, v150, v151
  ds_read_b128 v[248:251], v4 offset:32768
  ds_read_b128 v[252:255], v4 offset:33792
  v_mfma_f32_32x32x16_bf16 v[136:151], v[90:93], v[130:133], v[200:215]
  s_add_u32 m0, s46, 124928
  s_nop 0
  buffer_load_dwordx4 v3, s[4:7], s47 offen offset:1024 lds
  v_exp_f32 v152, v152
  v_exp_f32 v153, v153
  v_exp_f32 v154, v154
  v_exp_f32 v155, v155
  v_cvt_pk_bf16_f32 v232, v152, v153
  v_cvt_pk_bf16_f32 v233, v154, v155
  v_mfma_f32_32x32x8_bf16 v[136:151], v[116:117], v[134:135], v[136:151]
  s_add_u32 m0, s46, 124928
  s_nop 0
  buffer_load_dwordx4 v3, s[4:7], s47 offen offset:2048 lds
  v_exp_f32 v156, v156
  v_exp_f32 v157, v157
  v_exp_f32 v158, v158
  v_exp_f32 v159, v159
  v_cvt_pk_bf16_f32 v234, v156, v157
  v_cvt_pk_bf16_f32 v235, v158, v159
  s_waitcnt lgkmcnt(2)
  v_mfma_f32_32x32x16_bf16 a[16:31], v[240:243], v[224:227], a[16:31]
  v_exp_f32 v160, v160
  v_exp_f32 v161, v161
  v_exp_f32 v162, v162
  v_exp_f32 v163, v163
  v_cvt_pk_bf16_f32 v236, v160, v161
  v_cvt_pk_bf16_f32 v237, v162, v163
  v_mfma_f32_32x32x16_bf16 a[16:31], v[244:247], v[228:231], a[16:31]
  v_exp_f32 v164, v164
  v_exp_f32 v165, v165
  v_exp_f32 v166, v166
  v_exp_f32 v167, v167
  v_cvt_pk_bf16_f32 v238, v164, v165
  v_cvt_pk_bf16_f32 v239, v166, v167
  ds_read_b128 v[240:243], v4 offset:34816
  ds_read_b128 v[244:247], v4 offset:35840
  v_mov_b32 v12, 1
  v_min_u32 v13, 1, v0
  v_lshlrev_b32 v13, 31, v13
  s_waitcnt vmcnt(9)
  s_barrier
  buffer_store_dword v12, v13, s[8:11], s48 offen sc1
  v_mfma_f32_32x32x16_bf16 v[152:167], v[94:97], v[130:133], v[200:215]
  s_add_u32 s47, s45, 36864
  s_add_u32 m0, s46, 2048
  s_nop 0
  buffer_load_dwordx4 v3, s[4:7], s47 offen offset:0 lds
  v_exp_f32 v136, v136
  v_exp_f32 v137, v137
  v_exp_f32 v138, v138
  v_exp_f32 v139, v139
  v_cvt_pk_bf16_f32 v224, v136, v137
  v_cvt_pk_bf16_f32 v225, v138, v139
  v_mfma_f32_32x32x8_bf16 v[152:167], v[118:119], v[134:135], v[152:167]
  s_add_u32 m0, s46, 2048
  s_nop 0
  buffer_load_dwordx4 v3, s[4:7], s47 offen offset:1024 lds
  v_exp_f32 v140, v140
  v_exp_f32 v141, v141
  v_exp_f32 v142, v142
  v_exp_f32 v143, v143
  v_cvt_pk_bf16_f32 v226, v140, v141
  v_cvt_pk_bf16_f32 v227, v142, v143
  s_waitcnt lgkmcnt(2)
  v_mfma_f32_32x32x16_bf16 a[16:31], v[248:251], v[232:235], a[16:31]
  s_add_u32 m0, s46, 2048
  s_nop 0
  buffer_load_dwordx4 v3, s[4:7], s47 offen offset:2048 lds
  v_exp_f32 v144, v144
  v_exp_f32 v145, v145
  v_exp_f32 v146, v146
  v_exp_f32 v147, v147
  v_cvt_pk_bf16_f32 v228, v144, v145
  v_cvt_pk_bf16_f32 v229, v146, v147
  v_mfma_f32_32x32x16_bf16 a[16:31], v[252:255], v[236:239], a[16:31]
  s_add_u32 s47, s45, 49152
  s_add_u32 m0, s46, 22528
  s_nop 0
  buffer_load_dwordx4 v3, s[4:7], s47 offen offset:0 lds
  v_exp_f32 v148, v148
  v_exp_f32 v149, v149
  v_exp_f32 v150, v150
  v_exp_f32 v151, v151
  v_cvt_pk_bf16_f32 v230, v148, v149
  v_cvt_pk_bf16_f32 v231, v150, v151
  ds_read_b128 v[248:251], v4 offset:36864
  ds_read_b128 v[252:255], v4 offset:37888
  v_mfma_f32_32x32x16_bf16 v[136:151], v[98:101], v[130:133], v[200:215]
  s_add_u32 m0, s46, 22528
  s_nop 0
  buffer_load_dwordx4 v3, s[4:7], s47 offen offset:1024 lds
  v_exp_f32 v152, v152
  v_exp_f32 v153, v153
  v_exp_f32 v154, v154
  v_exp_f32 v155, v155
  v_cvt_pk_bf16_f32 v232, v152, v153
  v_cvt_pk_bf16_f32 v233, v154, v155
  v_mfma_f32_32x32x8_bf16 v[136:151], v[120:121], v[134:135], v[136:151]
  s_add_u32 m0, s46, 22528
  s_nop 0
  buffer_load_dwordx4 v3, s[4:7], s47 offen offset:2048 lds
  v_exp_f32 v156, v156
  v_exp_f32 v157, v157
  v_exp_f32 v158, v158
  v_exp_f32 v159, v159
  v_cvt_pk_bf16_f32 v234, v156, v157
  v_cvt_pk_bf16_f32 v235, v158, v159
  s_waitcnt lgkmcnt(2)
  v_mfma_f32_32x32x16_bf16 a[16:31], v[240:243], v[224:227], a[16:31]
  v_exp_f32 v160, v160
  v_exp_f32 v161, v161
  v_exp_f32 v162, v162
  v_exp_f32 v163, v163
  v_cvt_pk_bf16_f32 v236, v160, v161
  v_cvt_pk_bf16_f32 v237, v162, v163
  v_mfma_f32_32x32x16_bf16 a[16:31], v[244:247], v[228:231], a[16:31]
  v_exp_f32 v164, v164
  v_exp_f32 v165, v165
  v_exp_f32 v166, v166
  v_exp_f32 v167, v167
  v_cvt_pk_bf16_f32 v238, v164, v165
  v_cvt_pk_bf16_f32 v239, v166, v167
  ds_read_b128 v[240:243], v4 offset:38912
  ds_read_b128 v[244:247], v4 offset:39936
  v_mfma_f32_32x32x16_bf16 v[152:167], v[102:105], v[130:133], v[200:215]
  v_exp_f32 v136, v136
  v_exp_f32 v137, v137
  v_exp_f32 v138, v138
  v_exp_f32 v139, v139
  v_cvt_pk_bf16_f32 v224, v136, v137
  v_cvt_pk_bf16_f32 v225, v138, v139
  v_mfma_f32_32x32x8_bf16 v[152:167], v[122:123], v[134:135], v[152:167]
  v_exp_f32 v140, v140
  v_exp_f32 v141, v141
  v_exp_f32 v142, v142
  v_exp_f32 v143, v143
  v_cvt_pk_bf16_f32 v226, v140, v141
  v_cvt_pk_bf16_f32 v227, v142, v143
  s_waitcnt lgkmcnt(2)
  v_mfma_f32_32x32x16_bf16 a[16:31], v[248:251], v[232:235], a[16:31]
  v_exp_f32 v144, v144
  v_exp_f32 v145, v145
  v_exp_f32 v146, v146
  v_exp_f32 v147, v147
  v_cvt_pk_bf16_f32 v228, v144, v145
  v_cvt_pk_bf16_f32 v229, v146, v147
  v_mfma_f32_32x32x16_bf16 a[16:31], v[252:255], v[236:239], a[16:31]
  v_exp_f32 v148, v148
  v_exp_f32 v149, v149
  v_exp_f32 v150, v150
  v_exp_f32 v151, v151
  v_cvt_pk_bf16_f32 v230, v148, v149
  v_cvt_pk_bf16_f32 v231, v150, v151
  ds_read_b128 v[248:251], v4 offset:40960
  ds_read_b128 v[252:255], v4 offset:41984
  s_waitcnt lgkmcnt(2)
  v_mfma_f32_32x32x16_bf16 a[16:31], v[240:243], v[224:227], a[16:31]
  v_exp_f32 v152, v152
  v_exp_f32 v153, v153
  v_exp_f32 v154, v154
  v_exp_f32 v155, v155
  v_cvt_pk_bf16_f32 v232, v152, v153
  v_cvt_pk_bf16_f32 v233, v154, v155
  v_and_b32 v232, v216, v232
  v_and_b32 v233, v217, v233
  v_exp_f32 v156, v156
  v_exp_f32 v157, v157
  v_exp_f32 v158, v158
  v_exp_f32 v159, v159
  v_cvt_pk_bf16_f32 v234, v156, v157
  v_cvt_pk_bf16_f32 v235, v158, v159
  v_and_b32 v234, v218, v234
  v_and_b32 v235, v219, v235
  v_mfma_f32_32x32x16_bf16 a[16:31], v[244:247], v[228:231], a[16:31]
  v_exp_f32 v160, v160
  v_exp_f32 v161, v161
  v_exp_f32 v162, v162
  v_exp_f32 v163, v163
  v_cvt_pk_bf16_f32 v236, v160, v161
  v_cvt_pk_bf16_f32 v237, v162, v163
  v_and_b32 v236, v220, v236
  v_and_b32 v237, v221, v237
  v_exp_f32 v164, v164
  v_exp_f32 v165, v165
  v_exp_f32 v166, v166
  v_exp_f32 v167, v167
  v_cvt_pk_bf16_f32 v238, v164, v165
  v_cvt_pk_bf16_f32 v239, v166, v167
  v_and_b32 v238, v222, v238
  v_and_b32 v239, v223, v239
  s_nop 1
  s_waitcnt lgkmcnt(0)
  v_mfma_f32_32x32x16_bf16 a[16:31], v[248:251], v[232:235], a[16:31]
  v_mfma_f32_32x32x16_bf16 a[16:31], v[252:255], v[236:239], a[16:31]
  s_nop 11
  v_accvgpr_read_b32 v16, a16
  v_accvgpr_read_b32 v17, a17
  v_accvgpr_read_b32 v18, a18
  v_accvgpr_read_b32 v19, a19
  v_accvgpr_read_b32 v20, a20
  v_accvgpr_read_b32 v21, a21
  v_accvgpr_read_b32 v22, a22
  v_accvgpr_read_b32 v23, a23
  v_accvgpr_read_b32 v24, a24
  v_accvgpr_read_b32 v25, a25
  v_accvgpr_read_b32 v26, a26
  v_rcp_f32 v8, v26
  s_nop 0
  v_mul_f32 v16, v16, v8
  v_mul_f32 v17, v17, v8
  v_mul_f32 v18, v18, v8
  v_mul_f32 v19, v19, v8
  v_mul_f32 v20, v20, v8
  v_mul_f32 v21, v21, v8
  v_mul_f32 v22, v22, v8
  v_mul_f32 v23, v23, v8
  v_mul_f32 v24, v24, v8
  v_mul_f32 v25, v25, v8
  v_cvt_pk_bf16_f32 v28, v16, v17
  v_cvt_pk_bf16_f32 v29, v18, v19
  v_cvt_pk_bf16_f32 v30, v20, v21
  v_cvt_pk_bf16_f32 v31, v22, v23
  v_cvt_pk_bf16_f32 v15, v24, v25
  buffer_store_dwordx4 v[28:31], v3, s[8:11], s27 offen sc1
  v_lshrrev_b32 v10, 1, v10
  v_lshl_or_b32 v10, v5, 31, v10
  buffer_store_dwordx2 v[14:15], v10, s[8:11], s28 offen sc1
p3_code:
  s_cmp_ge_u32 s2, 192
  s_cbranch_scc1 main_s3
  s_and_b32 s50, s2, 7
  s_lshl_b32 s50, s50, 2
  s_bfe_u32 s51, s2, 0x20003
  s_add_u32 s50, s50, s51
  s_lshr_b32 s54, s50, 1
  s_lshl_b32 s54, s54, 10
  s_add_u32 s54, s54, 83902464
  v_and_b32 v124, 15, v1
  v_lshlrev_b32 v124, 6, v124
  s_mul_i32 s51, s50, 73728
  s_lshl_b32 s52, s20, 10
  s_add_u32 s51, s51, s52
  s_add_u32 s51, s51, 45088768
  s_cmp_lg_u32 s20, 0
  s_cbranch_scc1 p3_eg
  buffer_load_dword v125, v124, s[8:11], s54 offen sc1
  s_waitcnt vmcnt(0)
  s_mov_b32 s53, 0
  s_branch p3_ec
p3_ep:
  buffer_load_dword v125, v124, s[8:11], s54 offen sc1
  s_add_u32 s53, s53, 1
  s_waitcnt vmcnt(0)
p3_ec:
  v_cmp_gt_u32 vcc, 1, v125
  s_cmp_gt_u32 s53, 0x8000
  s_cbranch_scc1 p3_eg
  s_cbranch_vccz p3_eg
  s_sleep 2
  s_branch p3_ep
p3_eg:
  s_mov_b32 s18, s50
  s_lshr_b32 s19, s2, 5
  s_mov_b32 s24, s46
  s_and_b32 s26, s20, 1
  s_lshr_b32 s27, s20, 1
  s_lshl_b32 s28, s18, 1
  v_and_b32 v6, 31, v1
  v_add_u32 v2, 36864, v3
  s_add_u32 s28, s28, s26
  s_mul_i32 s30, s28, 36
  s_mul_i32 s31, s19, 6
  s_add_u32 s30, s30, s31
  s_lshl_b32 s31, s27, 2
  s_add_u32 s30, s30, s31
  s_lshl_b32 s30, s30, 10
  s_add_u32 s31, s30, 20971520
  s_lshl_b32 s33, s26, 10
  v_add_u32 v4, s33, v3
  s_lshl_b32 s32, s27, 11
  s_add_u32 s32, s32, 2048
  v_add_u32 v5, s32, v3
  v_add_u32 v9, 0x10000, v4
  v_add_u32 v10, 0x10000, v5
  v_add_u32 v11, 0x20000, v4
  v_add_u32 v14, 0x20000, v5
  v_lshrrev_b32 v7, 5, v1
  v_lshlrev_b32 v8, 14, v7
  v_lshl_add_u32 v8, v6, 4, v8
  s_lshl_b32 s34, s20, 16
  s_lshl_b32 s35, s18, 9
  s_add_u32 s34, s34, s35
  s_add_u32 s34, s34, 41418752
  v_lshlrev_b32 v15, 10, v7
  v_lshl_add_u32 v15, v6, 3, v15
  s_lshl_b32 s35, s26, 8
  s_add_u32 s35, s35, 102400
  v_add_u32 v15, s35, v15
  s_lshl_b32 s32, s19, 1
  s_add_u32 s32, s32, s27
  s_lshl_b32 s32, s32, 14
  s_lshl_b32 s33, s28, 8
  s_add_u32 s32, s32, s33
  s_add_u32 s32, s32, 48234496
  v_lshlrev_b32 v6, 3, v6
  v_lshl_or_b32 v6, v7, 31, v6
  v_mov_b32 v12, 2
  v_min_u32 v13, 1, v0
  v_lshlrev_b32 v13, 31, v13
  s_waitcnt vmcnt(0)
  s_barrier
  buffer_store_dword v12, v13, s[8:11], s48 offen sc1
  s_add_u32 m0, s46, 81920
  s_add_u32 s52, s51, 0
  buffer_load_dwordx4 v3, s[8:11], s52 offen sc1 lds
  s_add_u32 m0, s46, 82944
  s_nop 0
  buffer_load_dwordx4 v2, s[8:11], s52 offen sc1 lds
  s_add_u32 m0, s46, 102400
  s_add_u32 s52, s51, 4096
  buffer_load_dwordx4 v3, s[8:11], s52 offen sc1 lds
  s_add_u32 m0, s46, 103424
  s_nop 0
  buffer_load_dwordx4 v2, s[8:11], s52 offen sc1 lds
  s_add_u32 m0, s46, 122880
  s_add_u32 s52, s51, 8192
  buffer_load_dwordx4 v3, s[8:11], s52 offen sc1 lds
  s_add_u32 m0, s46, 123904
  s_nop 0
  buffer_load_dwordx4 v2, s[8:11], s52 offen sc1 lds
  s_add_u32 m0, s46, 0
  s_add_u32 s52, s51, 12288
  buffer_load_dwordx4 v3, s[8:11], s52 offen sc1 lds
  s_add_u32 m0, s46, 1024
  s_nop 0
  buffer_load_dwordx4 v2, s[8:11], s52 offen sc1 lds
  s_mov_b32 s36, 0x00003f80
  s_mov_b32 s37, 0x3f800000
  s_mov_b32 s38, 0x3f803f80
  s_cmp_lg_u32 s27, 0
  s_cbranch_scc1 p3_one
  s_waitcnt vmcnt(6)
  s_barrier
  ds_read_b128 v[64:67], v9 offset:16384
  ds_read_b128 v[68:71], v10 offset:16384
  ds_read_b128 v[72:75], v10 offset:17408
  ds_read_b128 v[76:79], v9 offset:21504
  ds_read_b128 v[80:83], v10 offset:21504
  ds_read_b128 v[84:87], v10 offset:22528
  ds_read_b128 v[88:91], v9 offset:26624
  ds_read_b128 v[92:95], v10 offset:26624
  ds_read_b128 v[96:99], v10 offset:27648
  s_waitcnt lgkmcnt(6)
  v_mfma_f32_32x32x16_bf16 v[16:31], v[68:71], v[64:67], 0
  ds_read_b128 v[100:103], v9 offset:31744
  ds_read_b128 v[104:107], v10 offset:31744
  ds_read_b128 v[108:111], v10 offset:32768
  v_mfma_f32_32x32x16_bf16 v[32:47], v[72:75], v[64:67], 0
  s_cmp_lg_u32 s20, 0
  s_cbranch_scc1 p3_l0
  buffer_load_dword v125, v124, s[8:11], s54 offen sc1
p3_l0:
  s_waitcnt vmcnt(4)
  s_barrier
  s_waitcnt lgkmcnt(6)
  v_mfma_f32_32x32x16_bf16 v[16:31], v[80:83], v[76:79], v[16:31]
  ds_read_b128 v[64:67], v9 offset:36864
  ds_read_b128 v[68:71], v10 offset:36864
  ds_read_b128 v[72:75], v10 offset:37888
  v_mfma_f32_32x32x16_bf16 v[32:47], v[84:87], v[76:79], v[32:47]
  s_add_u32 s47, s45, 61440
  s_add_u32 m0, s46, 43008
  s_nop 0
  buffer_load_dwordx4 v3, s[4:7], s47 offen offset:0 lds
  s_waitcnt lgkmcnt(6)
  v_mfma_f32_32x32x16_bf16 v[16:31], v[92:95], v[88:91], v[16:31]
  ds_read_b128 v[76:79], v9 offset:41984
  ds_read_b128 v[80:83], v10 offset:41984
  ds_read_b128 v[84:87], v10 offset:43008
  v_mfma_f32_32x32x16_bf16 v[32:47], v[96:99], v[88:91], v[32:47]
  s_add_u32 m0, s46, 43008
  s_nop 0
  buffer_load_dwordx4 v3, s[4:7], s47 offen offset:1024 lds
  s_waitcnt lgkmcnt(6)
  v_mfma_f32_32x32x16_bf16 v[16:31], v[104:107], v[100:103], v[16:31]
  ds_read_b128 v[88:91], v9 offset:47104
  ds_read_b128 v[92:95], v10 offset:47104
  ds_read_b128 v[96:99], v10 offset:48128
  v_mfma_f32_32x32x16_bf16 v[32:47], v[108:111], v[100:103], v[32:47]
  s_add_u32 m0, s46, 43008
  s_nop 0
  buffer_load_dwordx4 v3, s[4:7], s47 offen offset:2048 lds
  s_waitcnt lgkmcnt(6)
  v_mfma_f32_32x32x16_bf16 v[16:31], v[68:71], v[64:67], v[16:31]
  ds_read_b128 v[100:103], v9 offset:52224
  ds_read_b128 v[104:107], v10 offset:52224
  ds_read_b128 v[108:111], v10 offset:53248
  v_mfma_f32_32x32x16_bf16 v[32:47], v[72:75], v[64:67], v[32:47]
  buffer_load_dwordx4 v[48:51], v3, s[8:11], s31 offen offset:0 sc1
  s_cmp_lg_u32 s20, 0
  s_cbranch_scc1 p3_lg
  s_waitcnt vmcnt(0)
  s_mov_b32 s53, 0
  s_branch p3_lc
p3_lp:
  buffer_load_dword v125, v124, s[8:11], s54 offen sc1
  s_add_u32 s53, s53, 1
  s_waitcnt vmcnt(0)
p3_lc:
  v_cmp_gt_u32 vcc, 2, v125
  s_cmp_gt_u32 s53, 0x8000
  s_cbranch_scc1 p3_lg
  s_cbranch_vccz p3_lg
  s_sleep 2
  s_branch p3_lp
p3_lg:
  s_waitcnt vmcnt(6)
  s_barrier
  s_waitcnt lgkmcnt(6)
  v_mfma_f32_32x32x16_bf16 v[16:31], v[80:83], v[76:79], v[16:31]
  ds_read_b128 v[64:67], v9 offset:57344
  ds_read_b128 v[68:71], v10 offset:57344
  ds_read_b128 v[72:75], v10 offset:58368
  v_mfma_f32_32x32x16_bf16 v[32:47], v[84:87], v[76:79], v[32:47]
  s_add_u32 m0, s46, 20480
  s_add_u32 s52, s51, 16384
  buffer_load_dwordx4 v3, s[8:11], s52 offen sc1 lds
  s_add_u32 m0, s46, 21504
  s_nop 0
  buffer_load_dwordx4 v2, s[8:11], s52 offen sc1 lds
  s_waitcnt lgkmcnt(6)
  v_mfma_f32_32x32x16_bf16 v[16:31], v[92:95], v[88:91], v[16:31]
  ds_read_b128 v[76:79], v9 offset:62464
  ds_read_b128 v[80:83], v10 offset:62464
  ds_read_b128 v[84:87], v10 offset:63488
  v_mfma_f32_32x32x16_bf16 v[32:47], v[96:99], v[88:91], v[32:47]
  s_add_u32 m0, s46, 40960
  s_add_u32 s52, s51, 20480
  buffer_load_dwordx4 v3, s[8:11], s52 offen sc1 lds
  s_add_u32 m0, s46, 41984
  s_nop 0
  buffer_load_dwordx4 v2, s[8:11], s52 offen sc1 lds
  s_waitcnt lgkmcnt(6)
  v_mfma_f32_32x32x16_bf16 v[16:31], v[104:107], v[100:103], v[16:31]
  ds_read_b128 v[88:91], v11 offset:2048
  ds_read_b128 v[92:95], v14 offset:2048
  ds_read_b128 v[96:99], v14 offset:3072
  v_mfma_f32_32x32x16_bf16 v[32:47], v[108:111], v[100:103], v[32:47]
  buffer_load_dwordx4 v[52:55], v3, s[8:11], s31 offen offset:1024 sc1
  buffer_load_dwordx4 v[56:59], v3, s[8:11], s31 offen offset:2048 sc1
  s_waitcnt lgkmcnt(6)
  v_mfma_f32_32x32x16_bf16 v[16:31], v[68:71], v[64:67], v[16:31]
  ds_read_b128 v[100:103], v11 offset:7168
  ds_read_b128 v[104:107], v14 offset:7168
  ds_read_b128 v[108:111], v14 offset:8192
  v_mfma_f32_32x32x16_bf16 v[32:47], v[72:75], v[64:67], v[32:47]
  buffer_load_dwordx4 v[60:63], v3, s[8:11], s31 offen offset:3072 sc1
  s_add_u32 s47, s45, 73728
  s_add_u32 m0, s46, 63488
  s_nop 0
  buffer_load_dwordx4 v3, s[4:7], s47 offen offset:0 lds
  s_waitcnt vmcnt(12)
  s_barrier
  s_waitcnt lgkmcnt(6)
  v_mfma_f32_32x32x16_bf16 v[16:31], v[80:83], v[76:79], v[16:31]
  ds_read_b128 v[64:67], v4 offset:0
  ds_read_b128 v[68:71], v5 offset:0
  ds_read_b128 v[72:75], v5 offset:1024
  v_mfma_f32_32x32x16_bf16 v[32:47], v[84:87], v[76:79], v[32:47]
  s_add_u32 m0, s46, 63488
  s_nop 0
  buffer_load_dwordx4 v3, s[4:7], s47 offen offset:1024 lds
  s_add_u32 m0, s46, 63488
  s_nop 0
  buffer_load_dwordx4 v3, s[4:7], s47 offen offset:2048 lds
  s_waitcnt lgkmcnt(6)
  v_mfma_f32_32x32x16_bf16 v[16:31], v[92:95], v[88:91], v[16:31]
  ds_read_b128 v[76:79], v4 offset:5120
  ds_read_b128 v[80:83], v5 offset:5120
  ds_read_b128 v[84:87], v5 offset:6144
  v_mfma_f32_32x32x16_bf16 v[32:47], v[96:99], v[88:91], v[32:47]
  s_add_u32 m0, s46, 61440
  s_add_u32 s52, s51, 24576
  buffer_load_dwordx4 v3, s[8:11], s52 offen sc1 lds
  s_add_u32 m0, s46, 62464
  s_nop 0
  buffer_load_dwordx4 v2, s[8:11], s52 offen sc1 lds
  s_waitcnt lgkmcnt(6)
  v_mfma_f32_32x32x16_bf16 v[16:31], v[104:107], v[100:103], v[16:31]
  ds_read_b128 v[88:91], v4 offset:10240
  ds_read_b128 v[92:95], v5 offset:10240
  ds_read_b128 v[96:99], v5 offset:11264
  v_mfma_f32_32x32x16_bf16 v[32:47], v[108:111], v[100:103], v[32:47]
  s_add_u32 s47, s45, 86016
  s_add_u32 m0, s46, 83968
  s_nop 0
  buffer_load_dwordx4 v3, s[4:7], s47 offen offset:0 lds
  s_add_u32 m0, s46, 83968
  s_nop 0
  buffer_load_dwordx4 v3, s[4:7], s47 offen offset:1024 lds
  s_waitcnt lgkmcnt(6)
  v_mfma_f32_32x32x16_bf16 v[16:31], v[68:71], v[64:67], v[16:31]
  ds_read_b128 v[100:103], v4 offset:15360
  ds_read_b128 v[104:107], v5 offset:15360
  ds_read_b128 v[108:111], v5 offset:16384
  v_mfma_f32_32x32x16_bf16 v[32:47], v[72:75], v[64:67], v[32:47]
  s_add_u32 m0, s46, 83968
  s_nop 0
  buffer_load_dwordx4 v3, s[4:7], s47 offen offset:2048 lds
  s_add_u32 m0, s46, 81920
  s_add_u32 s52, s51, 28672
  buffer_load_dwordx4 v3, s[8:11], s52 offen sc1 lds
  s_waitcnt vmcnt(14)
  s_barrier
  s_waitcnt lgkmcnt(6)
  v_mfma_f32_32x32x16_bf16 v[16:31], v[80:83], v[76:79], v[16:31]
  ds_read_b128 v[64:67], v4 offset:20480
  ds_read_b128 v[68:71], v5 offset:20480
  ds_read_b128 v[72:75], v5 offset:21504
  v_mfma_f32_32x32x16_bf16 v[32:47], v[84:87], v[76:79], v[32:47]
  s_add_u32 m0, s46, 82944
  s_nop 0
  buffer_load_dwordx4 v2, s[8:11], s52 offen sc1 lds
  s_add_u32 s47, s45, 98304
  s_add_u32 m0, s46, 104448
  s_nop 0
  buffer_load_dwordx4 v3, s[4:7], s47 offen offset:0 lds
  s_waitcnt lgkmcnt(6)
  v_mfma_f32_32x32x16_bf16 v[16:31], v[92:95], v[88:91], v[16:31]
  ds_read_b128 v[76:79], v4 offset:25600
  ds_read_b128 v[80:83], v5 offset:25600
  ds_read_b128 v[84:87], v5 offset:26624
  v_mfma_f32_32x32x16_bf16 v[32:47], v[96:99], v[88:91], v[32:47]
  s_add_u32 m0, s46, 104448
  s_nop 0
  buffer_load_dwordx4 v3, s[4:7], s47 offen offset:1024 lds
  s_add_u32 m0, s46, 104448
  s_nop 0
  buffer_load_dwordx4 v3, s[4:7], s47 offen offset:2048 lds
  s_waitcnt lgkmcnt(6)
  v_mfma_f32_32x32x16_bf16 v[16:31], v[104:107], v[100:103], v[16:31]
  ds_read_b128 v[88:91], v4 offset:30720
  ds_read_b128 v[92:95], v5 offset:30720
  ds_read_b128 v[96:99], v5 offset:31744
  v_mfma_f32_32x32x16_bf16 v[32:47], v[108:111], v[100:103], v[32:47]
  s_add_u32 m0, s24, 102400
  s_add_u32 s35, s34, 32768
  buffer_load_dwordx4 v8, s[8:11], s34 offen sc1 lds
  s_add_u32 m0, s24, 103424
  s_nop 0
  buffer_load_dwordx4 v8, s[8:11], s35 offen sc1 lds
  s_waitcnt lgkmcnt(6)
  v_mfma_f32_32x32x16_bf16 v[16:31], v[68:71], v[64:67], v[16:31]
  ds_read_b128 v[100:103], v4 offset:35840
  ds_read_b128 v[104:107], v5 offset:35840
  ds_read_b128 v[108:111], v5 offset:36864
  v_mfma_f32_32x32x16_bf16 v[32:47], v[72:75], v[64:67], v[32:47]
  s_waitcnt vmcnt(18)
  s_barrier
  s_waitcnt lgkmcnt(6)
  v_mfma_f32_32x32x16_bf16 v[16:31], v[80:83], v[76:79], v[16:31]
  ds_read_b128 v[64:67], v4 offset:40960
  ds_read_b128 v[68:71], v5 offset:40960
  ds_read_b128 v[72:75], v5 offset:41984
  v_mfma_f32_32x32x16_bf16 v[32:47], v[84:87], v[76:79], v[32:47]
  s_waitcnt lgkmcnt(6)
  v_mfma_f32_32x32x16_bf16 v[16:31], v[92:95], v[88:91], v[16:31]
  ds_read_b128 v[76:79], v4 offset:46080
  ds_read_b128 v[80:83], v5 offset:46080
  ds_read_b128 v[84:87], v5 offset:47104
  v_mfma_f32_32x32x16_bf16 v[32:47], v[96:99], v[88:91], v[32:47]
  s_waitcnt lgkmcnt(6)
  v_mfma_f32_32x32x16_bf16 v[16:31], v[104:107], v[100:103], v[16:31]
  ds_read_b128 v[88:91], v4 offset:51200
  ds_read_b128 v[92:95], v5 offset:51200
  ds_read_b128 v[96:99], v5 offset:52224
  v_mfma_f32_32x32x16_bf16 v[32:47], v[108:111], v[100:103], v[32:47]
  s_waitcnt lgkmcnt(6)
  v_mfma_f32_32x32x16_bf16 v[16:31], v[68:71], v[64:67], v[16:31]
  ds_read_b128 v[100:103], v4 offset:56320
  ds_read_b128 v[104:107], v5 offset:56320
  ds_read_b128 v[108:111], v5 offset:57344
  v_mfma_f32_32x32x16_bf16 v[32:47], v[72:75], v[64:67], v[32:47]
  s_waitcnt vmcnt(10)
  s_barrier
  s_waitcnt lgkmcnt(6)
  v_mfma_f32_32x32x16_bf16 v[16:31], v[80:83], v[76:79], v[16:31]
  ds_read_b128 v[64:67], v4 offset:61440
  ds_read_b128 v[68:71], v5 offset:61440
  ds_read_b128 v[72:75], v5 offset:62464
  v_mfma_f32_32x32x16_bf16 v[32:47], v[84:87], v[76:79], v[32:47]
  s_waitcnt lgkmcnt(6)
  v_mfma_f32_32x32x16_bf16 v[16:31], v[92:95], v[88:91], v[16:31]
  ds_read_b128 v[76:79], v9 offset:1024
  ds_read_b128 v[80:83], v10 offset:1024
  ds_read_b128 v[84:87], v10 offset:2048
  v_mfma_f32_32x32x16_bf16 v[32:47], v[96:99], v[88:91], v[32:47]
  s_waitcnt lgkmcnt(6)
  v_mfma_f32_32x32x16_bf16 v[16:31], v[104:107], v[100:103], v[16:31]
  ds_read_b128 v[88:91], v9 offset:6144
  ds_read_b128 v[92:95], v10 offset:6144
  ds_read_b128 v[96:99], v10 offset:7168
  v_mfma_f32_32x32x16_bf16 v[32:47], v[108:111], v[100:103], v[32:47]
  s_waitcnt lgkmcnt(6)
  v_mfma_f32_32x32x16_bf16 v[16:31], v[68:71], v[64:67], v[16:31]
  ds_read_b128 v[100:103], v9 offset:11264
  ds_read_b128 v[104:107], v10 offset:11264
  ds_read_b128 v[108:111], v10 offset:12288
  v_mfma_f32_32x32x16_bf16 v[32:47], v[72:75], v[64:67], v[32:47]
  s_waitcnt vmcnt(5)
  s_barrier
  s_waitcnt lgkmcnt(6)
  v_mfma_f32_32x32x16_bf16 v[16:31], v[80:83], v[76:79], v[16:31]
  ds_read_b128 v[64:67], v9 offset:16384
  ds_read_b128 v[68:71], v10 offset:16384
  ds_read_b128 v[72:75], v10 offset:17408
  v_mfma_f32_32x32x16_bf16 v[32:47], v[84:87], v[76:79], v[32:47]
  s_waitcnt lgkmcnt(6)
  v_mfma_f32_32x32x16_bf16 v[16:31], v[92:95], v[88:91], v[16:31]
  ds_read_b128 v[76:79], v9 offset:21504
  ds_read_b128 v[80:83], v10 offset:21504
  ds_read_b128 v[84:87], v10 offset:22528
  v_mfma_f32_32x32x16_bf16 v[32:47], v[96:99], v[88:91], v[32:47]
  s_waitcnt lgkmcnt(6)
  v_mfma_f32_32x32x16_bf16 v[16:31], v[104:107], v[100:103], v[16:31]
  ds_read_b128 v[88:91], v9 offset:26624
  ds_read_b128 v[92:95], v10 offset:26624
  ds_read_b128 v[96:99], v10 offset:27648
  v_mfma_f32_32x32x16_bf16 v[32:47], v[108:111], v[100:103], v[32:47]
  s_waitcnt lgkmcnt(6)
  v_mfma_f32_32x32x16_bf16 v[16:31], v[68:71], v[64:67], v[16:31]
  ds_read_b128 v[100:103], v9 offset:31744
  ds_read_b128 v[104:107], v10 offset:31744
  ds_read_b128 v[108:111], v10 offset:32768
  v_mfma_f32_32x32x16_bf16 v[32:47], v[72:75], v[64:67], v[32:47]
  s_waitcnt vmcnt(0)
  s_barrier
  s_waitcnt lgkmcnt(6)
  v_mfma_f32_32x32x16_bf16 v[16:31], v[80:83], v[76:79], v[16:31]
  ds_read2_b64 v[64:67], v15 offset0:0 offset1:64
  ds_read_b128 v[68:71], v10 offset:36864
  ds_read_b128 v[72:75], v10 offset:37888
  v_mfma_f32_32x32x16_bf16 v[32:47], v[84:87], v[76:79], v[32:47]
  s_waitcnt lgkmcnt(6)
  v_mfma_f32_32x32x16_bf16 v[16:31], v[92:95], v[88:91], v[16:31]
  v_add_u32 v15, 5120, v15
  ds_read2_b64 v[76:79], v15 offset0:0 offset1:64
  ds_read_b128 v[80:83], v10 offset:41984
  ds_read_b128 v[84:87], v10 offset:43008
  v_mfma_f32_32x32x16_bf16 v[32:47], v[96:99], v[88:91], v[32:47]
  s_waitcnt lgkmcnt(6)
  v_mfma_f32_32x32x16_bf16 v[16:31], v[104:107], v[100:103], v[16:31]
  v_add_u32 v15, 5120, v15
  ds_read2_b64 v[88:91], v15 offset0:0 offset1:64
  ds_read_b128 v[92:95], v10 offset:47104
  ds_read_b128 v[96:99], v10 offset:48128
  v_mfma_f32_32x32x16_bf16 v[32:47], v[108:111], v[100:103], v[32:47]
  s_waitcnt lgkmcnt(6)
  v_mfma_f32_32x32x16_bf16 v[16:31], v[68:71], v[64:67], v[16:31]
  v_add_u32 v15, 5120, v15
  ds_read2_b64 v[100:103], v15 offset0:0 offset1:64
  ds_read_b128 v[104:107], v10 offset:52224
  ds_read_b128 v[108:111], v10 offset:53248
  v_mfma_f32_32x32x16_bf16 v[32:47], v[72:75], v[64:67], v[32:47]
  s_waitcnt lgkmcnt(6)
  v_mfma_f32_32x32x16_bf16 v[16:31], v[80:83], v[76:79], v[16:31]
  v_mfma_f32_32x32x16_bf16 v[32:47], v[84:87], v[76:79], v[32:47]
  s_waitcnt lgkmcnt(3)
  v_mfma_f32_32x32x16_bf16 v[16:31], v[92:95], v[88:91], v[16:31]
  v_mfma_f32_32x32x16_bf16 v[32:47], v[96:99], v[88:91], v[32:47]
  s_waitcnt lgkmcnt(0)
  v_mfma_f32_32x32x16_bf16 v[16:31], v[104:107], v[100:103], v[16:31]
  v_mfma_f32_32x32x16_bf16 v[32:47], v[108:111], v[100:103], v[32:47]
  s_add_u32 s31, s30, 24117248
  v_mov_b32 v10, 0
  v_mov_b32 v11, 0
  s_nop 7
  v_dot2_f32_bf16 v16, v48, s36, v16
  v_dot2_f32_bf16 v17, v48, s37, v17
  v_dot2_f32_bf16 v18, v49, s36, v18
  v_dot2_f32_bf16 v19, v49, s37, v19
  v_dot2_f32_bf16 v20, v50, s36, v20
  v_dot2_f32_bf16 v21, v50, s37, v21
  v_dot2_f32_bf16 v22, v51, s36, v22
  v_dot2_f32_bf16 v23, v51, s37, v23
  v_cvt_pk_bf16_f32 v112, v16, v17
  v_cvt_pk_bf16_f32 v113, v18, v19
  v_cvt_pk_bf16_f32 v114, v20, v21
  v_cvt_pk_bf16_f32 v115, v22, v23
  buffer_store_dwordx4 v[112:115], v3, s[8:11], s31 offen offset:0 sc1
  v_dot2_f32_bf16 v24, v52, s36, v24
  v_dot2_f32_bf16 v25, v52, s37, v25
  v_dot2_f32_bf16 v26, v53, s36, v26
  v_dot2_f32_bf16 v27, v53, s37, v27
  v_dot2_f32_bf16 v28, v54, s36, v28
  v_dot2_f32_bf16 v29, v54, s37, v29
  v_dot2_f32_bf16 v30, v55, s36, v30
  v_dot2_f32_bf16 v31, v55, s37, v31
  v_cvt_pk_bf16_f32 v116, v24, v25
  v_cvt_pk_bf16_f32 v117, v26, v27
  v_cvt_pk_bf16_f32 v118, v28, v29
  v_cvt_pk_bf16_f32 v119, v30, v31
  buffer_store_dwordx4 v[116:119], v3, s[8:11], s31 offen offset:1024 sc1
  v_dot2_f32_bf16 v32, v56, s36, v32
  v_dot2_f32_bf16 v33, v56, s37, v33
  v_dot2_f32_bf16 v34, v57, s36, v34
  v_dot2_f32_bf16 v35, v57, s37, v35
  v_dot2_f32_bf16 v36, v58, s36, v36
  v_dot2_f32_bf16 v37, v58, s37, v37
  v_dot2_f32_bf16 v38, v59, s36, v38
  v_dot2_f32_bf16 v39, v59, s37, v39
  v_cvt_pk_bf16_f32 v120, v32, v33
  v_cvt_pk_bf16_f32 v121, v34, v35
  v_cvt_pk_bf16_f32 v122, v36, v37
  v_cvt_pk_bf16_f32 v123, v38, v39
  buffer_store_dwordx4 v[120:123], v3, s[8:11], s31 offen offset:2048 sc1
  v_dot2_f32_bf16 v40, v60, s36, v40
  v_dot2_f32_bf16 v41, v60, s37, v41
  v_dot2_f32_bf16 v42, v61, s36, v42
  v_dot2_f32_bf16 v43, v61, s37, v43
  v_dot2_f32_bf16 v44, v62, s36, v44
  v_dot2_f32_bf16 v45, v62, s37, v45
  v_dot2_f32_bf16 v46, v63, s36, v46
  v_dot2_f32_bf16 v47, v63, s37, v47
  v_cvt_pk_bf16_f32 v124, v40, v41
  v_cvt_pk_bf16_f32 v125, v42, v43
  v_cvt_pk_bf16_f32 v126, v44, v45
  v_cvt_pk_bf16_f32 v127, v46, v47
  buffer_store_dwordx4 v[124:127], v3, s[8:11], s31 offen offset:3072 sc1
  v_dot2c_f32_bf16 v10, s38, v112
  v_dot2c_f32_bf16 v11, v112, v112
  v_dot2c_f32_bf16 v10, s38, v113
  v_dot2c_f32_bf16 v11, v113, v113
  v_dot2c_f32_bf16 v10, s38, v114
  v_dot2c_f32_bf16 v11, v114, v114
  v_dot2c_f32_bf16 v10, s38, v115
  v_dot2c_f32_bf16 v11, v115, v115
  v_dot2c_f32_bf16 v10, s38, v116
  v_dot2c_f32_bf16 v11, v116, v116
  v_dot2c_f32_bf16 v10, s38, v117
  v_dot2c_f32_bf16 v11, v117, v117
  v_dot2c_f32_bf16 v10, s38, v118
  v_dot2c_f32_bf16 v11, v118, v118
  v_dot2c_f32_bf16 v10, s38, v119
  v_dot2c_f32_bf16 v11, v119, v119
  v_dot2c_f32_bf16 v10, s38, v120
  v_dot2c_f32_bf16 v11, v120, v120
  v_dot2c_f32_bf16 v10, s38, v121
  v_dot2c_f32_bf16 v11, v121, v121
  v_dot2c_f32_bf16 v10, s38, v122
  v_dot2c_f32_bf16 v11, v122, v122
  v_dot2c_f32_bf16 v10, s38, v123
  v_dot2c_f32_bf16 v11, v123, v123
  v_dot2c_f32_bf16 v10, s38, v124
  v_dot2c_f32_bf16 v11, v124, v124
  v_dot2c_f32_bf16 v10, s38, v125
  v_dot2c_f32_bf16 v11, v125, v125
  v_dot2c_f32_bf16 v10, s38, v126
  v_dot2c_f32_bf16 v11, v126, v126
  v_dot2c_f32_bf16 v10, s38, v127
  v_dot2c_f32_bf16 v11, v127, v127
  s_branch p3_j
p3_one:
  s_waitcnt vmcnt(6)
  s_barrier
  ds_read_b128 v[64:67], v9 offset:16384
  ds_read_b128 v[68:71], v10 offset:16384
  ds_read_b128 v[76:79], v9 offset:21504
  ds_read_b128 v[80:83], v10 offset:21504
  ds_read_b128 v[88:91], v9 offset:26624
  ds_read_b128 v[92:95], v10 offset:26624
  s_waitcnt lgkmcnt(4)
  v_mfma_f32_32x32x16_bf16 v[16:31], v[68:71], v[64:67], 0
  ds_read_b128 v[100:103], v9 offset:31744
  ds_read_b128 v[104:107], v10 offset:31744
  s_waitcnt vmcnt(4)
  s_barrier
  s_waitcnt lgkmcnt(4)
  v_mfma_f32_32x32x16_bf16 v[16:31], v[80:83], v[76:79], v[16:31]
  ds_read_b128 v[64:67], v9 offset:36864
  ds_read_b128 v[68:71], v10 offset:36864
  s_add_u32 s47, s45, 61440
  s_add_u32 m0, s46, 43008
  s_nop 0
  buffer_load_dwordx4 v3, s[4:7], s47 offen offset:0 lds
  s_waitcnt lgkmcnt(4)
  v_mfma_f32_32x32x16_bf16 v[16:31], v[92:95], v[88:91], v[16:31]
  ds_read_b128 v[76:79], v9 offset:41984
  ds_read_b128 v[80:83], v10 offset:41984
  s_add_u32 m0, s46, 43008
  s_nop 0
  buffer_load_dwordx4 v3, s[4:7], s47 offen offset:1024 lds
  s_waitcnt lgkmcnt(4)
  v_mfma_f32_32x32x16_bf16 v[16:31], v[104:107], v[100:103], v[16:31]
  ds_read_b128 v[88:91], v9 offset:47104
  ds_read_b128 v[92:95], v10 offset:47104
  s_add_u32 m0, s46, 43008
  s_nop 0
  buffer_load_dwordx4 v3, s[4:7], s47 offen offset:2048 lds
  s_waitcnt lgkmcnt(4)
  v_mfma_f32_32x32x16_bf16 v[16:31], v[68:71], v[64:67], v[16:31]
  ds_read_b128 v[100:103], v9 offset:52224
  ds_read_b128 v[104:107], v10 offset:52224
  buffer_load_dwordx4 v[48:51], v3, s[8:11], s31 offen offset:0 sc1
  s_waitcnt vmcnt(6)
  s_barrier
  s_waitcnt lgkmcnt(4)
  v_mfma_f32_32x32x16_bf16 v[16:31], v[80:83], v[76:79], v[16:31]
  ds_read_b128 v[64:67], v9 offset:57344
  ds_read_b128 v[68:71], v10 offset:57344
  s_add_u32 m0, s46, 20480
  s_add_u32 s52, s51, 16384
  buffer_load_dwordx4 v3, s[8:11], s52 offen sc1 lds
  s_add_u32 m0, s46, 21504
  s_nop 0
  buffer_load_dwordx4 v2, s[8:11], s52 offen sc1 lds
  s_waitcnt lgkmcnt(4)
  v_mfma_f32_32x32x16_bf16 v[16:31], v[92:95], v[88:91], v[16:31]
  ds_read_b128 v[76:79], v9 offset:62464
  ds_read_b128 v[80:83], v10 offset:62464
  s_add_u32 m0, s46, 40960
  s_add_u32 s52, s51, 20480
  buffer_load_dwordx4 v3, s[8:11], s52 offen sc1 lds
  s_add_u32 m0, s46, 41984
  s_nop 0
  buffer_load_dwordx4 v2, s[8:11], s52 offen sc1 lds
  s_waitcnt lgkmcnt(4)
  v_mfma_f32_32x32x16_bf16 v[16:31], v[104:107], v[100:103], v[16:31]
  ds_read_b128 v[88:91], v11 offset:2048
  ds_read_b128 v[92:95], v14 offset:2048
  buffer_load_dwordx4 v[52:55], v3, s[8:11], s31 offen offset:1024 sc1
  s_add_u32 s47, s45, 73728
  s_add_u32 m0, s46, 63488
  s_nop 0
  buffer_load_dwordx4 v3, s[4:7], s47 offen offset:0 lds
  s_waitcnt lgkmcnt(4)
  v_mfma_f32_32x32x16_bf16 v[16:31], v[68:71], v[64:67], v[16:31]
  ds_read_b128 v[100:103], v11 offset:7168
  ds_read_b128 v[104:107], v14 offset:7168
  s_add_u32 m0, s46, 63488
  s_nop 0
  buffer_load_dwordx4 v3, s[4:7], s47 offen offset:1024 lds
  s_add_u32 m0, s46, 63488
  s_nop 0
  buffer_load_dwordx4 v3, s[4:7], s47 offen offset:2048 lds
  s_waitcnt vmcnt(12)
  s_barrier
  s_waitcnt lgkmcnt(4)
  v_mfma_f32_32x32x16_bf16 v[16:31], v[80:83], v[76:79], v[16:31]
  ds_read_b128 v[64:67], v4 offset:0
  ds_read_b128 v[68:71], v5 offset:0
  s_add_u32 m0, s46, 61440
  s_add_u32 s52, s51, 24576
  buffer_load_dwordx4 v3, s[8:11], s52 offen sc1 lds
  s_add_u32 m0, s46, 62464
  s_nop 0
  buffer_load_dwordx4 v2, s[8:11], s52 offen sc1 lds
  s_waitcnt lgkmcnt(4)
  v_mfma_f32_32x32x16_bf16 v[16:31], v[92:95], v[88:91], v[16:31]
  ds_read_b128 v[76:79], v4 offset:5120
  ds_read_b128 v[80:83], v5 offset:5120
  s_add_u32 s47, s45, 86016
  s_add_u32 m0, s46, 83968
  s_nop 0
  buffer_load_dwordx4 v3, s[4:7], s47 offen offset:0 lds
  s_add_u32 m0, s46, 83968
  s_nop 0
  buffer_load_dwordx4 v3, s[4:7], s47 offen offset:1024 lds
  s_waitcnt lgkmcnt(4)
  v_mfma_f32_32x32x16_bf16 v[16:31], v[104:107], v[100:103], v[16:31]
  ds_read_b128 v[88:91], v4 offset:10240
  ds_read_b128 v[92:95], v5 offset:10240
  s_add_u32 m0, s46, 83968
  s_nop 0
  buffer_load_dwordx4 v3, s[4:7], s47 offen offset:2048 lds
  s_add_u32 m0, s46, 81920
  s_add_u32 s52, s51, 28672
  buffer_load_dwordx4 v3, s[8:11], s52 offen sc1 lds
  s_waitcnt lgkmcnt(4)
  v_mfma_f32_32x32x16_bf16 v[16:31], v[68:71], v[64:67], v[16:31]
  ds_read_b128 v[100:103], v4 offset:15360
  ds_read_b128 v[104:107], v5 offset:15360
  s_add_u32 m0, s46, 82944
  s_nop 0
  buffer_load_dwordx4 v2, s[8:11], s52 offen sc1 lds
  s_waitcnt vmcnt(13)
  s_barrier
  s_waitcnt lgkmcnt(4)
  v_mfma_f32_32x32x16_bf16 v[16:31], v[80:83], v[76:79], v[16:31]
  ds_read_b128 v[64:67], v4 offset:20480
  ds_read_b128 v[68:71], v5 offset:20480
  s_add_u32 s47, s45, 98304
  s_add_u32 m0, s46, 104448
  s_nop 0
  buffer_load_dwordx4 v3, s[4:7], s47 offen offset:0 lds
  s_add_u32 m0, s46, 104448
  s_nop 0
  buffer_load_dwordx4 v3, s[4:7], s47 offen offset:1024 lds
  s_waitcnt lgkmcnt(4)
  v_mfma_f32_32x32x16_bf16 v[16:31], v[92:95], v[88:91], v[16:31]
  ds_read_b128 v[76:79], v4 offset:25600
  ds_read_b128 v[80:83], v5 offset:25600
  s_add_u32 m0, s46, 104448
  s_nop 0
  buffer_load_dwordx4 v3, s[4:7], s47 offen offset:2048 lds
  s_add_u32 m0, s24, 102400
  s_add_u32 s35, s34, 32768
  buffer_load_dwordx4 v8, s[8:11], s34 offen sc1 lds
  s_waitcnt lgkmcnt(4)
  v_mfma_f32_32x32x16_bf16 v[16:31], v[104:107], v[100:103], v[16:31]
  ds_read_b128 v[88:91], v4 offset:30720
  ds_read_b128 v[92:95], v5 offset:30720
  s_add_u32 m0, s24, 103424
  s_nop 0
  buffer_load_dwordx4 v8, s[8:11], s35 offen sc1 lds
  s_waitcnt lgkmcnt(4)
  v_mfma_f32_32x32x16_bf16 v[16:31], v[68:71], v[64:67], v[16:31]
  ds_read_b128 v[100:103], v4 offset:35840
  ds_read_b128 v[104:107], v5 offset:35840
  s_waitcnt vmcnt(16)
  s_barrier
  s_waitcnt lgkmcnt(4)
  v_mfma_f32_32x32x16_bf16 v[16:31], v[80:83], v[76:79], v[16:31]
  ds_read_b128 v[64:67], v4 offset:40960
  ds_read_b128 v[68:71], v5 offset:40960
  s_waitcnt lgkmcnt(4)
  v_mfma_f32_32x32x16_bf16 v[16:31], v[92:95], v[88:91], v[16:31]
  ds_read_b128 v[76:79], v4 offset:46080
  ds_read_b128 v[80:83], v5 offset:46080
  s_waitcnt lgkmcnt(4)
  v_mfma_f32_32x32x16_bf16 v[16:31], v[104:107], v[100:103], v[16:31]
  ds_read_b128 v[88:91], v4 offset:51200
  ds_read_b128 v[92:95], v5 offset:51200
  s_waitcnt lgkmcnt(4)
  v_mfma_f32_32x32x16_bf16 v[16:31], v[68:71], v[64:67], v[16:31]
  ds_read_b128 v[100:103], v4 offset:56320
  ds_read_b128 v[104:107], v5 offset:56320
  s_waitcnt vmcnt(10)
  s_barrier
  s_waitcnt lgkmcnt(4)
  v_mfma_f32_32x32x16_bf16 v[16:31], v[80:83], v[76:79], v[16:31]
  ds_read_b128 v[64:67], v4 offset:61440
  ds_read_b128 v[68:71], v5 offset:61440
  s_waitcnt lgkmcnt(4)
  v_mfma_f32_32x32x16_bf16 v[16:31], v[92:95], v[88:91], v[16:31]
  ds_read_b128 v[76:79], v9 offset:1024
  ds_read_b128 v[80:83], v10 offset:1024
  s_waitcnt lgkmcnt(4)
  v_mfma_f32_32x32x16_bf16 v[16:31], v[104:107], v[100:103], v[16:31]
  ds_read_b128 v[88:91], v9 offset:6144
  ds_read_b128 v[92:95], v10 offset:6144
  s_waitcnt lgkmcnt(4)
  v_mfma_f32_32x32x16_bf16 v[16:31], v[68:71], v[64:67], v[16:31]
  ds_read_b128 v[100:103], v9 offset:11264
  ds_read_b128 v[104:107], v10 offset:11264
  s_waitcnt vmcnt(5)
  s_barrier
  s_waitcnt lgkmcnt(4)
  v_mfma_f32_32x32x16_bf16 v[16:31], v[80:83], v[76:79], v[16:31]
  ds_read_b128 v[64:67], v9 offset:16384
  ds_read_b128 v[68:71], v10 offset:16384
  s_waitcnt lgkmcnt(4)
  v_mfma_f32_32x32x16_bf16 v[16:31], v[92:95], v[88:91], v[16:31]
  ds_read_b128 v[76:79], v9 offset:21504
  ds_read_b128 v[80:83], v10 offset:21504
  s_waitcnt lgkmcnt(4)
  v_mfma_f32_32x32x16_bf16 v[16:31], v[104:107], v[100:103], v[16:31]
  ds_read_b128 v[88:91], v9 offset:26624
  ds_read_b128 v[92:95], v10 offset:26624
  s_waitcnt lgkmcnt(4)
  v_mfma_f32_32x32x16_bf16 v[16:31], v[68:71], v[64:67], v[16:31]
  ds_read_b128 v[100:103], v9 offset:31744
  ds_read_b128 v[104:107], v10 offset:31744
  s_waitcnt vmcnt(0)
  s_barrier
  s_waitcnt lgkmcnt(4)
  v_mfma_f32_32x32x16_bf16 v[16:31], v[80:83], v[76:79], v[16:31]
  ds_read2_b64 v[64:67], v15 offset0:0 offset1:64
  ds_read_b128 v[68:71], v10 offset:36864
  s_waitcnt lgkmcnt(4)
  v_mfma_f32_32x32x16_bf16 v[16:31], v[92:95], v[88:91], v[16:31]
  v_add_u32 v15, 5120, v15
  ds_read2_b64 v[76:79], v15 offset0:0 offset1:64
  ds_read_b128 v[80:83], v10 offset:41984
  s_waitcnt lgkmcnt(4)
  v_mfma_f32_32x32x16_bf16 v[16:31], v[104:107], v[100:103], v[16:31]
  v_add_u32 v15, 5120, v15
  ds_read2_b64 v[88:91], v15 offset0:0 offset1:64
  ds_read_b128 v[92:95], v10 offset:47104
  s_waitcnt lgkmcnt(4)
  v_mfma_f32_32x32x16_bf16 v[16:31], v[68:71], v[64:67], v[16:31]
  v_add_u32 v15, 5120, v15
  ds_read2_b64 v[100:103], v15 offset0:0 offset1:64
  ds_read_b128 v[104:107], v10 offset:52224
  s_waitcnt lgkmcnt(4)
  v_mfma_f32_32x32x16_bf16 v[16:31], v[80:83], v[76:79], v[16:31]
  s_waitcnt lgkmcnt(2)
  v_mfma_f32_32x32x16_bf16 v[16:31], v[92:95], v[88:91], v[16:31]
  s_waitcnt lgkmcnt(0)
  v_mfma_f32_32x32x16_bf16 v[16:31], v[104:107], v[100:103], v[16:31]
  s_add_u32 s31, s30, 24117248
  v_mov_b32 v10, 0
  v_mov_b32 v11, 0
  s_nop 8
  v_dot2_f32_bf16 v16, v48, s36, v16
  v_dot2_f32_bf16 v17, v48, s37, v17
  v_dot2_f32_bf16 v18, v49, s36, v18
  v_dot2_f32_bf16 v19, v49, s37, v19
  v_dot2_f32_bf16 v20, v50, s36, v20
  v_dot2_f32_bf16 v21, v50, s37, v21
  v_dot2_f32_bf16 v22, v51, s36, v22
  v_dot2_f32_bf16 v23, v51, s37, v23
  v_cvt_pk_bf16_f32 v112, v16, v17
  v_cvt_pk_bf16_f32 v113, v18, v19
  v_cvt_pk_bf16_f32 v114, v20, v21
  v_cvt_pk_bf16_f32 v115, v22, v23
  buffer_store_dwordx4 v[112:115], v3, s[8:11], s31 offen offset:0 sc1
  v_dot2_f32_bf16 v24, v52, s36, v24
  v_dot2_f32_bf16 v25, v52, s37, v25
  v_dot2_f32_bf16 v26, v53, s36, v26
  v_dot2_f32_bf16 v27, v53, s37, v27
  v_dot2_f32_bf16 v28, v54, s36, v28
  v_dot2_f32_bf16 v29, v54, s37, v29
  v_dot2_f32_bf16 v30, v55, s36, v30
  v_dot2_f32_bf16 v31, v55, s37, v31
  v_cvt_pk_bf16_f32 v116, v24, v25
  v_cvt_pk_bf16_f32 v117, v26, v27
  v_cvt_pk_bf16_f32 v118, v28, v29
  v_cvt_pk_bf16_f32 v119, v30, v31
  buffer_store_dwordx4 v[116:119], v3, s[8:11], s31 offen offset:1024 sc1
  v_dot2c_f32_bf16 v10, s38, v112
  v_dot2c_f32_bf16 v11, v112, v112
  v_dot2c_f32_bf16 v10, s38, v113
  v_dot2c_f32_bf16 v11, v113, v113
  v_dot2c_f32_bf16 v10, s38, v114
  v_dot2c_f32_bf16 v11, v114, v114
  v_dot2c_f32_bf16 v10, s38, v115
  v_dot2c_f32_bf16 v11, v115, v115
  v_dot2c_f32_bf16 v10, s38, v116
  v_dot2c_f32_bf16 v11, v116, v116
  v_dot2c_f32_bf16 v10, s38, v117
  v_dot2c_f32_bf16 v11, v117, v117
  v_dot2c_f32_bf16 v10, s38, v118
  v_dot2c_f32_bf16 v11, v118, v118
  v_dot2c_f32_bf16 v10, s38, v119
  v_dot2c_f32_bf16 v11, v119, v119
p3_j:
  s_nop 2
  v_mov_b32 v4, v10
  v_mov_b32 v5, v11
  s_nop 1
  v_permlane32_swap_b32 v4, v10
  v_permlane32_swap_b32 v5, v11
  v_add_f32 v10, v10, v4
  v_add_f32 v11, v11, v5
  buffer_store_dwordx2 v[10:11], v6, s[8:11], s32 offen sc1
  s_lshl_b32 s48, s18, 3
  s_add_u32 s48, s48, s19
  s_lshl_b32 s48, s48, 6
  s_add_u32 s48, s48, 83918848
  s_mov_b32 s3, 0
main_p4:
  s_and_b32 s18, s2, 1
  s_lshl_b32 s18, s18, 2
  s_bfe_u32 s19, s2, 0x20003
  s_add_u32 s18, s18, s19
  s_bfe_u32 s19, s2, 0x20001
  s_lshl_b32 s19, s19, 3
  s_lshr_b32 s17, s2, 5
  s_add_u32 s19, s19, s17
  s_lshl_b32 s18, s18, 3
  s_lshl_b32 s21, s20, 1
  s_add_u32 s18, s18, s21
  s_mul_i32 s23, s19, 331776
  s_add_u32 s23, s23, 3145728
  s_mul_i32 s32, s20, 4096
  s_mul_i32 s33, s20, 9216
  s_cmp_lg_u32 s3, 0
  s_cbranch_scc1 p4_np
  v_mov_b32 v12, 1
  v_min_u32 v13, 1, v0
  v_lshlrev_b32 v13, 31, v13
  s_waitcnt vmcnt(0)
  s_barrier
  buffer_store_dword v12, v13, s[8:11], s48 offen sc1
p4_np:
  s_cmp_eq_u32 s20, 0
  s_cbranch_scc1 p4_xw
  s_sub_u32 s24, s20, 1
  s_mul_i32 s21, s24, 16384
  s_add_u32 m0, s21, 0
  s_add_u32 s24, m0, s23
  buffer_load_dwordx4 v3, s[4:7], s24 offen offset:0 lds
  buffer_load_dwordx4 v3, s[4:7], s24 offen offset:1024 lds
  buffer_load_dwordx4 v3, s[4:7], s24 offen offset:2048 lds
  buffer_load_dwordx4 v3, s[4:7], s24 offen offset:3072 lds
  s_add_u32 m0, s21, 4096
  s_add_u32 s24, m0, s23
  buffer_load_dwordx4 v3, s[4:7], s24 offen offset:0 lds
  buffer_load_dwordx4 v3, s[4:7], s24 offen offset:1024 lds
  buffer_load_dwordx4 v3, s[4:7], s24 offen offset:2048 lds
  buffer_load_dwordx4 v3, s[4:7], s24 offen offset:3072 lds
  s_add_u32 m0, s21, 8192
  s_add_u32 s24, m0, s23
  buffer_load_dwordx4 v3, s[4:7], s24 offen offset:0 lds
  buffer_load_dwordx4 v3, s[4:7], s24 offen offset:1024 lds
  buffer_load_dwordx4 v3, s[4:7], s24 offen offset:2048 lds
  buffer_load_dwordx4 v3, s[4:7], s24 offen offset:3072 lds
  s_add_u32 m0, s21, 12288
  s_add_u32 s24, m0, s23
  buffer_load_dwordx4 v3, s[4:7], s24 offen offset:0 lds
  buffer_load_dwordx4 v3, s[4:7], s24 offen offset:1024 lds
  buffer_load_dwordx4 v3, s[4:7], s24 offen offset:2048 lds
  buffer_load_dwordx4 v3, s[4:7], s24 offen offset:3072 lds
  s_add_u32 m0, s21, 49152
  s_add_u32 s24, m0, s23
  buffer_load_dwordx4 v3, s[4:7], s24 offen offset:0 lds
  buffer_load_dwordx4 v3, s[4:7], s24 offen offset:1024 lds
  buffer_load_dwordx4 v3, s[4:7], s24 offen offset:2048 lds
  buffer_load_dwordx4 v3, s[4:7], s24 offen offset:3072 lds
  s_add_u32 m0, s21, 53248
  s_add_u32 s24, m0, s23
  buffer_load_dwordx4 v3, s[4:7], s24 offen offset:0 lds
  buffer_load_dwordx4 v3, s[4:7], s24 offen offset:1024 lds
  buffer_load_dwordx4 v3, s[4:7], s24 offen offset:2048 lds
  buffer_load_dwordx4 v3, s[4:7], s24 offen offset:3072 lds
  s_add_u32 m0, s21, 57344
  s_add_u32 s24, m0, s23
  buffer_load_dwordx4 v3, s[4:7], s24 offen offset:0 lds
  buffer_load_dwordx4 v3, s[4:7], s24 offen offset:1024 lds
  buffer_load_dwordx4 v3, s[4:7], s24 offen offset:2048 lds
  buffer_load_dwordx4 v3, s[4:7], s24 offen offset:3072 lds
  s_add_u32 m0, s21, 61440
  s_add_u32 s24, m0, s23
  buffer_load_dwordx4 v3, s[4:7], s24 offen offset:0 lds
  buffer_load_dwordx4 v3, s[4:7], s24 offen offset:1024 lds
  buffer_load_dwordx4 v3, s[4:7], s24 offen offset:2048 lds
  buffer_load_dwordx4 v3, s[4:7], s24 offen offset:3072 lds
  s_branch p4_xg
p4_xw:
  s_lshr_b32 s29, s18, 3
  s_lshl_b32 s29, s29, 11
  s_add_u32 s29, s29, 83918848
  v_and_b32 v6, 7, v1
  v_min_u32 v6, 5, v6
  v_and_b32 v7, 24, v1
  v_add_u32 v6, v6, v7
  v_lshlrev_b32 v6, 6, v6
  s_mov_b32 s53, 0
p4_xp:
  s_sleep 2
  buffer_load_dword v16, v6, s[8:11], s29 offen sc1
  s_add_u32 s53, s53, 1
  s_waitcnt vmcnt(0)
  v_cmp_gt_u32 vcc, 1, v16
  s_cmp_gt_u32 s53, 0x8000
  s_cbranch_scc1 p4_xg
  s_cbranch_vccnz p4_xp
p4_xg:
  s_mul_i32 s21, s18, 36864
  s_add_u32 s21, s21, 24117248
  s_add_u32 s22, s21, 36864
  s_barrier
  v_and_b32 v6, 31, v1
  v_lshrrev_b32 v7, 5, v1
  buffer_load_dwordx4 a[0:3], v3, s[8:11], s21 offen offset:0 sc1
  buffer_load_dwordx4 a[4:7], v3, s[8:11], s22 offen offset:0 sc1
  buffer_load_dwordx4 a[8:11], v3, s[8:11], s21 offen offset:1024 sc1
  buffer_load_dwordx4 a[12:15], v3, s[8:11], s22 offen offset:1024 sc1
  buffer_load_dwordx4 a[16:19], v3, s[8:11], s21 offen offset:2048 sc1
  buffer_load_dwordx4 a[20:23], v3, s[8:11], s22 offen offset:2048 sc1
  buffer_load_dwordx4 a[24:27], v3, s[8:11], s21 offen offset:3072 sc1
  s_add_u32 s21, s21, 4096
  buffer_load_dwordx4 a[28:31], v3, s[8:11], s22 offen offset:3072 sc1
  s_add_u32 s22, s22, 4096
  buffer_load_dwordx4 a[32:35], v3, s[8:11], s21 offen offset:0 sc1
  buffer_load_dwordx4 a[36:39], v3, s[8:11], s22 offen offset:0 sc1
  v_add_u32 v4, 0x10000, v3
  v_add_u32 v9, 0x20000, v3
  v_mul_u32_u24 v5, 98304, v7
  v_lshl_add_u32 v5, v6, 3, v5
  s_lshl_b32 s25, s18, 8
  s_add_u32 s25, s25, 48234496
  v_lshrrev_b32 v8, 4, v6
  v_mul_u32_u24 v8, 147456, v8
  v_and_b32 v6, 15, v6
  v_lshl_add_u32 v8, v6, 4, v8
  v_lshl_add_u32 v8, v7, 8, v8
  s_mul_i32 s26, s18, 294912
  s_mul_i32 s27, s19, 4608
  s_add_u32 s26, s26, s27
  s_add_u32 s26, s26, 50331648
  s_add_u32 s27, s26, 294912
  s_add_u32 s28, s26, 4096
  s_add_u32 s29, s27, 4096
  s_waitcnt vmcnt(26)
  s_barrier
  ds_read_b128 v[208:211], v3 offset:0
  ds_read_b128 v[212:215], v3 offset:1024
  ds_read_b128 v[216:219], v3 offset:2048
  ds_read_b128 v[220:223], v3 offset:3072
  s_waitcnt vmcnt(8) lgkmcnt(3)
  v_mfma_f32_32x32x16_bf16 v[46:61], v[208:211], a[0:3], 0
  ds_read_b128 v[224:227], v3 offset:4096
  v_mfma_f32_32x32x16_bf16 v[62:77], v[208:211], a[4:7], 0
  buffer_load_dwordx4 a[40:43], v3, s[8:11], s21 offen offset:1024 sc1
  s_waitcnt lgkmcnt(3)
  v_mfma_f32_32x32x16_bf16 v[78:93], v[212:215], a[0:3], 0
  ds_read_b128 v[208:211], v3 offset:5120
  v_mfma_f32_32x32x16_bf16 v[94:109], v[212:215], a[4:7], 0
  buffer_load_dwordx4 a[44:47], v3, s[8:11], s22 offen offset:1024 sc1
  s_waitcnt lgkmcnt(3)
  v_mfma_f32_32x32x16_bf16 v[110:125], v[216:219], a[0:3], 0
  ds_read_b128 v[212:215], v3 offset:6144
  v_mfma_f32_32x32x16_bf16 v[126:141], v[216:219], a[4:7], 0
  buffer_load_dwordx4 a[48:51], v3, s[8:11], s21 offen offset:2048 sc1
  s_waitcnt lgkmcnt(3)
  v_mfma_f32_32x32x16_bf16 v[142:157], v[220:223], a[0:3], 0
  ds_read_b128 v[216:219], v3 offset:7168
  v_mfma_f32_32x32x16_bf16 v[158:173], v[220:223], a[4:7], 0
  buffer_load_dwordx4 a[52:55], v3, s[8:11], s22 offen offset:2048 sc1
  s_waitcnt vmcnt(10) lgkmcnt(3)
  v_mfma_f32_32x32x16_bf16 v[46:61], v[224:227], a[8:11], v[46:61]
  ds_read_b128 v[220:223], v3 offset:8192
  v_mfma_f32_32x32x16_bf16 v[62:77], v[224:227], a[12:15], v[62:77]
  buffer_load_dwordx4 a[56:59], v3, s[8:11], s21 offen offset:3072 sc1
  s_add_u32 s21, s21, 4096
  s_waitcnt lgkmcnt(3)
  v_mfma_f32_32x32x16_bf16 v[78:93], v[208:211], a[8:11], v[78:93]
  ds_read_b128 v[224:227], v3 offset:9216
  v_mfma_f32_32x32x16_bf16 v[94:109], v[208:211], a[12:15], v[94:109]
  buffer_load_dwordx4 a[60:63], v3, s[8:11], s22 offen offset:3072 sc1
  s_add_u32 s22, s22, 4096
  s_waitcnt lgkmcnt(3)
  v_mfma_f32_32x32x16_bf16 v[110:125], v[212:215], a[8:11], v[110:125]
  ds_read_b128 v[208:211], v3 offset:10240
  v_mfma_f32_32x32x16_bf16 v[126:141], v[212:215], a[12:15], v[126:141]
  buffer_load_dwordx4 a[64:67], v3, s[8:11], s21 offen offset:0 sc1
  s_waitcnt lgkmcnt(3)
  v_mfma_f32_32x32x16_bf16 v[142:157], v[216:219], a[8:11], v[142:157]
  ds_read_b128 v[212:215], v3 offset:11264
  v_mfma_f32_32x32x16_bf16 v[158:173], v[216:219], a[12:15], v[158:173]
  buffer_load_dwordx4 a[68:71], v3, s[8:11], s22 offen offset:0 sc1
  s_waitcnt vmcnt(12) lgkmcnt(3)
  v_mfma_f32_32x32x16_bf16 v[46:61], v[220:223], a[16:19], v[46:61]
  ds_read_b128 v[216:219], v3 offset:12288
  v_mfma_f32_32x32x16_bf16 v[62:77], v[220:223], a[20:23], v[62:77]
  buffer_load_dwordx4 a[72:75], v3, s[8:11], s21 offen offset:1024 sc1
  s_waitcnt lgkmcnt(3)
  v_mfma_f32_32x32x16_bf16 v[78:93], v[224:227], a[16:19], v[78:93]
  ds_read_b128 v[220:223], v3 offset:13312
  v_mfma_f32_32x32x16_bf16 v[94:109], v[224:227], a[20:23], v[94:109]
  buffer_load_dwordx4 a[76:79], v3, s[8:11], s22 offen offset:1024 sc1
  s_waitcnt lgkmcnt(3)
  v_mfma_f32_32x32x16_bf16 v[110:125], v[208:211], a[16:19], v[110:125]
  ds_read_b128 v[224:227], v3 offset:14336
  v_mfma_f32_32x32x16_bf16 v[126:141], v[208:211], a[20:23], v[126:141]
  buffer_load_dwordx4 a[80:83], v3, s[8:11], s21 offen offset:2048 sc1
  s_waitcnt lgkmcnt(3)
  v_mfma_f32_32x32x16_bf16 v[142:157], v[212:215], a[16:19], v[142:157]
  ds_read_b128 v[208:211], v3 offset:15360
  v_mfma_f32_32x32x16_bf16 v[158:173], v[212:215], a[20:23], v[158:173]
  buffer_load_dwordx4 a[84:87], v3, s[8:11], s22 offen offset:2048 sc1
  s_waitcnt vmcnt(14) lgkmcnt(3)
  v_mfma_f32_32x32x16_bf16 v[46:61], v[216:219], a[24:27], v[46:61]
  ds_read_b128 v[212:215], v3 offset:16384
  v_mfma_f32_32x32x16_bf16 v[62:77], v[216:219], a[28:31], v[62:77]
  buffer_load_dwordx4 a[88:91], v3, s[8:11], s21 offen offset:3072 sc1
  s_add_u32 s21, s21, 4096
  s_waitcnt lgkmcnt(3)
  v_mfma_f32_32x32x16_bf16 v[78:93], v[220:223], a[24:27], v[78:93]
  ds_read_b128 v[216:219], v3 offset:17408
  v_mfma_f32_32x32x16_bf16 v[94:109], v[220:223], a[28:31], v[94:109]
  buffer_load_dwordx4 a[92:95], v3, s[8:11], s22 offen offset:3072 sc1
  s_add_u32 s22, s22, 4096
  s_waitcnt lgkmcnt(3)
  v_mfma_f32_32x32x16_bf16 v[110:125], v[224:227], a[24:27], v[110:125]
  ds_read_b128 v[220:223], v3 offset:18432
  v_mfma_f32_32x32x16_bf16 v[126:141], v[224:227], a[28:31], v[126:141]
  s_waitcnt lgkmcnt(3)
  v_mfma_f32_32x32x16_bf16 v[142:157], v[208:211], a[24:27], v[142:157]
  ds_read_b128 v[224:227], v3 offset:19456
  v_mfma_f32_32x32x16_bf16 v[158:173], v[208:211], a[28:31], v[158:173]
  buffer_load_dwordx4 a[96:99], v3, s[8:11], s21 offen offset:0 sc1
  s_waitcnt vmcnt(15) lgkmcnt(3)
  v_mfma_f32_32x32x16_bf16 v[46:61], v[212:215], a[32:35], v[46:61]
  ds_read_b128 v[208:211], v3 offset:20480
  v_mfma_f32_32x32x16_bf16 v[62:77], v[212:215], a[36:39], v[62:77]
  buffer_load_dwordx4 a[100:103], v3, s[8:11], s22 offen offset:0 sc1
  s_waitcnt lgkmcnt(3)
  v_mfma_f32_32x32x16_bf16 v[78:93], v[216:219], a[32:35], v[78:93]
  ds_read_b128 v[212:215], v3 offset:21504
  v_mfma_f32_32x32x16_bf16 v[94:109], v[216:219], a[36:39], v[94:109]
  s_waitcnt lgkmcnt(3)
  v_mfma_f32_32x32x16_bf16 v[110:125], v[220:223], a[32:35], v[110:125]
  ds_read_b128 v[216:219], v3 offset:22528
  v_mfma_f32_32x32x16_bf16 v[126:141], v[220:223], a[36:39], v[126:141]
  s_waitcnt lgkmcnt(3)
  v_mfma_f32_32x32x16_bf16 v[142:157], v[224:227], a[32:35], v[142:157]
  ds_read_b128 v[220:223], v3 offset:23552
  v_mfma_f32_32x32x16_bf16 v[158:173], v[224:227], a[36:39], v[158:173]
  buffer_load_dwordx4 a[104:107], v3, s[8:11], s21 offen offset:1024 sc1
  s_waitcnt vmcnt(15) lgkmcnt(3)
  v_mfma_f32_32x32x16_bf16 v[46:61], v[208:211], a[40:43], v[46:61]
  ds_read_b128 v[224:227], v3 offset:24576
  v_mfma_f32_32x32x16_bf16 v[62:77], v[208:211], a[44:47], v[62:77]
  buffer_load_dwordx4 a[108:111], v3, s[8:11], s22 offen offset:1024 sc1
  s_waitcnt lgkmcnt(3)
  v_mfma_f32_32x32x16_bf16 v[78:93], v[212:215], a[40:43], v[78:93]
  ds_read_b128 v[208:211], v3 offset:25600
  v_mfma_f32_32x32x16_bf16 v[94:109], v[212:215], a[44:47], v[94:109]
  s_waitcnt lgkmcnt(3)
  v_mfma_f32_32x32x16_bf16 v[110:125], v[216:219], a[40:43], v[110:125]
  ds_read_b128 v[212:215], v3 offset:26624
  v_mfma_f32_32x32x16_bf16 v[126:141], v[216:219], a[44:47], v[126:141]
  s_waitcnt lgkmcnt(3)
  v_mfma_f32_32x32x16_bf16 v[142:157], v[220:223], a[40:43], v[142:157]
  ds_read_b128 v[216:219], v3 offset:27648
  v_mfma_f32_32x32x16_bf16 v[158:173], v[220:223], a[44:47], v[158:173]
  buffer_load_dwordx4 a[112:115], v3, s[8:11], s21 offen offset:2048 sc1
  s_waitcnt vmcnt(15) lgkmcnt(3)
  v_mfma_f32_32x32x16_bf16 v[46:61], v[224:227], a[48:51], v[46:61]
  ds_read_b128 v[220:223], v3 offset:28672
  v_mfma_f32_32x32x16_bf16 v[62:77], v[224:227], a[52:55], v[62:77]
  buffer_load_dwordx4 a[116:119], v3, s[8:11], s22 offen offset:2048 sc1
  s_waitcnt lgkmcnt(3)
  v_mfma_f32_32x32x16_bf16 v[78:93], v[208:211], a[48:51], v[78:93]
  ds_read_b128 v[224:227], v3 offset:29696
  v_mfma_f32_32x32x16_bf16 v[94:109], v[208:211], a[52:55], v[94:109]
  s_waitcnt lgkmcnt(3)
  v_mfma_f32_32x32x16_bf16 v[110:125], v[212:215], a[48:51], v[110:125]
  ds_read_b128 v[208:211], v3 offset:30720
  v_mfma_f32_32x32x16_bf16 v[126:141], v[212:215], a[52:55], v[126:141]
  s_waitcnt lgkmcnt(3)
  v_mfma_f32_32x32x16_bf16 v[142:157], v[216:219], a[48:51], v[142:157]
  ds_read_b128 v[212:215], v3 offset:31744
  v_mfma_f32_32x32x16_bf16 v[158:173], v[216:219], a[52:55], v[158:173]
  buffer_load_dwordx4 a[120:123], v3, s[8:11], s21 offen offset:3072 sc1
  s_add_u32 s21, s21, 4096
  s_waitcnt vmcnt(15) lgkmcnt(3)
  v_mfma_f32_32x32x16_bf16 v[46:61], v[220:223], a[56:59], v[46:61]
  ds_read_b128 v[216:219], v3 offset:32768
  v_mfma_f32_32x32x16_bf16 v[62:77], v[220:223], a[60:63], v[62:77]
  buffer_load_dwordx4 a[124:127], v3, s[8:11], s22 offen offset:3072 sc1
  s_add_u32 s22, s22, 4096
  s_waitcnt lgkmcnt(3)
  v_mfma_f32_32x32x16_bf16 v[78:93], v[224:227], a[56:59], v[78:93]
  ds_read_b128 v[220:223], v3 offset:33792
  v_mfma_f32_32x32x16_bf16 v[94:109], v[224:227], a[60:63], v[94:109]
  s_waitcnt lgkmcnt(3)
  v_mfma_f32_32x32x16_bf16 v[110:125], v[208:211], a[56:59], v[110:125]
  ds_read_b128 v[224:227], v3 offset:34816
  v_mfma_f32_32x32x16_bf16 v[126:141], v[208:211], a[60:63], v[126:141]
  s_waitcnt lgkmcnt(3)
  v_mfma_f32_32x32x16_bf16 v[142:157], v[212:215], a[56:59], v[142:157]
  ds_read_b128 v[208:211], v3 offset:35840
  v_mfma_f32_32x32x16_bf16 v[158:173], v[212:215], a[60:63], v[158:173]
  buffer_load_dwordx4 a[128:131], v3, s[8:11], s21 offen offset:0 sc1
  s_waitcnt vmcnt(15) lgkmcnt(3)
  v_mfma_f32_32x32x16_bf16 v[46:61], v[216:219], a[64:67], v[46:61]
  ds_read_b128 v[212:215], v3 offset:36864
  v_mfma_f32_32x32x16_bf16 v[62:77], v[216:219], a[68:71], v[62:77]
  buffer_load_dwordx4 a[132:135], v3, s[8:11], s22 offen offset:0 sc1
  s_waitcnt lgkmcnt(3)
  v_mfma_f32_32x32x16_bf16 v[78:93], v[220:223], a[64:67], v[78:93]
  ds_read_b128 v[216:219], v3 offset:37888
  v_mfma_f32_32x32x16_bf16 v[94:109], v[220:223], a[68:71], v[94:109]
  s_waitcnt lgkmcnt(3)
  v_mfma_f32_32x32x16_bf16 v[110:125], v[224:227], a[64:67], v[110:125]
  ds_read_b128 v[220:223], v3 offset:38912
  v_mfma_f32_32x32x16_bf16 v[126:141], v[224:227], a[68:71], v[126:141]
  s_waitcnt lgkmcnt(3)
  v_mfma_f32_32x32x16_bf16 v[142:157], v[208:211], a[64:67], v[142:157]
  ds_read_b128 v[224:227], v3 offset:39936
  v_mfma_f32_32x32x16_bf16 v[158:173], v[208:211], a[68:71], v[158:173]
  buffer_load_dwordx4 a[136:139], v3, s[8:11], s21 offen offset:1024 sc1
  s_waitcnt vmcnt(15) lgkmcnt(3)
  v_mfma_f32_32x32x16_bf16 v[46:61], v[212:215], a[72:75], v[46:61]
  ds_read_b128 v[208:211], v3 offset:40960
  v_mfma_f32_32x32x16_bf16 v[62:77], v[212:215], a[76:79], v[62:77]
  buffer_load_dwordx4 a[140:143], v3, s[8:11], s22 offen offset:1024 sc1
  s_waitcnt lgkmcnt(3)
  v_mfma_f32_32x32x16_bf16 v[78:93], v[216:219], a[72:75], v[78:93]
  ds_read_b128 v[212:215], v3 offset:41984
  v_mfma_f32_32x32x16_bf16 v[94:109], v[216:219], a[76:79], v[94:109]
  s_waitcnt lgkmcnt(3)
  v_mfma_f32_32x32x16_bf16 v[110:125], v[220:223], a[72:75], v[110:125]
  ds_read_b128 v[216:219], v3 offset:43008
  v_mfma_f32_32x32x16_bf16 v[126:141], v[220:223], a[76:79], v[126:141]
  s_waitcnt lgkmcnt(3)
  v_mfma_f32_32x32x16_bf16 v[142:157], v[224:227], a[72:75], v[142:157]
  ds_read_b128 v[220:223], v3 offset:44032
  v_mfma_f32_32x32x16_bf16 v[158:173], v[224:227], a[76:79], v[158:173]
  buffer_load_dwordx4 a[144:147], v3, s[8:11], s21 offen offset:2048 sc1
  s_waitcnt vmcnt(15) lgkmcnt(3)
  v_mfma_f32_32x32x16_bf16 v[46:61], v[208:211], a[80:83], v[46:61]
  ds_read_b128 v[224:227], v3 offset:45056
  v_mfma_f32_32x32x16_bf16 v[62:77], v[208:211], a[84:87], v[62:77]
  buffer_load_dwordx4 a[148:151], v3, s[8:11], s22 offen offset:2048 sc1
  s_waitcnt lgkmcnt(3)
  v_mfma_f32_32x32x16_bf16 v[78:93], v[212:215], a[80:83], v[78:93]
  ds_read_b128 v[208:211], v3 offset:46080
  v_mfma_f32_32x32x16_bf16 v[94:109], v[212:215], a[84:87], v[94:109]
  s_waitcnt lgkmcnt(3)
  v_mfma_f32_32x32x16_bf16 v[110:125], v[216:219], a[80:83], v[110:125]
  ds_read_b128 v[212:215], v3 offset:47104
  v_mfma_f32_32x32x16_bf16 v[126:141], v[216:219], a[84:87], v[126:141]
  s_waitcnt lgkmcnt(3)
  v_mfma_f32_32x32x16_bf16 v[142:157], v[220:223], a[80:83], v[142:157]
  ds_read_b128 v[216:219], v3 offset:48128
  v_mfma_f32_32x32x16_bf16 v[158:173], v[220:223], a[84:87], v[158:173]
  buffer_load_dwordx4 a[152:155], v3, s[8:11], s21 offen offset:3072 sc1
  s_add_u32 s21, s21, 4096
  s_barrier
  s_waitcnt vmcnt(15) lgkmcnt(3)
  v_mfma_f32_32x32x16_bf16 v[46:61], v[224:227], a[88:91], v[46:61]
  ds_read_b128 v[220:223], v3 offset:49152
  v_mfma_f32_32x32x16_bf16 v[62:77], v[224:227], a[92:95], v[62:77]
  buffer_load_dwordx4 a[156:159], v3, s[8:11], s22 offen offset:3072 sc1
  s_add_u32 s22, s22, 4096
  s_waitcnt lgkmcnt(3)
  v_mfma_f32_32x32x16_bf16 v[78:93], v[208:211], a[88:91], v[78:93]
  ds_read_b128 v[224:227], v3 offset:50176
  v_mfma_f32_32x32x16_bf16 v[94:109], v[208:211], a[92:95], v[94:109]
  s_waitcnt lgkmcnt(3)
  v_mfma_f32_32x32x16_bf16 v[110:125], v[212:215], a[88:91], v[110:125]
  ds_read_b128 v[208:211], v3 offset:51200
  v_mfma_f32_32x32x16_bf16 v[126:141], v[212:215], a[92:95], v[126:141]
  s_waitcnt lgkmcnt(3)
  v_mfma_f32_32x32x16_bf16 v[142:157], v[216:219], a[88:91], v[142:157]
  ds_read_b128 v[212:215], v3 offset:52224
  v_mfma_f32_32x32x16_bf16 v[158:173], v[216:219], a[92:95], v[158:173]
  buffer_load_dwordx4 a[160:163], v3, s[8:11], s21 offen offset:0 sc1
  s_waitcnt vmcnt(15) lgkmcnt(3)
  v_mfma_f32_32x32x16_bf16 v[46:61], v[220:223], a[96:99], v[46:61]
  ds_read_b128 v[216:219], v3 offset:53248
  v_mfma_f32_32x32x16_bf16 v[62:77], v[220:223], a[100:103], v[62:77]
  buffer_load_dwordx4 a[164:167], v3, s[8:11], s22 offen offset:0 sc1
  s_waitcnt lgkmcnt(3)
  v_mfma_f32_32x32x16_bf16 v[78:93], v[224:227], a[96:99], v[78:93]
  ds_read_b128 v[220:223], v3 offset:54272
  v_mfma_f32_32x32x16_bf16 v[94:109], v[224:227], a[100:103], v[94:109]
  s_waitcnt lgkmcnt(3)
  v_mfma_f32_32x32x16_bf16 v[110:125], v[208:211], a[96:99], v[110:125]
  ds_read_b128 v[224:227], v3 offset:55296
  v_mfma_f32_32x32x16_bf16 v[126:141], v[208:211], a[100:103], v[126:141]
  s_waitcnt lgkmcnt(3)
  v_mfma_f32_32x32x16_bf16 v[142:157], v[212:215], a[96:99], v[142:157]
  ds_read_b128 v[208:211], v3 offset:56320
  v_mfma_f32_32x32x16_bf16 v[158:173], v[212:215], a[100:103], v[158:173]
  buffer_load_dwordx4 a[168:171], v3, s[8:11], s21 offen offset:1024 sc1
  s_waitcnt vmcnt(15) lgkmcnt(3)
  v_mfma_f32_32x32x16_bf16 v[46:61], v[216:219], a[104:107], v[46:61]
  ds_read_b128 v[212:215], v3 offset:57344
  v_mfma_f32_32x32x16_bf16 v[62:77], v[216:219], a[108:111], v[62:77]
  buffer_load_dwordx4 a[172:175], v3, s[8:11], s22 offen offset:1024 sc1
  s_waitcnt lgkmcnt(3)
  v_mfma_f32_32x32x16_bf16 v[78:93], v[220:223], a[104:107], v[78:93]
  ds_read_b128 v[216:219], v3 offset:58368
  v_mfma_f32_32x32x16_bf16 v[94:109], v[220:223], a[108:111], v[94:109]
  s_waitcnt lgkmcnt(3)
  v_mfma_f32_32x32x16_bf16 v[110:125], v[224:227], a[104:107], v[110:125]
  ds_read_b128 v[220:223], v3 offset:59392
  v_mfma_f32_32x32x16_bf16 v[126:141], v[224:227], a[108:111], v[126:141]
  s_waitcnt lgkmcnt(3)
  v_mfma_f32_32x32x16_bf16 v[142:157], v[208:211], a[104:107], v[142:157]
  ds_read_b128 v[224:227], v3 offset:60416
  v_mfma_f32_32x32x16_bf16 v[158:173], v[208:211], a[108:111], v[158:173]
  buffer_load_dwordx4 a[176:179], v3, s[8:11], s21 offen offset:2048 sc1
  s_waitcnt vmcnt(15) lgkmcnt(3)
  v_mfma_f32_32x32x16_bf16 v[46:61], v[212:215], a[112:115], v[46:61]
  ds_read_b128 v[208:211], v3 offset:61440
  v_mfma_f32_32x32x16_bf16 v[62:77], v[212:215], a[116:119], v[62:77]
  buffer_load_dwordx4 a[180:183], v3, s[8:11], s22 offen offset:2048 sc1
  s_waitcnt lgkmcnt(3)
  v_mfma_f32_32x32x16_bf16 v[78:93], v[216:219], a[112:115], v[78:93]
  ds_read_b128 v[212:215], v3 offset:62464
  v_mfma_f32_32x32x16_bf16 v[94:109], v[216:219], a[116:119], v[94:109]
  s_waitcnt lgkmcnt(3)
  v_mfma_f32_32x32x16_bf16 v[110:125], v[220:223], a[112:115], v[110:125]
  ds_read_b128 v[216:219], v3 offset:63488
  v_mfma_f32_32x32x16_bf16 v[126:141], v[220:223], a[116:119], v[126:141]
  s_add_u32 m0, s32, 98304
  s_add_u32 s24, s32, 98304
  s_add_u32 s24, s24, s23
  buffer_load_dwordx4 v3, s[4:7], s24 offen offset:0 lds
  s_waitcnt lgkmcnt(3)
  v_mfma_f32_32x32x16_bf16 v[142:157], v[224:227], a[112:115], v[142:157]
  ds_read_b128 v[220:223], v3 offset:64512
  v_mfma_f32_32x32x16_bf16 v[158:173], v[224:227], a[116:119], v[158:173]
  buffer_load_dwordx4 v3, s[4:7], s24 offen offset:1024 lds
  s_waitcnt vmcnt(16) lgkmcnt(3)
  v_mfma_f32_32x32x16_bf16 v[46:61], v[208:211], a[120:123], v[46:61]
  ds_read_b128 v[224:227], v4 offset:0
  v_mfma_f32_32x32x16_bf16 v[62:77], v[208:211], a[124:127], v[62:77]
  buffer_load_dwordx4 v3, s[4:7], s24 offen offset:2048 lds
  s_waitcnt lgkmcnt(3)
  v_mfma_f32_32x32x16_bf16 v[78:93], v[212:215], a[120:123], v[78:93]
  ds_read_b128 v[208:211], v4 offset:1024
  v_mfma_f32_32x32x16_bf16 v[94:109], v[212:215], a[124:127], v[94:109]
  buffer_load_dwordx4 v3, s[4:7], s24 offen offset:3072 lds
  s_waitcnt lgkmcnt(3)
  v_mfma_f32_32x32x16_bf16 v[110:125], v[216:219], a[120:123], v[110:125]
  ds_read_b128 v[212:215], v4 offset:2048
  v_mfma_f32_32x32x16_bf16 v[126:141], v[216:219], a[124:127], v[126:141]
  buffer_load_dwordx4 a[184:187], v3, s[8:11], s21 offen offset:3072 sc1
  s_add_u32 s21, s21, 4096
  s_waitcnt lgkmcnt(3)
  v_mfma_f32_32x32x16_bf16 v[142:157], v[220:223], a[120:123], v[142:157]
  ds_read_b128 v[216:219], v4 offset:3072
  v_mfma_f32_32x32x16_bf16 v[158:173], v[220:223], a[124:127], v[158:173]
  buffer_load_dwordx2 v[174:175], v5, s[8:11], s25 offen offset:0 sc1
  s_waitcnt vmcnt(18) lgkmcnt(3)
  v_mfma_f32_32x32x16_bf16 v[46:61], v[224:227], a[128:131], v[46:61]
  ds_read_b128 v[220:223], v4 offset:4096
  v_mfma_f32_32x32x16_bf16 v[62:77], v[224:227], a[132:135], v[62:77]
  buffer_load_dwordx4 a[188:191], v3, s[8:11], s22 offen offset:3072 sc1
  s_add_u32 s22, s22, 4096
  s_waitcnt lgkmcnt(3)
  v_mfma_f32_32x32x16_bf16 v[78:93], v[208:211], a[128:131], v[78:93]
  ds_read_b128 v[224:227], v4 offset:5120
  v_mfma_f32_32x32x16_bf16 v[94:109], v[208:211], a[132:135], v[94:109]
  buffer_load_dwordx2 v[176:177], v5, s[8:11], s25 offen offset:256 sc1
  s_add_u32 s25, s25, 16384
  s_waitcnt lgkmcnt(3)
  v_mfma_f32_32x32x16_bf16 v[110:125], v[212:215], a[128:131], v[110:125]
  ds_read_b128 v[208:211], v4 offset:6144
  v_mfma_f32_32x32x16_bf16 v[126:141], v[212:215], a[132:135], v[126:141]
  buffer_load_dwordx4 a[192:195], v3, s[8:11], s21 offen offset:0 sc1
  s_waitcnt lgkmcnt(3)
  v_mfma_f32_32x32x16_bf16 v[142:157], v[216:219], a[128:131], v[142:157]
  ds_read_b128 v[212:215], v4 offset:7168
  v_mfma_f32_32x32x16_bf16 v[158:173], v[216:219], a[132:135], v[158:173]
  buffer_load_dwordx4 a[196:199], v3, s[8:11], s22 offen offset:0 sc1
  s_waitcnt vmcnt(20) lgkmcnt(3)
  v_mfma_f32_32x32x16_bf16 v[46:61], v[220:223], a[136:139], v[46:61]
  ds_read_b128 v[216:219], v4 offset:8192
  v_mfma_f32_32x32x16_bf16 v[62:77], v[220:223], a[140:143], v[62:77]
  buffer_load_dwordx2 v[178:179], v5, s[8:11], s25 offen offset:0 sc1
  s_waitcnt lgkmcnt(3)
  v_mfma_f32_32x32x16_bf16 v[78:93], v[224:227], a[136:139], v[78:93]
  ds_read_b128 v[220:223], v4 offset:9216
  v_mfma_f32_32x32x16_bf16 v[94:109], v[224:227], a[140:143], v[94:109]
  buffer_load_dwordx2 v[180:181], v5, s[8:11], s25 offen offset:256 sc1
  s_add_u32 s25, s25, 16384
  s_waitcnt lgkmcnt(3)
  v_mfma_f32_32x32x16_bf16 v[110:125], v[208:211], a[136:139], v[110:125]
  ds_read_b128 v[224:227], v4 offset:10240
  v_mfma_f32_32x32x16_bf16 v[126:141], v[208:211], a[140:143], v[126:141]
  buffer_load_dwordx4 a[200:203], v3, s[8:11], s21 offen offset:1024 sc1
  s_waitcnt lgkmcnt(3)
  v_mfma_f32_32x32x16_bf16 v[142:157], v[212:215], a[136:139], v[142:157]
  ds_read_b128 v[208:211], v4 offset:11264
  v_mfma_f32_32x32x16_bf16 v[158:173], v[212:215], a[140:143], v[158:173]
  buffer_load_dwordx4 a[204:207], v3, s[8:11], s22 offen offset:1024 sc1
  s_waitcnt vmcnt(22) lgkmcnt(3)
  v_mfma_f32_32x32x16_bf16 v[46:61], v[216:219], a[144:147], v[46:61]
  ds_read_b128 v[212:215], v4 offset:12288
  v_mfma_f32_32x32x16_bf16 v[62:77], v[216:219], a[148:151], v[62:77]
  buffer_load_dwordx2 v[182:183], v5, s[8:11], s25 offen offset:0 sc1
  s_waitcnt lgkmcnt(3)
  v_mfma_f32_32x32x16_bf16 v[78:93], v[220:223], a[144:147], v[78:93]
  ds_read_b128 v[216:219], v4 offset:13312
  v_mfma_f32_32x32x16_bf16 v[94:109], v[220:223], a[148:151], v[94:109]
  buffer_load_dwordx2 v[184:185], v5, s[8:11], s25 offen offset:256 sc1
  s_add_u32 s25, s25, 16384
  s_waitcnt lgkmcnt(3)
  v_mfma_f32_32x32x16_bf16 v[110:125], v[224:227], a[144:147], v[110:125]
  ds_read_b128 v[220:223], v4 offset:14336
  v_mfma_f32_32x32x16_bf16 v[126:141], v[224:227], a[148:151], v[126:141]
  buffer_load_dwordx4 a[208:211], v3, s[8:11], s21 offen offset:2048 sc1
  s_waitcnt lgkmcnt(3)
  v_mfma_f32_32x32x16_bf16 v[142:157], v[208:211], a[144:147], v[142:157]
  ds_read_b128 v[224:227], v4 offset:15360
  v_mfma_f32_32x32x16_bf16 v[158:173], v[208:211], a[148:151], v[158:173]
  buffer_load_dwordx4 a[212:215], v3, s[8:11], s22 offen offset:2048 sc1
  s_waitcnt vmcnt(24) lgkmcnt(3)
  v_mfma_f32_32x32x16_bf16 v[46:61], v[212:215], a[152:155], v[46:61]
  ds_read_b128 v[208:211], v4 offset:16384
  v_mfma_f32_32x32x16_bf16 v[62:77], v[212:215], a[156:159], v[62:77]
  s_add_u32 m0, s32, 114688
  s_add_u32 s24, s32, 114688
  s_add_u32 s24, s24, s23
  buffer_load_dwordx4 v3, s[4:7], s24 offen offset:0 lds
  s_waitcnt lgkmcnt(3)
  v_mfma_f32_32x32x16_bf16 v[78:93], v[216:219], a[152:155], v[78:93]
  ds_read_b128 v[212:215], v4 offset:17408
  v_mfma_f32_32x32x16_bf16 v[94:109], v[216:219], a[156:159], v[94:109]
  buffer_load_dwordx2 v[186:187], v5, s[8:11], s25 offen offset:0 sc1
  s_waitcnt lgkmcnt(3)
  v_mfma_f32_32x32x16_bf16 v[110:125], v[220:223], a[152:155], v[110:125]
  ds_read_b128 v[216:219], v4 offset:18432
  v_mfma_f32_32x32x16_bf16 v[126:141], v[220:223], a[156:159], v[126:141]
  buffer_load_dwordx4 v3, s[4:7], s24 offen offset:1024 lds
  s_waitcnt lgkmcnt(3)
  v_mfma_f32_32x32x16_bf16 v[142:157], v[224:227], a[152:155], v[142:157]
  ds_read_b128 v[220:223], v4 offset:19456
  v_mfma_f32_32x32x16_bf16 v[158:173], v[224:227], a[156:159], v[158:173]
  buffer_load_dwordx2 v[188:189], v5, s[8:11], s25 offen offset:256 sc1
  s_add_u32 s25, s25, 16384
  s_waitcnt vmcnt(26) lgkmcnt(3)
  v_mfma_f32_32x32x16_bf16 v[46:61], v[208:211], a[160:163], v[46:61]
  ds_read_b128 v[224:227], v4 offset:20480
  v_mfma_f32_32x32x16_bf16 v[62:77], v[208:211], a[164:167], v[62:77]
  buffer_load_dwordx4 v3, s[4:7], s24 offen offset:2048 lds
  s_waitcnt lgkmcnt(3)
  v_mfma_f32_32x32x16_bf16 v[78:93], v[212:215], a[160:163], v[78:93]
  ds_read_b128 v[208:211], v4 offset:21504
  v_mfma_f32_32x32x16_bf16 v[94:109], v[212:215], a[164:167], v[94:109]
  buffer_load_dwordx4 v3, s[4:7], s24 offen offset:3072 lds
  s_waitcnt lgkmcnt(3)
  v_mfma_f32_32x32x16_bf16 v[110:125], v[216:219], a[160:163], v[110:125]
  ds_read_b128 v[212:215], v4 offset:22528
  v_mfma_f32_32x32x16_bf16 v[126:141], v[216:219], a[164:167], v[126:141]
  buffer_load_dwordx4 a[216:219], v3, s[8:11], s21 offen offset:3072 sc1
  s_add_u32 s21, s21, 4096
  s_waitcnt lgkmcnt(3)
  v_mfma_f32_32x32x16_bf16 v[142:157], v[220:223], a[160:163], v[142:157]
  ds_read_b128 v[216:219], v4 offset:23552
  v_mfma_f32_32x32x16_bf16 v[158:173], v[220:223], a[164:167], v[158:173]
  buffer_load_dwordx4 a[220:223], v3, s[8:11], s22 offen offset:3072 sc1
  s_add_u32 s22, s22, 4096
  s_waitcnt vmcnt(28) lgkmcnt(3)
  v_mfma_f32_32x32x16_bf16 v[46:61], v[224:227], a[168:171], v[46:61]
  ds_read_b128 v[220:223], v4 offset:24576
  v_mfma_f32_32x32x16_bf16 v[62:77], v[224:227], a[172:175], v[62:77]
  buffer_load_dwordx4 a[224:227], v3, s[8:11], s21 offen offset:0 sc1
  s_waitcnt lgkmcnt(3)
  v_mfma_f32_32x32x16_bf16 v[78:93], v[208:211], a[168:171], v[78:93]
  ds_read_b128 v[224:227], v4 offset:25600
  v_mfma_f32_32x32x16_bf16 v[94:109], v[208:211], a[172:175], v[94:109]
  buffer_load_dwordx2 v[190:191], v5, s[8:11], s25 offen offset:0 sc1
  s_waitcnt lgkmcnt(3)
  v_mfma_f32_32x32x16_bf16 v[110:125], v[212:215], a[168:171], v[110:125]
  ds_read_b128 v[208:211], v4 offset:26624
  v_mfma_f32_32x32x16_bf16 v[126:141], v[212:215], a[172:175], v[126:141]
  buffer_load_dwordx4 a[228:231], v3, s[8:11], s22 offen offset:0 sc1
  s_waitcnt lgkmcnt(3)
  v_mfma_f32_32x32x16_bf16 v[142:157], v[216:219], a[168:171], v[142:157]
  ds_read_b128 v[212:215], v4 offset:27648
  v_mfma_f32_32x32x16_bf16 v[158:173], v[216:219], a[172:175], v[158:173]
  buffer_load_dwordx2 v[192:193], v5, s[8:11], s25 offen offset:256 sc1
  s_add_u32 s25, s25, 16384
  s_waitcnt vmcnt(30) lgkmcnt(3)
  v_mfma_f32_32x32x16_bf16 v[46:61], v[220:223], a[176:179], v[46:61]
  ds_read_b128 v[216:219], v4 offset:28672
  v_mfma_f32_32x32x16_bf16 v[62:77], v[220:223], a[180:183], v[62:77]
  buffer_load_dwordx4 a[232:235], v3, s[8:11], s21 offen offset:1024 sc1
  s_waitcnt lgkmcnt(3)
  v_mfma_f32_32x32x16_bf16 v[78:93], v[224:227], a[176:179], v[78:93]
  ds_read_b128 v[220:223], v4 offset:29696
  v_mfma_f32_32x32x16_bf16 v[94:109], v[224:227], a[180:183], v[94:109]
  buffer_load_dwordx4 a[236:239], v3, s[8:11], s22 offen offset:1024 sc1
  s_waitcnt lgkmcnt(3)
  v_mfma_f32_32x32x16_bf16 v[110:125], v[208:211], a[176:179], v[110:125]
  ds_read_b128 v[224:227], v4 offset:30720
  v_mfma_f32_32x32x16_bf16 v[126:141], v[208:211], a[180:183], v[126:141]
  buffer_load_dwordx2 v[194:195], v5, s[8:11], s25 offen offset:0 sc1
  s_waitcnt lgkmcnt(3)
  v_mfma_f32_32x32x16_bf16 v[142:157], v[212:215], a[176:179], v[142:157]
  ds_read_b128 v[208:211], v4 offset:31744
  v_mfma_f32_32x32x16_bf16 v[158:173], v[212:215], a[180:183], v[158:173]
  buffer_load_dwordx2 v[196:197], v5, s[8:11], s25 offen offset:256 sc1
  s_add_u32 s25, s25, 16384
  s_waitcnt vmcnt(30)
  s_barrier
  s_waitcnt vmcnt(27) lgkmcnt(3)
  v_mfma_f32_32x32x16_bf16 v[46:61], v[216:219], a[184:187], v[46:61]
  ds_read_b128 v[212:215], v4 offset:32768
  v_mfma_f32_32x32x16_bf16 v[62:77], v[216:219], a[188:191], v[62:77]
  buffer_load_dwordx4 a[240:243], v3, s[8:11], s21 offen offset:2048 sc1
  s_waitcnt lgkmcnt(3)
  v_mfma_f32_32x32x16_bf16 v[78:93], v[220:223], a[184:187], v[78:93]
  ds_read_b128 v[216:219], v4 offset:33792
  v_mfma_f32_32x32x16_bf16 v[94:109], v[220:223], a[188:191], v[94:109]
  buffer_load_dwordx4 a[244:247], v3, s[8:11], s22 offen offset:2048 sc1
  s_waitcnt lgkmcnt(3)
  v_mfma_f32_32x32x16_bf16 v[110:125], v[224:227], a[184:187], v[110:125]
  ds_read_b128 v[220:223], v4 offset:34816
  v_mfma_f32_32x32x16_bf16 v[126:141], v[224:227], a[188:191], v[126:141]
  s_add_u32 m0, s32, 131072
  s_add_u32 s24, s32, 131072
  s_add_u32 s24, s24, s23
  buffer_load_dwordx4 v3, s[4:7], s24 offen offset:0 lds
  s_waitcnt lgkmcnt(3)
  v_mfma_f32_32x32x16_bf16 v[142:157], v[208:211], a[184:187], v[142:157]
  ds_read_b128 v[224:227], v4 offset:35840
  v_mfma_f32_32x32x16_bf16 v[158:173], v[208:211], a[188:191], v[158:173]
  buffer_load_dwordx4 v3, s[4:7], s24 offen offset:1024 lds
  s_waitcnt vmcnt(28) lgkmcnt(3)
  v_mfma_f32_32x32x16_bf16 v[46:61], v[212:215], a[192:195], v[46:61]
  ds_read_b128 v[208:211], v4 offset:36864
  v_mfma_f32_32x32x16_bf16 v[62:77], v[212:215], a[196:199], v[62:77]
  buffer_load_dwordx4 v3, s[4:7], s24 offen offset:2048 lds
  s_waitcnt lgkmcnt(3)
  v_mfma_f32_32x32x16_bf16 v[78:93], v[216:219], a[192:195], v[78:93]
  ds_read_b128 v[212:215], v4 offset:37888
  v_mfma_f32_32x32x16_bf16 v[94:109], v[216:219], a[196:199], v[94:109]
  buffer_load_dwordx4 v3, s[4:7], s24 offen offset:3072 lds
  s_waitcnt lgkmcnt(3)
  v_mfma_f32_32x32x16_bf16 v[110:125], v[220:223], a[192:195], v[110:125]
  ds_read_b128 v[216:219], v4 offset:38912
  v_mfma_f32_32x32x16_bf16 v[126:141], v[220:223], a[196:199], v[126:141]
  buffer_load_dwordx4 a[248:251], v3, s[8:11], s21 offen offset:3072 sc1
  s_add_u32 s21, s21, 4096
  s_waitcnt lgkmcnt(3)
  v_mfma_f32_32x32x16_bf16 v[142:157], v[224:227], a[192:195], v[142:157]
  ds_read_b128 v[220:223], v4 offset:39936
  v_mfma_f32_32x32x16_bf16 v[158:173], v[224:227], a[196:199], v[158:173]
  buffer_load_dwordx4 a[252:255], v3, s[8:11], s22 offen offset:3072 sc1
  s_add_u32 s22, s22, 4096
  s_waitcnt vmcnt(28) lgkmcnt(3)
  v_mfma_f32_32x32x16_bf16 v[46:61], v[208:211], a[200:203], v[46:61]
  ds_read_b128 v[224:227], v4 offset:40960
  v_mfma_f32_32x32x16_bf16 v[62:77], v[208:211], a[204:207], v[62:77]
  buffer_load_dwordx4 v[14:17], v3, s[8:11], s21 offen offset:0 sc1
  s_waitcnt lgkmcnt(3)
  v_mfma_f32_32x32x16_bf16 v[78:93], v[212:215], a[200:203], v[78:93]
  ds_read_b128 v[208:211], v4 offset:41984
  v_mfma_f32_32x32x16_bf16 v[94:109], v[212:215], a[204:207], v[94:109]
  buffer_load_dwordx4 v[18:21], v3, s[8:11], s22 offen offset:0 sc1
  s_waitcnt lgkmcnt(3)
  v_mfma_f32_32x32x16_bf16 v[110:125], v[216:219], a[200:203], v[110:125]
  ds_read_b128 v[212:215], v4 offset:43008
  v_mfma_f32_32x32x16_bf16 v[126:141], v[216:219], a[204:207], v[126:141]
  buffer_load_dwordx4 v[22:25], v3, s[8:11], s21 offen offset:1024 sc1
  s_waitcnt lgkmcnt(3)
  v_mfma_f32_32x32x16_bf16 v[142:157], v[220:223], a[200:203], v[142:157]
  ds_read_b128 v[216:219], v4 offset:44032
  v_mfma_f32_32x32x16_bf16 v[158:173], v[220:223], a[204:207], v[158:173]
  buffer_load_dwordx4 v[26:29], v3, s[8:11], s22 offen offset:1024 sc1
  s_waitcnt vmcnt(28) lgkmcnt(3)
  v_mfma_f32_32x32x16_bf16 v[46:61], v[224:227], a[208:211], v[46:61]
  ds_read_b128 v[220:223], v4 offset:45056
  v_mfma_f32_32x32x16_bf16 v[62:77], v[224:227], a[212:215], v[62:77]
  buffer_load_dwordx4 v[30:33], v3, s[8:11], s21 offen offset:2048 sc1
  s_waitcnt lgkmcnt(3)
  v_mfma_f32_32x32x16_bf16 v[78:93], v[208:211], a[208:211], v[78:93]
  ds_read_b128 v[224:227], v4 offset:46080
  v_mfma_f32_32x32x16_bf16 v[94:109], v[208:211], a[212:215], v[94:109]
  buffer_load_dwordx4 v[34:37], v3, s[8:11], s22 offen offset:2048 sc1
  s_waitcnt lgkmcnt(3)
  v_mfma_f32_32x32x16_bf16 v[110:125], v[212:215], a[208:211], v[110:125]
  ds_read_b128 v[208:211], v4 offset:47104
  v_mfma_f32_32x32x16_bf16 v[126:141], v[212:215], a[212:215], v[126:141]
  s_add_u32 m0, s33, 0
  s_add_u32 s24, s33, 147456
  s_add_u32 s24, s24, s23
  buffer_load_dwordx4 v3, s[4:7], s24 offen offset:0 lds
  s_waitcnt lgkmcnt(3)
  v_mfma_f32_32x32x16_bf16 v[142:157], v[216:219], a[208:211], v[142:157]
  ds_read_b128 v[212:215], v4 offset:48128
  v_mfma_f32_32x32x16_bf16 v[158:173], v[216:219], a[212:215], v[158:173]
  buffer_load_dwordx4 v3, s[4:7], s24 offen offset:1024 lds
  s_waitcnt vmcnt(26)
  s_barrier
  s_waitcnt vmcnt(24) lgkmcnt(3)
  v_mfma_f32_32x32x16_bf16 v[46:61], v[220:223], a[216:219], v[46:61]
  ds_read_b128 v[216:219], v4 offset:49152
  v_mfma_f32_32x32x16_bf16 v[62:77], v[220:223], a[220:223], v[62:77]
  buffer_load_dwordx4 v3, s[4:7], s24 offen offset:2048 lds
  s_waitcnt lgkmcnt(3)
  v_mfma_f32_32x32x16_bf16 v[78:93], v[224:227], a[216:219], v[78:93]
  ds_read_b128 v[220:223], v4 offset:50176
  v_mfma_f32_32x32x16_bf16 v[94:109], v[224:227], a[220:223], v[94:109]
  buffer_load_dwordx4 v3, s[4:7], s24 offen offset:3072 lds
  s_waitcnt lgkmcnt(3)
  v_mfma_f32_32x32x16_bf16 v[110:125], v[208:211], a[216:219], v[110:125]
  ds_read_b128 v[224:227], v4 offset:51200
  v_mfma_f32_32x32x16_bf16 v[126:141], v[208:211], a[220:223], v[126:141]
  s_add_u32 m0, s33, 4096
  s_add_u32 s24, s33, 151552
  s_add_u32 s24, s24, s23
  buffer_load_dwordx4 v3, s[4:7], s24 offen offset:0 lds
  s_waitcnt lgkmcnt(3)
  v_mfma_f32_32x32x16_bf16 v[142:157], v[212:215], a[216:219], v[142:157]
  ds_read_b128 v[208:211], v4 offset:52224
  v_mfma_f32_32x32x16_bf16 v[158:173], v[212:215], a[220:223], v[158:173]
  buffer_load_dwordx4 v3, s[4:7], s24 offen offset:1024 lds
  s_waitcnt vmcnt(25) lgkmcnt(3)
  v_mfma_f32_32x32x16_bf16 v[46:61], v[216:219], a[224:227], v[46:61]
  ds_read_b128 v[212:215], v4 offset:53248
  v_mfma_f32_32x32x16_bf16 v[62:77], v[216:219], a[228:231], v[62:77]
  buffer_load_dwordx4 v3, s[4:7], s24 offen offset:2048 lds
  s_waitcnt lgkmcnt(3)
  v_mfma_f32_32x32x16_bf16 v[78:93], v[220:223], a[224:227], v[78:93]
  ds_read_b128 v[216:219], v4 offset:54272
  v_mfma_f32_32x32x16_bf16 v[94:109], v[220:223], a[228:231], v[94:109]
  buffer_load_dwordx4 v3, s[4:7], s24 offen offset:3072 lds
  s_waitcnt lgkmcnt(3)
  v_mfma_f32_32x32x16_bf16 v[110:125], v[224:227], a[224:227], v[110:125]
  ds_read_b128 v[220:223], v4 offset:55296
  v_mfma_f32_32x32x16_bf16 v[126:141], v[224:227], a[228:231], v[126:141]
  s_add_u32 m0, s33, 8192
  s_add_u32 s24, s33, 155648
  s_add_u32 s24, s24, s23
  buffer_load_dwordx4 v3, s[4:7], s24 offen offset:0 lds
  s_waitcnt lgkmcnt(3)
  v_mfma_f32_32x32x16_bf16 v[142:157], v[208:211], a[224:227], v[142:157]
  ds_read_b128 v[224:227], v4 offset:56320
  v_mfma_f32_32x32x16_bf16 v[158:173], v[208:211], a[228:231], v[158:173]
  buffer_load_dwordx4 v[38:41], v3, s[8:11], s21 offen offset:3072 sc1
  s_add_u32 s21, s21, 4096
  s_waitcnt vmcnt(26) lgkmcnt(3)
  v_mfma_f32_32x32x16_bf16 v[46:61], v[212:215], a[232:235], v[46:61]
  ds_read_b128 v[208:211], v4 offset:57344
  v_mfma_f32_32x32x16_bf16 v[62:77], v[212:215], a[236:239], v[62:77]
  buffer_load_dwordx4 v[42:45], v3, s[8:11], s22 offen offset:3072 sc1
  s_add_u32 s22, s22, 4096
  s_waitcnt lgkmcnt(3)
  v_mfma_f32_32x32x16_bf16 v[78:93], v[216:219], a[232:235], v[78:93]
  ds_read_b128 v[212:215], v4 offset:58368
  v_mfma_f32_32x32x16_bf16 v[94:109], v[216:219], a[236:239], v[94:109]
  s_add_u32 m0, s33, 36864
  s_add_u32 s24, s33, 184320
  s_add_u32 s24, s24, s23
  buffer_load_dwordx4 v3, s[4:7], s24 offen offset:0 lds
  s_waitcnt lgkmcnt(3)
  v_mfma_f32_32x32x16_bf16 v[110:125], v[220:223], a[232:235], v[110:125]
  ds_read_b128 v[216:219], v4 offset:59392
  v_mfma_f32_32x32x16_bf16 v[126:141], v[220:223], a[236:239], v[126:141]
  buffer_load_dwordx4 v3, s[4:7], s24 offen offset:1024 lds
  s_waitcnt lgkmcnt(3)
  v_mfma_f32_32x32x16_bf16 v[142:157], v[224:227], a[232:235], v[142:157]
  ds_read_b128 v[220:223], v4 offset:60416
  v_mfma_f32_32x32x16_bf16 v[158:173], v[224:227], a[236:239], v[158:173]
  buffer_load_dwordx4 v3, s[4:7], s24 offen offset:2048 lds
  s_waitcnt vmcnt(26) lgkmcnt(3)
  v_mfma_f32_32x32x16_bf16 v[46:61], v[208:211], a[240:243], v[46:61]
  ds_read_b128 v[224:227], v4 offset:61440
  v_mfma_f32_32x32x16_bf16 v[62:77], v[208:211], a[244:247], v[62:77]
  buffer_load_dwordx4 v3, s[4:7], s24 offen offset:3072 lds
  s_waitcnt lgkmcnt(3)
  v_mfma_f32_32x32x16_bf16 v[78:93], v[212:215], a[240:243], v[78:93]
  ds_read_b128 v[208:211], v4 offset:62464
  v_mfma_f32_32x32x16_bf16 v[94:109], v[212:215], a[244:247], v[94:109]
  s_add_u32 m0, s33, 40960
  s_add_u32 s24, s33, 188416
  s_add_u32 s24, s24, s23
  buffer_load_dwordx4 v3, s[4:7], s24 offen offset:0 lds
  s_waitcnt lgkmcnt(3)
  v_mfma_f32_32x32x16_bf16 v[110:125], v[216:219], a[240:243], v[110:125]
  ds_read_b128 v[212:215], v4 offset:63488
  v_add_f32 v174, v174, v178
  v_add_f32 v175, v175, v179
  v_add_f32 v174, v174, v182
  v_mfma_f32_32x32x16_bf16 v[126:141], v[216:219], a[244:247], v[126:141]
  buffer_load_dwordx4 v3, s[4:7], s24 offen offset:1024 lds
  v_add_f32 v175, v175, v183
  v_add_f32 v174, v174, v186
  v_add_f32 v175, v175, v187
  v_add_f32 v174, v174, v190
  s_waitcnt lgkmcnt(3)
  v_mfma_f32_32x32x16_bf16 v[142:157], v[220:223], a[240:243], v[142:157]
  ds_read_b128 v[216:219], v4 offset:64512
  v_add_f32 v175, v175, v191
  v_add_f32 v174, v174, v194
  v_add_f32 v175, v175, v195
  v_mov_b32 v228, v174
  v_mfma_f32_32x32x16_bf16 v[158:173], v[220:223], a[244:247], v[158:173]
  buffer_load_dwordx4 v3, s[4:7], s24 offen offset:2048 lds
  v_mov_b32 v229, v175
  s_nop 1
  v_permlane32_swap_b32 v228, v174
  s_waitcnt vmcnt(26)
  s_barrier
  s_waitcnt vmcnt(24) lgkmcnt(3)
  v_mfma_f32_32x32x16_bf16 v[46:61], v[224:227], a[248:251], v[46:61]
  ds_read_b128 v[220:223], v9 offset:0
  v_permlane32_swap_b32 v229, v175
  v_add_f32 v174, v174, v228
  v_mfma_f32_32x32x16_bf16 v[62:77], v[224:227], a[252:255], v[62:77]
  buffer_load_dwordx4 v3, s[4:7], s24 offen offset:3072 lds
  v_add_f32 v175, v175, v229
  v_mul_f32 v174, 0x3ae38e39, v174
  v_mul_f32 v175, 0x3ae38e39, v175
  v_fma_f32 v175, -v174, v174, v175
  s_waitcnt lgkmcnt(3)
  v_mfma_f32_32x32x16_bf16 v[78:93], v[208:211], a[248:251], v[78:93]
  ds_read_b128 v[224:227], v9 offset:1024
  v_max_f32 v175, 0, v175
  v_add_f32 v246, 0x3727c5ac, v175
  v_rsq_f32 v174, v246
  v_mfma_f32_32x32x16_bf16 v[94:109], v[208:211], a[252:255], v[94:109]
  s_add_u32 m0, s33, 45056
  s_add_u32 s24, s33, 192512
  s_add_u32 s24, s24, s23
  buffer_load_dwordx4 v3, s[4:7], s24 offen offset:0 lds
  s_nop 0
  v_mul_f32 v244, 0xc0135761, v174
  v_mul_f32 v175, v174, v174
  v_mul_f32 v175, v175, v174
  s_waitcnt lgkmcnt(3)
  v_mfma_f32_32x32x16_bf16 v[110:125], v[212:215], a[248:251], v[110:125]
  ds_read_b128 v[208:211], v9 offset:2048
  v_mul_f32 v245, 0xbdd2d3e8, v175
  v_add_f32 v176, v176, v180
  v_add_f32 v177, v177, v181
  v_mfma_f32_32x32x16_bf16 v[126:141], v[212:215], a[252:255], v[126:141]
  v_add_f32 v176, v176, v184
  v_add_f32 v177, v177, v185
  v_add_f32 v176, v176, v188
  v_add_f32 v177, v177, v189
  v_add_f32 v176, v176, v192
  v_add_f32 v177, v177, v193
  s_waitcnt lgkmcnt(3)
  v_mfma_f32_32x32x16_bf16 v[142:157], v[216:219], a[248:251], v[142:157]
  ds_read_b128 v[212:215], v9 offset:3072
  v_add_f32 v176, v176, v196
  v_add_f32 v177, v177, v197
  v_mov_b32 v228, v176
  v_mov_b32 v229, v177
  v_mfma_f32_32x32x16_bf16 v[158:173], v[216:219], a[252:255], v[158:173]
  s_nop 1
  v_permlane32_swap_b32 v228, v176
  v_permlane32_swap_b32 v229, v177
  v_add_f32 v176, v176, v228
  v_add_f32 v177, v177, v229
  s_waitcnt vmcnt(24) lgkmcnt(3)
  v_mfma_f32_32x32x16_bf16 v[46:61], v[220:223], v[14:17], v[46:61]
  ds_read_b128 v[216:219], v9 offset:4096
  v_mul_f32 v176, 0x3ae38e39, v176
  v_mul_f32 v177, 0x3ae38e39, v177
  v_fma_f32 v177, -v176, v176, v177
  v_max_f32 v177, 0, v177
  v_mfma_f32_32x32x16_bf16 v[62:77], v[220:223], v[18:21], v[62:77]
  v_add_f32 v249, 0x3727c5ac, v177
  v_rsq_f32 v176, v249
  s_nop 0
  v_mul_f32 v247, 0xc0135761, v176
  v_mul_f32 v177, v176, v176
  s_waitcnt lgkmcnt(3)
  v_mfma_f32_32x32x16_bf16 v[78:93], v[224:227], v[14:17], v[78:93]
  ds_read_b128 v[220:223], v9 offset:5120
  v_mul_f32 v177, v177, v176
  v_mul_f32 v248, 0xbdd2d3e8, v177
  v_mfma_f32_32x32x16_bf16 v[94:109], v[224:227], v[18:21], v[94:109]
  s_bfe_u32 s45, s2, 0x20001
  s_and_b32 s46, s2, 1
  s_lshl_b32 s46, s46, 3
  s_bfe_u32 s44, s2, 0x30003
  s_add_u32 s46, s46, s44
  s_lshr_b32 s44, s2, 6
  s_lshl_b32 s46, s46, 2
  s_add_u32 s46, s46, s20
  s_lshr_b32 s55, s46, 2
  s_lshl_b32 s55, s55, 2
  s_add_u32 s55, s55, s44
  s_lshl_b32 s55, s55, 2
  s_add_u32 s55, s55, s20
  s_mul_i32 s55, s55, 28672
  s_add_u32 s55, s55, 71303168
  s_waitcnt lgkmcnt(3)
  v_mfma_f32_32x32x16_bf16 v[110:125], v[208:211], v[14:17], v[110:125]
  ds_read_b128 v[224:227], v9 offset:6144
  v_mfma_f32_32x32x16_bf16 v[126:141], v[208:211], v[18:21], v[126:141]
  s_waitcnt lgkmcnt(3)
  v_mfma_f32_32x32x16_bf16 v[142:157], v[212:215], v[14:17], v[142:157]
  ds_read_b128 v[208:211], v9 offset:7168
  v_mfma_f32_32x32x16_bf16 v[158:173], v[212:215], v[18:21], v[158:173]
  s_waitcnt vmcnt(22) lgkmcnt(3)
  v_mfma_f32_32x32x16_bf16 v[46:61], v[216:219], v[22:25], v[46:61]
  ds_read_b128 v[212:215], v9 offset:8192
  v_mfma_f32_32x32x16_bf16 v[62:77], v[216:219], v[26:29], v[62:77]
  s_waitcnt lgkmcnt(3)
  v_mfma_f32_32x32x16_bf16 v[78:93], v[220:223], v[22:25], v[78:93]
  ds_read_b128 v[216:219], v9 offset:9216
  v_mfma_f32_32x32x16_bf16 v[94:109], v[220:223], v[26:29], v[94:109]
  s_bfe_u32 s36, s2, 0x20001
  s_lshr_b32 s37, s2, 6
  s_lshl_b32 s37, s37, 2
  s_add_u32 s36, s36, s37
  s_mul_i32 s36, s36, 331776
  s_add_u32 s36, s36, 14680064
  s_mul_i32 s41, s46, 294912
  s_mul_i32 s42, s45, 36864
  s_add_u32 s41, s41, s42
  s_add_u32 s41, s41, 50331648
  s_waitcnt lgkmcnt(3)
  v_mfma_f32_32x32x16_bf16 v[110:125], v[224:227], v[22:25], v[110:125]
  ds_read_b128 v[220:223], v9 offset:10240
  v_mfma_f32_32x32x16_bf16 v[126:141], v[224:227], v[26:29], v[126:141]
  s_waitcnt lgkmcnt(3)
  v_mfma_f32_32x32x16_bf16 v[142:157], v[208:211], v[22:25], v[142:157]
  ds_read_b128 v[224:227], v9 offset:11264
  v_mfma_f32_32x32x16_bf16 v[158:173], v[208:211], v[26:29], v[158:173]
  s_waitcnt vmcnt(20) lgkmcnt(3)
  v_mfma_f32_32x32x16_bf16 v[46:61], v[212:215], v[30:33], v[46:61]
  ds_read_b128 v[208:211], v9 offset:12288
  v_mfma_f32_32x32x16_bf16 v[62:77], v[212:215], v[34:37], v[62:77]
  s_waitcnt lgkmcnt(3)
  v_mfma_f32_32x32x16_bf16 v[78:93], v[216:219], v[30:33], v[78:93]
  ds_read_b128 v[212:215], v9 offset:13312
  v_mfma_f32_32x32x16_bf16 v[94:109], v[216:219], v[34:37], v[94:109]
  s_waitcnt lgkmcnt(3)
  v_mfma_f32_32x32x16_bf16 v[110:125], v[220:223], v[30:33], v[110:125]
  ds_read_b128 v[216:219], v9 offset:14336
  v_mfma_f32_32x32x16_bf16 v[126:141], v[220:223], v[34:37], v[126:141]
  s_waitcnt lgkmcnt(3)
  v_mfma_f32_32x32x16_bf16 v[142:157], v[224:227], v[30:33], v[142:157]
  ds_read_b128 v[220:223], v9 offset:15360
  v_mfma_f32_32x32x16_bf16 v[158:173], v[224:227], v[34:37], v[158:173]
  v_mov_b32 v252, -1
  v_mov_b32 v253, -1
  v_mov_b32 v254, -1
  v_mov_b32 v255, -1
  s_mul_i32 s34, s45, 6144
  s_add_u32 s34, s34, s55
  buffer_store_dwordx4 v[252:255], v3, s[8:11], s34 offen offset:0 sc1
  s_waitcnt vmcnt(12)
  s_barrier
  s_waitcnt vmcnt(10) lgkmcnt(3)
  v_mfma_f32_32x32x16_bf16 v[46:61], v[208:211], v[38:41], v[46:61]
  ds_read_b128 v[224:227], v3 offset:0
  v_mfma_f32_32x32x16_bf16 v[62:77], v[208:211], v[42:45], v[62:77]
  s_add_u32 m0, s33, 73728
  s_add_u32 s24, s33, 221184
  s_add_u32 s24, s24, s23
  buffer_load_dwordx4 v3, s[4:7], s24 offen offset:0 lds
  s_waitcnt lgkmcnt(3)
  v_mfma_f32_32x32x16_bf16 v[78:93], v[212:215], v[38:41], v[78:93]
  ds_read_b128 v[208:211], v3 offset:1024
  v_mfma_f32_32x32x16_bf16 v[94:109], v[212:215], v[42:45], v[94:109]
  buffer_load_dwordx4 v3, s[4:7], s24 offen offset:1024 lds
  s_waitcnt lgkmcnt(3)
  v_mfma_f32_32x32x16_bf16 v[110:125], v[216:219], v[38:41], v[110:125]
  ds_read_b128 v[212:215], v3 offset:2048
  v_mfma_f32_32x32x16_bf16 v[126:141], v[216:219], v[42:45], v[126:141]
  buffer_load_dwordx4 v3, s[4:7], s24 offen offset:2048 lds
  s_waitcnt lgkmcnt(3)
  v_mfma_f32_32x32x16_bf16 v[142:157], v[220:223], v[38:41], v[142:157]
  ds_read_b128 v[216:219], v3 offset:3072
  v_mfma_f32_32x32x16_bf16 v[158:173], v[220:223], v[42:45], v[158:173]
  buffer_load_dwordx4 v3, s[4:7], s24 offen offset:3072 lds
  s_waitcnt lgkmcnt(2)
  v_mfma_f32_32x32x16_bf16 v[174:189], v[224:227], a[0:3], 0
  ds_read_b128 v[220:223], v3 offset:4096
  v_mfma_f32_32x32x16_bf16 v[190:205], v[224:227], a[4:7], 0
  s_add_u32 m0, s33, 77824
  s_add_u32 s24, s33, 225280
  s_add_u32 s24, s24, s23
  buffer_load_dwordx4 v3, s[4:7], s24 offen offset:0 lds
  v_mfma_f32_32x32x16_bf16 v[174:189], v[208:211], a[8:11], v[174:189]
  ds_read_b128 v[224:227], v3 offset:5120
  v_mfma_f32_32x32x16_bf16 v[190:205], v[208:211], a[12:15], v[190:205]
  buffer_load_dwordx4 v3, s[4:7], s24 offen offset:1024 lds
  s_waitcnt lgkmcnt(2)
  v_mfma_f32_32x32x16_bf16 v[174:189], v[212:215], a[16:19], v[174:189]
  ds_read_b128 v[208:211], v3 offset:6144
  v_mfma_f32_32x32x16_bf16 v[190:205], v[212:215], a[20:23], v[190:205]
  buffer_load_dwordx4 v3, s[4:7], s24 offen offset:2048 lds
  v_mfma_f32_32x32x16_bf16 v[174:189], v[216:219], a[24:27], v[174:189]
  ds_read_b128 v[212:215], v3 offset:7168
  v_mfma_f32_32x32x16_bf16 v[190:205], v[216:219], a[28:31], v[190:205]
  buffer_load_dwordx4 v3, s[4:7], s24 offen offset:3072 lds
  s_waitcnt lgkmcnt(2)
  v_mfma_f32_32x32x16_bf16 v[174:189], v[220:223], a[32:35], v[174:189]
  ds_read_b128 v[216:219], v3 offset:8192
  v_mul_f32 v228, v46, v46
  v_mul_f32 v229, v47, v47
  v_mul_f32 v230, v48, v48
  v_mul_f32 v231, v49, v49
  v_mfma_f32_32x32x16_bf16 v[190:205], v[220:223], a[36:39], v[190:205]
  s_add_u32 m0, s33, 81920
  s_add_u32 s24, s33, 229376
  s_add_u32 s24, s24, s23
  buffer_load_dwordx4 v3, s[4:7], s24 offen offset:0 lds
  v_fma_f32 v228, v228, v245, v244
  v_fma_f32 v229, v229, v245, v244
  v_fma_f32 v230, v230, v245, v244
  v_fma_f32 v231, v231, v245, v244
  v_mfma_f32_32x32x16_bf16 v[174:189], v[224:227], a[40:43], v[174:189]
  ds_read_b128 v[220:223], v3 offset:9216
  v_mul_f32 v228, v228, v46
  v_mul_f32 v229, v229, v47
  v_mul_f32 v230, v230, v48
  v_mul_f32 v231, v231, v49
  v_mfma_f32_32x32x16_bf16 v[190:205], v[224:227], a[44:47], v[190:205]
  buffer_store_dwordx4 v[252:255], v3, s[8:11], s34 offen offset:1024 sc1
  v_exp_f32 v228, v228
  v_mul_f32 v54, v54, v46
  s_waitcnt lgkmcnt(2)
  v_mfma_f32_32x32x16_bf16 v[174:189], v[208:211], a[48:51], v[174:189]
  ds_read_b128 v[224:227], v3 offset:10240
  v_exp_f32 v229, v229
  v_mul_f32 v55, v55, v47
  v_mfma_f32_32x32x16_bf16 v[190:205], v[208:211], a[52:55], v[190:205]
  buffer_store_dwordx4 v[252:255], v3, s[8:11], s34 offen offset:2048 sc1
  v_exp_f32 v230, v230
  v_mul_f32 v56, v56, v48
  v_mfma_f32_32x32x16_bf16 v[174:189], v[212:215], a[56:59], v[174:189]
  ds_read_b128 v[208:211], v3 offset:11264
  v_exp_f32 v231, v231
  v_mul_f32 v57, v57, v49
  v_fma_f32 v228, v228, v246, v246
  v_fma_f32 v229, v229, v246, v246
  v_mfma_f32_32x32x16_bf16 v[190:205], v[212:215], a[60:63], v[190:205]
  buffer_store_dwordx4 v[252:255], v3, s[8:11], s34 offen offset:3072 sc1
  v_fma_f32 v230, v230, v246, v246
  v_fma_f32 v231, v231, v246, v246
  v_rcp_f32 v228, v228
  s_waitcnt lgkmcnt(2)
  v_mfma_f32_32x32x16_bf16 v[174:189], v[216:219], a[64:67], v[174:189]
  ds_read_b128 v[212:215], v3 offset:12288
  v_rcp_f32 v229, v229
  v_rcp_f32 v230, v230
  v_mfma_f32_32x32x16_bf16 v[190:205], v[216:219], a[68:71], v[190:205]
  v_rcp_f32 v231, v231
  v_mul_f32 v54, v54, v228
  v_mul_f32 v55, v55, v229
  v_mul_f32 v56, v56, v230
  v_mul_f32 v57, v57, v231
  v_mfma_f32_32x32x16_bf16 v[174:189], v[220:223], a[72:75], v[174:189]
  ds_read_b128 v[216:219], v3 offset:13312
  v_cvt_pk_bf16_f32 v236, v54, v55
  v_cvt_pk_bf16_f32 v237, v56, v57
  v_mul_f32 v232, v50, v50
  v_mul_f32 v233, v51, v51
  v_mul_f32 v234, v52, v52
  v_mfma_f32_32x32x16_bf16 v[190:205], v[220:223], a[76:79], v[190:205]
  v_mul_f32 v235, v53, v53
  v_fma_f32 v232, v232, v245, v244
  v_fma_f32 v233, v233, v245, v244
  v_fma_f32 v234, v234, v245, v244
  v_fma_f32 v235, v235, v245, v244
  v_mul_f32 v232, v232, v50
  s_waitcnt lgkmcnt(2)
  v_mfma_f32_32x32x16_bf16 v[174:189], v[224:227], a[80:83], v[174:189]
  ds_read_b128 v[220:223], v3 offset:14336
  v_mul_f32 v233, v233, v51
  v_mul_f32 v234, v234, v52
  v_mul_f32 v235, v235, v53
  v_mfma_f32_32x32x16_bf16 v[190:205], v[224:227], a[84:87], v[190:205]
  v_exp_f32 v232, v232
  v_mul_f32 v58, v58, v50
  v_exp_f32 v233, v233
  v_mul_f32 v59, v59, v51
  v_mfma_f32_32x32x16_bf16 v[174:189], v[208:211], a[88:91], v[174:189]
  ds_read_b128 v[224:227], v3 offset:15360
  v_exp_f32 v234, v234
  v_mul_f32 v60, v60, v52
  v_exp_f32 v235, v235
  v_mfma_f32_32x32x16_bf16 v[190:205], v[208:211], a[92:95], v[190:205]
  s_add_u32 s34, s34, 4096
  buffer_store_dwordx4 v[252:255], v3, s[8:11], s34 offen offset:0 sc1
  v_mul_f32 v61, v61, v53
  v_fma_f32 v232, v232, v246, v246
  v_fma_f32 v233, v233, v246, v246
  v_fma_f32 v234, v234, v246, v246
  s_waitcnt lgkmcnt(2)
  v_mfma_f32_32x32x16_bf16 v[174:189], v[212:215], a[96:99], v[174:189]
  ds_read_b128 v[208:211], v3 offset:16384
  v_fma_f32 v235, v235, v246, v246
  v_rcp_f32 v232, v232
  v_mfma_f32_32x32x16_bf16 v[190:205], v[212:215], a[100:103], v[190:205]
  v_rcp_f32 v233, v233
  v_rcp_f32 v234, v234
  v_rcp_f32 v235, v235
  v_mfma_f32_32x32x16_bf16 v[174:189], v[216:219], a[104:107], v[174:189]
  ds_read_b128 v[212:215], v3 offset:17408
  v_mul_f32 v58, v58, v232
  v_mul_f32 v59, v59, v233
  v_mul_f32 v60, v60, v234
  v_mul_f32 v61, v61, v235
  v_cvt_pk_bf16_f32 v238, v58, v59
  v_mfma_f32_32x32x16_bf16 v[190:205], v[216:219], a[108:111], v[190:205]
  v_cvt_pk_bf16_f32 v239, v60, v61
  buffer_store_dwordx4 v[236:239], v8, s[8:11], s26 offen offset:0 sc1
  v_mul_f32 v228, v62, v62
  v_mul_f32 v229, v63, v63
  v_mul_f32 v230, v64, v64
  v_mul_f32 v231, v65, v65
  s_waitcnt lgkmcnt(2)
  v_mfma_f32_32x32x16_bf16 v[174:189], v[220:223], a[112:115], v[174:189]
  ds_read_b128 v[216:219], v3 offset:18432
  v_fma_f32 v228, v228, v248, v247
  v_fma_f32 v229, v229, v248, v247
  v_fma_f32 v230, v230, v248, v247
  v_fma_f32 v231, v231, v248, v247
  v_mfma_f32_32x32x16_bf16 v[190:205], v[220:223], a[116:119], v[190:205]
  v_mul_f32 v228, v228, v62
  v_mul_f32 v229, v229, v63
  v_mul_f32 v230, v230, v64
  v_mul_f32 v231, v231, v65
  v_exp_f32 v228, v228
  v_mfma_f32_32x32x16_bf16 v[174:189], v[224:227], a[120:123], v[174:189]
  ds_read_b128 v[220:223], v3 offset:19456
  v_mul_f32 v70, v70, v62
  v_exp_f32 v229, v229
  v_mul_f32 v71, v71, v63
  v_mfma_f32_32x32x16_bf16 v[190:205], v[224:227], a[124:127], v[190:205]
  buffer_store_dwordx4 v[252:255], v3, s[8:11], s34 offen offset:1024 sc1
  v_exp_f32 v230, v230
  v_mul_f32 v72, v72, v64
  s_waitcnt lgkmcnt(2)
  v_mfma_f32_32x32x16_bf16 v[174:189], v[208:211], a[128:131], v[174:189]
  ds_read_b128 v[224:227], v3 offset:20480
  v_exp_f32 v231, v231
  v_mul_f32 v73, v73, v65
  v_fma_f32 v228, v228, v249, v249
  v_mfma_f32_32x32x16_bf16 v[190:205], v[208:211], a[132:135], v[190:205]
  v_fma_f32 v229, v229, v249, v249
  v_fma_f32 v230, v230, v249, v249
  v_fma_f32 v231, v231, v249, v249
  v_rcp_f32 v228, v228
  v_mfma_f32_32x32x16_bf16 v[174:189], v[212:215], a[136:139], v[174:189]
  ds_read_b128 v[208:211], v3 offset:21504
  v_rcp_f32 v229, v229
  v_rcp_f32 v230, v230
  v_mfma_f32_32x32x16_bf16 v[190:205], v[212:215], a[140:143], v[190:205]
  v_rcp_f32 v231, v231
  v_mul_f32 v70, v70, v228
  v_mul_f32 v71, v71, v229
  v_mul_f32 v72, v72, v230
  v_mul_f32 v73, v73, v231
  s_waitcnt lgkmcnt(2)
  v_mfma_f32_32x32x16_bf16 v[174:189], v[216:219], a[144:147], v[174:189]
  ds_read_b128 v[212:215], v3 offset:22528
  v_cvt_pk_bf16_f32 v240, v70, v71
  v_cvt_pk_bf16_f32 v241, v72, v73
  v_mul_f32 v232, v66, v66
  v_mul_f32 v233, v67, v67
  v_mfma_f32_32x32x16_bf16 v[190:205], v[216:219], a[148:151], v[190:205]
  v_mul_f32 v234, v68, v68
  v_mul_f32 v235, v69, v69
  v_fma_f32 v232, v232, v248, v247
  v_fma_f32 v233, v233, v248, v247
  v_fma_f32 v234, v234, v248, v247
  v_fma_f32 v235, v235, v248, v247
  v_mfma_f32_32x32x16_bf16 v[174:189], v[220:223], a[152:155], v[174:189]
  ds_read_b128 v[216:219], v3 offset:23552
  v_mul_f32 v232, v232, v66
  v_mul_f32 v233, v233, v67
  v_mul_f32 v234, v234, v68
  v_mul_f32 v235, v235, v69
  v_mfma_f32_32x32x16_bf16 v[190:205], v[220:223], a[156:159], v[190:205]
  s_add_u32 s34, s55, 24576
  s_cmp_eq_u32 s45, s20
  s_cselect_b32 s34, s34, 268435456
  buffer_store_dwordx4 v[252:255], v3, s[8:11], s34 offen offset:0 sc1
  v_exp_f32 v232, v232
  v_mul_f32 v74, v74, v66
  s_waitcnt lgkmcnt(2)
  v_mfma_f32_32x32x16_bf16 v[174:189], v[224:227], a[160:163], v[174:189]
  ds_read_b128 v[220:223], v3 offset:24576
  v_exp_f32 v233, v233
  v_mul_f32 v75, v75, v67
  v_mfma_f32_32x32x16_bf16 v[190:205], v[224:227], a[164:167], v[190:205]
  v_exp_f32 v234, v234
  v_mul_f32 v76, v76, v68
  v_exp_f32 v235, v235
  v_mul_f32 v77, v77, v69
  v_mfma_f32_32x32x16_bf16 v[174:189], v[208:211], a[168:171], v[174:189]
  ds_read_b128 v[224:227], v3 offset:25600
  v_fma_f32 v232, v232, v249, v249
  v_fma_f32 v233, v233, v249, v249
  v_fma_f32 v234, v234, v249, v249
  v_fma_f32 v235, v235, v249, v249
  v_mfma_f32_32x32x16_bf16 v[190:205], v[208:211], a[172:175], v[190:205]
  v_rcp_f32 v232, v232
  v_rcp_f32 v233, v233
  v_rcp_f32 v234, v234
  s_waitcnt lgkmcnt(2)
  v_mfma_f32_32x32x16_bf16 v[174:189], v[212:215], a[176:179], v[174:189]
  ds_read_b128 v[208:211], v3 offset:26624
  v_rcp_f32 v235, v235
  v_mul_f32 v74, v74, v232
  v_mul_f32 v75, v75, v233
  v_mfma_f32_32x32x16_bf16 v[190:205], v[212:215], a[180:183], v[190:205]
  v_mul_f32 v76, v76, v234
  v_mul_f32 v77, v77, v235
  v_cvt_pk_bf16_f32 v242, v74, v75
  v_cvt_pk_bf16_f32 v243, v76, v77
  buffer_store_dwordx4 v[240:243], v8, s[8:11], s27 offen offset:0 sc1
  v_mul_f32 v228, v78, v78
  v_mfma_f32_32x32x16_bf16 v[174:189], v[216:219], a[184:187], v[174:189]
  ds_read_b128 v[212:215], v3 offset:27648
  v_mul_f32 v229, v79, v79
  v_mul_f32 v230, v80, v80
  v_mul_f32 v231, v81, v81
  v_fma_f32 v228, v228, v245, v244
  v_fma_f32 v229, v229, v245, v244
  v_mfma_f32_32x32x16_bf16 v[190:205], v[216:219], a[188:191], v[190:205]
  buffer_store_dwordx4 v[252:255], v3, s[8:11], s34 offen offset:1024 sc1
  v_fma_f32 v230, v230, v245, v244
  v_fma_f32 v231, v231, v245, v244
  v_mul_f32 v228, v228, v78
  v_mul_f32 v229, v229, v79
  s_waitcnt lgkmcnt(2)
  v_mfma_f32_32x32x16_bf16 v[174:189], v[220:223], a[192:195], v[174:189]
  ds_read_b128 v[216:219], v3 offset:28672
  v_mul_f32 v230, v230, v80
  v_mul_f32 v231, v231, v81
  v_exp_f32 v228, v228
  v_mfma_f32_32x32x16_bf16 v[190:205], v[220:223], a[196:199], v[190:205]
  v_mul_f32 v86, v86, v78
  v_exp_f32 v229, v229
  v_mul_f32 v87, v87, v79
  v_exp_f32 v230, v230
  v_mfma_f32_32x32x16_bf16 v[174:189], v[224:227], a[200:203], v[174:189]
  ds_read_b128 v[220:223], v3 offset:29696
  v_mul_f32 v88, v88, v80
  v_exp_f32 v231, v231
  v_mul_f32 v89, v89, v81
  v_fma_f32 v228, v228, v246, v246
  v_mfma_f32_32x32x16_bf16 v[190:205], v[224:227], a[204:207], v[190:205]
  v_fma_f32 v229, v229, v246, v246
  v_fma_f32 v230, v230, v246, v246
  v_fma_f32 v231, v231, v246, v246
  v_rcp_f32 v228, v228
  s_waitcnt lgkmcnt(2)
  v_mfma_f32_32x32x16_bf16 v[174:189], v[208:211], a[208:211], v[174:189]
  ds_read_b128 v[224:227], v3 offset:30720
  v_rcp_f32 v229, v229
  v_rcp_f32 v230, v230
  v_mfma_f32_32x32x16_bf16 v[190:205], v[208:211], a[212:215], v[190:205]
  v_rcp_f32 v231, v231
  v_mul_f32 v86, v86, v228
  v_mul_f32 v87, v87, v229
  v_mul_f32 v88, v88, v230
  v_mul_f32 v89, v89, v231
  v_mfma_f32_32x32x16_bf16 v[174:189], v[212:215], a[216:219], v[174:189]
  ds_read_b128 v[208:211], v3 offset:31744
  v_cvt_pk_bf16_f32 v236, v86, v87
  v_cvt_pk_bf16_f32 v237, v88, v89
  v_mul_f32 v232, v82, v82
  v_mul_f32 v233, v83, v83
  v_mul_f32 v234, v84, v84
  v_mfma_f32_32x32x16_bf16 v[190:205], v[212:215], a[220:223], v[190:205]
  buffer_store_dwordx4 v[252:255], v3, s[8:11], s34 offen offset:2048 sc1
  v_mul_f32 v235, v85, v85
  v_fma_f32 v232, v232, v245, v244
  v_fma_f32 v233, v233, v245, v244
  v_fma_f32 v234, v234, v245, v244
  s_waitcnt lgkmcnt(2)
  v_mfma_f32_32x32x16_bf16 v[174:189], v[216:219], a[224:227], v[174:189]
  ds_read_b128 v[212:215], v3 offset:32768
  v_fma_f32 v235, v235, v245, v244
  v_mul_f32 v232, v232, v82
  v_mul_f32 v233, v233, v83
  v_mul_f32 v234, v234, v84
  v_mfma_f32_32x32x16_bf16 v[190:205], v[216:219], a[228:231], v[190:205]
  v_mul_f32 v235, v235, v85
  v_exp_f32 v232, v232
  v_mul_f32 v90, v90, v82
  v_exp_f32 v233, v233
  v_mfma_f32_32x32x16_bf16 v[174:189], v[220:223], a[232:235], v[174:189]
  ds_read_b128 v[216:219], v3 offset:33792
  v_mul_f32 v91, v91, v83
  v_exp_f32 v234, v234
  v_mul_f32 v92, v92, v84
  v_mfma_f32_32x32x16_bf16 v[190:205], v[220:223], a[236:239], v[190:205]
  v_exp_f32 v235, v235
  v_mul_f32 v93, v93, v85
  v_fma_f32 v232, v232, v246, v246
  v_fma_f32 v233, v233, v246, v246
  v_fma_f32 v234, v234, v246, v246
  s_waitcnt lgkmcnt(2)
  v_mfma_f32_32x32x16_bf16 v[174:189], v[224:227], a[240:243], v[174:189]
  ds_read_b128 v[220:223], v3 offset:34816
  v_fma_f32 v235, v235, v246, v246
  v_rcp_f32 v232, v232
  v_mfma_f32_32x32x16_bf16 v[190:205], v[224:227], a[244:247], v[190:205]
  v_rcp_f32 v233, v233
  v_rcp_f32 v234, v234
  v_rcp_f32 v235, v235
  v_mfma_f32_32x32x16_bf16 v[174:189], v[208:211], a[248:251], v[174:189]
  ds_read_b128 v[224:227], v3 offset:35840
  v_mul_f32 v90, v90, v232
  v_mul_f32 v91, v91, v233
  v_mul_f32 v92, v92, v234
  v_mul_f32 v93, v93, v235
  v_cvt_pk_bf16_f32 v238, v90, v91
  v_mfma_f32_32x32x16_bf16 v[190:205], v[208:211], a[252:255], v[190:205]
  v_cvt_pk_bf16_f32 v239, v92, v93
  buffer_store_dwordx4 v[236:239], v8, s[8:11], s26 offen offset:512 sc1
  v_mul_f32 v228, v94, v94
  v_mul_f32 v229, v95, v95
  v_mul_f32 v230, v96, v96
  v_mul_f32 v231, v97, v97
  s_waitcnt vmcnt(21)
  s_barrier
  s_waitcnt lgkmcnt(2)
  v_mfma_f32_32x32x16_bf16 v[174:189], v[212:215], v[14:17], v[174:189]
  ds_read_b128 v[208:211], v3 offset:36864
  v_fma_f32 v228, v228, v248, v247
  v_fma_f32 v229, v229, v248, v247
  v_mfma_f32_32x32x16_bf16 v[190:205], v[212:215], v[18:21], v[190:205]
  v_fma_f32 v230, v230, v248, v247
  v_fma_f32 v231, v231, v248, v247
  v_mul_f32 v228, v228, v94
  v_mul_f32 v229, v229, v95
  v_mul_f32 v230, v230, v96
  v_mul_f32 v231, v231, v97
  v_mfma_f32_32x32x16_bf16 v[174:189], v[216:219], v[22:25], v[174:189]
  ds_read_b128 v[212:215], v3 offset:37888
  v_exp_f32 v228, v228
  v_mul_f32 v102, v102, v94
  v_exp_f32 v229, v229
  v_mfma_f32_32x32x16_bf16 v[190:205], v[216:219], v[26:29], v[190:205]
  v_mul_f32 v103, v103, v95
  v_exp_f32 v230, v230
  v_mul_f32 v104, v104, v96
  v_exp_f32 v231, v231
  s_waitcnt lgkmcnt(2)
  v_mfma_f32_32x32x16_bf16 v[174:189], v[220:223], v[30:33], v[174:189]
  ds_read_b128 v[216:219], v3 offset:38912
  v_mul_f32 v105, v105, v97
  v_fma_f32 v228, v228, v249, v249
  v_fma_f32 v229, v229, v249, v249
  v_fma_f32 v230, v230, v249, v249
  v_mfma_f32_32x32x16_bf16 v[190:205], v[220:223], v[34:37], v[190:205]
  v_fma_f32 v231, v231, v249, v249
  v_rcp_f32 v228, v228
  v_rcp_f32 v229, v229
  v_mfma_f32_32x32x16_bf16 v[174:189], v[224:227], v[38:41], v[174:189]
  ds_read_b128 v[220:223], v3 offset:39936
  v_rcp_f32 v230, v230
  v_rcp_f32 v231, v231
  v_mul_f32 v102, v102, v228
  v_mfma_f32_32x32x16_bf16 v[190:205], v[224:227], v[42:45], v[190:205]
  v_mul_f32 v103, v103, v229
  v_mul_f32 v104, v104, v230
  v_mul_f32 v105, v105, v231
  v_cvt_pk_bf16_f32 v240, v102, v103
  v_cvt_pk_bf16_f32 v241, v104, v105
  v_mul_f32 v232, v98, v98
  s_waitcnt lgkmcnt(2)
  v_mfma_f32_32x32x16_bf16 v[46:61], v[208:211], a[0:3], 0
  ds_read_b128 v[224:227], v3 offset:40960
  v_mul_f32 v233, v99, v99
  v_mul_f32 v234, v100, v100
  v_mul_f32 v235, v101, v101
  v_fma_f32 v232, v232, v248, v247
  v_mfma_f32_32x32x16_bf16 v[62:77], v[208:211], a[4:7], 0
  v_fma_f32 v233, v233, v248, v247
  v_fma_f32 v234, v234, v248, v247
  v_fma_f32 v235, v235, v248, v247
  v_mul_f32 v232, v232, v98
  v_mul_f32 v233, v233, v99
  v_mul_f32 v234, v234, v100
  v_mfma_f32_32x32x16_bf16 v[46:61], v[212:215], a[8:11], v[46:61]
  ds_read_b128 v[208:211], v3 offset:41984
  v_mul_f32 v235, v235, v101
  v_exp_f32 v232, v232
  v_mul_f32 v106, v106, v98
  v_mfma_f32_32x32x16_bf16 v[62:77], v[212:215], a[12:15], v[62:77]
  v_exp_f32 v233, v233
  v_mul_f32 v107, v107, v99
  v_exp_f32 v234, v234
  v_mul_f32 v108, v108, v100
  s_waitcnt lgkmcnt(2)
  v_mfma_f32_32x32x16_bf16 v[46:61], v[216:219], a[16:19], v[46:61]
  ds_read_b128 v[212:215], v3 offset:43008
  v_exp_f32 v235, v235
  v_mul_f32 v109, v109, v101
  v_fma_f32 v232, v232, v249, v249
  v_mfma_f32_32x32x16_bf16 v[62:77], v[216:219], a[20:23], v[62:77]
  v_fma_f32 v233, v233, v249, v249
  v_fma_f32 v234, v234, v249, v249
  v_fma_f32 v235, v235, v249, v249
  v_rcp_f32 v232, v232
  v_mfma_f32_32x32x16_bf16 v[46:61], v[220:223], a[24:27], v[46:61]
  ds_read_b128 v[216:219], v3 offset:44032
  v_rcp_f32 v233, v233
  v_rcp_f32 v234, v234
  v_mfma_f32_32x32x16_bf16 v[62:77], v[220:223], a[28:31], v[62:77]
  v_rcp_f32 v235, v235
  v_mul_f32 v106, v106, v232
  v_mul_f32 v107, v107, v233
  v_mul_f32 v108, v108, v234
  v_mul_f32 v109, v109, v235
  s_waitcnt lgkmcnt(2)
  v_mfma_f32_32x32x16_bf16 v[46:61], v[224:227], a[32:35], v[46:61]
  ds_read_b128 v[220:223], v3 offset:45056
  v_cvt_pk_bf16_f32 v242, v106, v107
  v_cvt_pk_bf16_f32 v243, v108, v109
  buffer_store_dwordx4 v[240:243], v8, s[8:11], s27 offen offset:512 sc1
  v_mul_f32 v228, v110, v110
  v_mfma_f32_32x32x16_bf16 v[62:77], v[224:227], a[36:39], v[62:77]
  v_mul_f32 v229, v111, v111
  v_mul_f32 v230, v112, v112
  v_mul_f32 v231, v113, v113
  v_fma_f32 v228, v228, v245, v244
  v_fma_f32 v229, v229, v245, v244
  v_fma_f32 v230, v230, v245, v244
  v_mfma_f32_32x32x16_bf16 v[46:61], v[208:211], a[40:43], v[46:61]
  ds_read_b128 v[224:227], v3 offset:46080
  v_fma_f32 v231, v231, v245, v244
  v_mul_f32 v228, v228, v110
  v_mul_f32 v229, v229, v111
  v_mul_f32 v230, v230, v112
  v_mul_f32 v231, v231, v113
  v_mfma_f32_32x32x16_bf16 v[62:77], v[208:211], a[44:47], v[62:77]
  v_exp_f32 v228, v228
  v_mul_f32 v118, v118, v110
  v_exp_f32 v229, v229
  v_mul_f32 v119, v119, v111
  s_waitcnt lgkmcnt(2)
  v_mfma_f32_32x32x16_bf16 v[46:61], v[212:215], a[48:51], v[46:61]
  ds_read_b128 v[208:211], v3 offset:47104
  v_exp_f32 v230, v230
  v_mul_f32 v120, v120, v112
  v_mfma_f32_32x32x16_bf16 v[62:77], v[212:215], a[52:55], v[62:77]
  v_exp_f32 v231, v231
  v_mul_f32 v121, v121, v113
  v_fma_f32 v228, v228, v246, v246
  v_fma_f32 v229, v229, v246, v246
  v_fma_f32 v230, v230, v246, v246
  v_mfma_f32_32x32x16_bf16 v[46:61], v[216:219], a[56:59], v[46:61]
  ds_read_b128 v[212:215], v3 offset:48128
  v_fma_f32 v231, v231, v246, v246
  v_rcp_f32 v228, v228
  v_rcp_f32 v229, v229
  v_mfma_f32_32x32x16_bf16 v[62:77], v[216:219], a[60:63], v[62:77]
  v_rcp_f32 v230, v230
  v_rcp_f32 v231, v231
  v_mul_f32 v118, v118, v228
  v_mul_f32 v119, v119, v229
  s_waitcnt lgkmcnt(2)
  v_mfma_f32_32x32x16_bf16 v[46:61], v[220:223], a[64:67], v[46:61]
  ds_read_b128 v[216:219], v3 offset:49152
  v_mul_f32 v120, v120, v230
  v_mul_f32 v121, v121, v231
  v_cvt_pk_bf16_f32 v236, v118, v119
  v_cvt_pk_bf16_f32 v237, v120, v121
  v_mfma_f32_32x32x16_bf16 v[62:77], v[220:223], a[68:71], v[62:77]
  v_mul_f32 v232, v114, v114
  v_mul_f32 v233, v115, v115
  v_mul_f32 v234, v116, v116
  v_mul_f32 v235, v117, v117
  v_fma_f32 v232, v232, v245, v244
  v_fma_f32 v233, v233, v245, v244
  v_mfma_f32_32x32x16_bf16 v[46:61], v[224:227], a[72:75], v[46:61]
  ds_read_b128 v[220:223], v3 offset:50176
  v_fma_f32 v234, v234, v245, v244
  v_fma_f32 v235, v235, v245, v244
  v_mul_f32 v232, v232, v114
  v_mul_f32 v233, v233, v115
  v_mul_f32 v234, v234, v116
  v_mfma_f32_32x32x16_bf16 v[62:77], v[224:227], a[76:79], v[62:77]
  v_mul_f32 v235, v235, v117
  v_exp_f32 v232, v232
  v_mul_f32 v122, v122, v114
  v_exp_f32 v233, v233
  s_waitcnt lgkmcnt(2)
  v_mfma_f32_32x32x16_bf16 v[46:61], v[208:211], a[80:83], v[46:61]
  ds_read_b128 v[224:227], v3 offset:51200
  v_mul_f32 v123, v123, v115
  v_exp_f32 v234, v234
  v_mul_f32 v124, v124, v116
  v_mfma_f32_32x32x16_bf16 v[62:77], v[208:211], a[84:87], v[62:77]
  v_exp_f32 v235, v235
  v_mul_f32 v125, v125, v117
  v_fma_f32 v232, v232, v246, v246
  v_fma_f32 v233, v233, v246, v246
  v_fma_f32 v234, v234, v246, v246
  v_mfma_f32_32x32x16_bf16 v[46:61], v[212:215], a[88:91], v[46:61]
  ds_read_b128 v[208:211], v3 offset:52224
  v_fma_f32 v235, v235, v246, v246
  v_rcp_f32 v232, v232
  v_rcp_f32 v233, v233
  v_mfma_f32_32x32x16_bf16 v[62:77], v[212:215], a[92:95], v[62:77]
  v_rcp_f32 v234, v234
  v_rcp_f32 v235, v235
  v_mul_f32 v122, v122, v232
  v_mul_f32 v123, v123, v233
  s_waitcnt lgkmcnt(2)
  v_mfma_f32_32x32x16_bf16 v[46:61], v[216:219], a[96:99], v[46:61]
  ds_read_b128 v[212:215], v3 offset:53248
  v_mul_f32 v124, v124, v234
  v_mul_f32 v125, v125, v235
  v_cvt_pk_bf16_f32 v238, v122, v123
  v_cvt_pk_bf16_f32 v239, v124, v125
  v_mfma_f32_32x32x16_bf16 v[62:77], v[216:219], a[100:103], v[62:77]
  buffer_store_dwordx4 v[236:239], v8, s[8:11], s26 offen offset:1024 sc1
  v_mul_f32 v228, v126, v126
  v_mul_f32 v229, v127, v127
  v_mul_f32 v230, v128, v128
  v_mul_f32 v231, v129, v129
  v_fma_f32 v228, v228, v248, v247
  v_mfma_f32_32x32x16_bf16 v[46:61], v[220:223], a[104:107], v[46:61]
  ds_read_b128 v[216:219], v3 offset:54272
  v_fma_f32 v229, v229, v248, v247
  v_fma_f32 v230, v230, v248, v247
  v_fma_f32 v231, v231, v248, v247
  v_mul_f32 v228, v228, v126
  v_mul_f32 v229, v229, v127
  v_mfma_f32_32x32x16_bf16 v[62:77], v[220:223], a[108:111], v[62:77]
  v_mul_f32 v230, v230, v128
  v_mul_f32 v231, v231, v129
  v_exp_f32 v228, v228
  v_mul_f32 v134, v134, v126
  s_waitcnt lgkmcnt(2)
  v_mfma_f32_32x32x16_bf16 v[46:61], v[224:227], a[112:115], v[46:61]
  ds_read_b128 v[220:223], v3 offset:55296
  v_exp_f32 v229, v229
  v_mul_f32 v135, v135, v127
  v_mfma_f32_32x32x16_bf16 v[62:77], v[224:227], a[116:119], v[62:77]
  v_exp_f32 v230, v230
  v_mul_f32 v136, v136, v128
  v_exp_f32 v231, v231
  v_mul_f32 v137, v137, v129
  v_mfma_f32_32x32x16_bf16 v[46:61], v[208:211], a[120:123], v[46:61]
  ds_read_b128 v[224:227], v3 offset:56320
  v_fma_f32 v228, v228, v249, v249
  v_fma_f32 v229, v229, v249, v249
  v_fma_f32 v230, v230, v249, v249
  v_fma_f32 v231, v231, v249, v249
  v_mfma_f32_32x32x16_bf16 v[62:77], v[208:211], a[124:127], v[62:77]
  v_rcp_f32 v228, v228
  v_rcp_f32 v229, v229
  v_rcp_f32 v230, v230
  s_waitcnt lgkmcnt(2)
  v_mfma_f32_32x32x16_bf16 v[46:61], v[212:215], a[128:131], v[46:61]
  ds_read_b128 v[208:211], v3 offset:57344
  v_rcp_f32 v231, v231
  v_mul_f32 v134, v134, v228
  v_mul_f32 v135, v135, v229
  v_mfma_f32_32x32x16_bf16 v[62:77], v[212:215], a[132:135], v[62:77]
  v_mul_f32 v136, v136, v230
  v_mul_f32 v137, v137, v231
  v_cvt_pk_bf16_f32 v240, v134, v135
  v_cvt_pk_bf16_f32 v241, v136, v137
  v_mul_f32 v232, v130, v130
  v_mul_f32 v233, v131, v131
  v_mfma_f32_32x32x16_bf16 v[46:61], v[216:219], a[136:139], v[46:61]
  ds_read_b128 v[212:215], v3 offset:58368
  v_mul_f32 v234, v132, v132
  v_mul_f32 v235, v133, v133
  v_fma_f32 v232, v232, v248, v247
  v_fma_f32 v233, v233, v248, v247
  v_fma_f32 v234, v234, v248, v247
  v_mfma_f32_32x32x16_bf16 v[62:77], v[216:219], a[140:143], v[62:77]
  v_fma_f32 v235, v235, v248, v247
  v_mul_f32 v232, v232, v130
  v_mul_f32 v233, v233, v131
  v_mul_f32 v234, v234, v132
  v_mul_f32 v235, v235, v133
  s_waitcnt lgkmcnt(2)
  v_mfma_f32_32x32x16_bf16 v[46:61], v[220:223], a[144:147], v[46:61]
  ds_read_b128 v[216:219], v3 offset:59392
  v_exp_f32 v232, v232
  v_mul_f32 v138, v138, v130
  v_mfma_f32_32x32x16_bf16 v[62:77], v[220:223], a[148:151], v[62:77]
  v_exp_f32 v233, v233
  v_mul_f32 v139, v139, v131
  v_exp_f32 v234, v234
  v_mul_f32 v140, v140, v132
  v_mfma_f32_32x32x16_bf16 v[46:61], v[224:227], a[152:155], v[46:61]
  ds_read_b128 v[220:223], v3 offset:60416
  v_exp_f32 v235, v235
  v_mul_f32 v141, v141, v133
  v_fma_f32 v232, v232, v249, v249
  v_fma_f32 v233, v233, v249, v249
  v_mfma_f32_32x32x16_bf16 v[62:77], v[224:227], a[156:159], v[62:77]
  v_fma_f32 v234, v234, v249, v249
  v_fma_f32 v235, v235, v249, v249
  v_rcp_f32 v232, v232
  v_rcp_f32 v233, v233
  s_waitcnt lgkmcnt(2)
  v_mfma_f32_32x32x16_bf16 v[46:61], v[208:211], a[160:163], v[46:61]
  ds_read_b128 v[224:227], v3 offset:61440
  v_rcp_f32 v234, v234
  v_rcp_f32 v235, v235
  v_mfma_f32_32x32x16_bf16 v[62:77], v[208:211], a[164:167], v[62:77]
  v_mul_f32 v138, v138, v232
  v_mul_f32 v139, v139, v233
  v_mul_f32 v140, v140, v234
  v_mul_f32 v141, v141, v235
  v_cvt_pk_bf16_f32 v242, v138, v139
  v_cvt_pk_bf16_f32 v243, v140, v141
  v_mfma_f32_32x32x16_bf16 v[46:61], v[212:215], a[168:171], v[46:61]
  ds_read_b128 v[208:211], v3 offset:62464
  buffer_store_dwordx4 v[240:243], v8, s[8:11], s27 offen offset:1024 sc1
  v_mul_f32 v228, v142, v142
  v_mul_f32 v229, v143, v143
  v_mul_f32 v230, v144, v144
  v_mul_f32 v231, v145, v145
  v_mfma_f32_32x32x16_bf16 v[62:77], v[212:215], a[172:175], v[62:77]
  v_fma_f32 v228, v228, v245, v244
  v_fma_f32 v229, v229, v245, v244
  v_fma_f32 v230, v230, v245, v244
  v_fma_f32 v231, v231, v245, v244
  v_mul_f32 v228, v228, v142
  v_mul_f32 v229, v229, v143
  s_waitcnt lgkmcnt(2)
  v_mfma_f32_32x32x16_bf16 v[46:61], v[216:219], a[176:179], v[46:61]
  ds_read_b128 v[212:215], v3 offset:63488
  v_mul_f32 v230, v230, v144
  v_mul_f32 v231, v231, v145
  v_exp_f32 v228, v228
  v_mfma_f32_32x32x16_bf16 v[62:77], v[216:219], a[180:183], v[62:77]
  v_mul_f32 v150, v150, v142
  v_exp_f32 v229, v229
  v_mul_f32 v151, v151, v143
  v_exp_f32 v230, v230
  v_mfma_f32_32x32x16_bf16 v[46:61], v[220:223], a[184:187], v[46:61]
  ds_read_b128 v[216:219], v3 offset:64512
  v_mul_f32 v152, v152, v144
  v_exp_f32 v231, v231
  v_mul_f32 v153, v153, v145
  v_fma_f32 v228, v228, v246, v246
  v_mfma_f32_32x32x16_bf16 v[62:77], v[220:223], a[188:191], v[62:77]
  v_fma_f32 v229, v229, v246, v246
  v_fma_f32 v230, v230, v246, v246
  v_fma_f32 v231, v231, v246, v246
  v_rcp_f32 v228, v228
  s_waitcnt lgkmcnt(2)
  v_mfma_f32_32x32x16_bf16 v[46:61], v[224:227], a[192:195], v[46:61]
  ds_read_b128 v[220:223], v4 offset:0
  v_rcp_f32 v229, v229
  v_rcp_f32 v230, v230
  v_mfma_f32_32x32x16_bf16 v[62:77], v[224:227], a[196:199], v[62:77]
  v_rcp_f32 v231, v231
  v_mul_f32 v150, v150, v228
  v_mul_f32 v151, v151, v229
  v_mul_f32 v152, v152, v230
  v_mul_f32 v153, v153, v231
  v_mfma_f32_32x32x16_bf16 v[46:61], v[208:211], a[200:203], v[46:61]
  ds_read_b128 v[224:227], v4 offset:1024
  v_cvt_pk_bf16_f32 v236, v150, v151
  v_cvt_pk_bf16_f32 v237, v152, v153
  v_mul_f32 v232, v146, v146
  v_mul_f32 v233, v147, v147
  v_mul_f32 v234, v148, v148
  v_mfma_f32_32x32x16_bf16 v[62:77], v[208:211], a[204:207], v[62:77]
  v_mul_f32 v235, v149, v149
  v_fma_f32 v232, v232, v245, v244
  v_fma_f32 v233, v233, v245, v244
  v_fma_f32 v234, v234, v245, v244
  v_fma_f32 v235, v235, v245, v244
  v_mul_f32 v232, v232, v146
  s_waitcnt lgkmcnt(2)
  v_mfma_f32_32x32x16_bf16 v[46:61], v[212:215], a[208:211], v[46:61]
  ds_read_b128 v[208:211], v4 offset:2048
  v_mul_f32 v233, v233, v147
  v_mul_f32 v234, v234, v148
  v_mul_f32 v235, v235, v149
  v_mfma_f32_32x32x16_bf16 v[62:77], v[212:215], a[212:215], v[62:77]
  v_exp_f32 v232, v232
  v_mul_f32 v154, v154, v146
  v_exp_f32 v233, v233
  v_mul_f32 v155, v155, v147
  v_mfma_f32_32x32x16_bf16 v[46:61], v[216:219], a[216:219], v[46:61]
  ds_read_b128 v[212:215], v4 offset:3072
  v_exp_f32 v234, v234
  v_mul_f32 v156, v156, v148
  v_exp_f32 v235, v235
  v_mfma_f32_32x32x16_bf16 v[62:77], v[216:219], a[220:223], v[62:77]
  v_mul_f32 v157, v157, v149
  v_fma_f32 v232, v232, v246, v246
  v_fma_f32 v233, v233, v246, v246
  v_fma_f32 v234, v234, v246, v246
  v_fma_f32 v235, v235, v246, v246
  s_waitcnt lgkmcnt(2)
  v_mfma_f32_32x32x16_bf16 v[46:61], v[220:223], a[224:227], v[46:61]
  ds_read_b128 v[216:219], v4 offset:4096
  v_rcp_f32 v232, v232
  v_rcp_f32 v233, v233
  v_mfma_f32_32x32x16_bf16 v[62:77], v[220:223], a[228:231], v[62:77]
  v_rcp_f32 v234, v234
  v_rcp_f32 v235, v235
  v_mul_f32 v154, v154, v232
  v_mul_f32 v155, v155, v233
  v_mfma_f32_32x32x16_bf16 v[46:61], v[224:227], a[232:235], v[46:61]
  ds_read_b128 v[220:223], v4 offset:5120
  v_mul_f32 v156, v156, v234
  v_mul_f32 v157, v157, v235
  v_cvt_pk_bf16_f32 v238, v154, v155
  v_cvt_pk_bf16_f32 v239, v156, v157
  buffer_store_dwordx4 v[236:239], v8, s[8:11], s26 offen offset:1536 sc1
  v_mfma_f32_32x32x16_bf16 v[62:77], v[224:227], a[236:239], v[62:77]
  v_mul_f32 v228, v158, v158
  v_mul_f32 v229, v159, v159
  v_mul_f32 v230, v160, v160
  v_mul_f32 v231, v161, v161
  v_fma_f32 v228, v228, v248, v247
  v_fma_f32 v229, v229, v248, v247
  s_waitcnt lgkmcnt(2)
  v_mfma_f32_32x32x16_bf16 v[46:61], v[208:211], a[240:243], v[46:61]
  ds_read_b128 v[224:227], v4 offset:6144
  v_fma_f32 v230, v230, v248, v247
  v_fma_f32 v231, v231, v248, v247
  v_mul_f32 v228, v228, v158
  v_mul_f32 v229, v229, v159
  v_mfma_f32_32x32x16_bf16 v[62:77], v[208:211], a[244:247], v[62:77]
  v_mul_f32 v230, v230, v160
  v_mul_f32 v231, v231, v161
  v_exp_f32 v228, v228
  v_mul_f32 v166, v166, v158
  v_mfma_f32_32x32x16_bf16 v[46:61], v[212:215], a[248:251], v[46:61]
  ds_read_b128 v[208:211], v4 offset:7168
  v_exp_f32 v229, v229
  v_mul_f32 v167, v167, v159
  v_exp_f32 v230, v230
  v_mfma_f32_32x32x16_bf16 v[62:77], v[212:215], a[252:255], v[62:77]
  v_mul_f32 v168, v168, v160
  v_exp_f32 v231, v231
  v_mul_f32 v169, v169, v161
  v_fma_f32 v228, v228, v249, v249
  v_fma_f32 v229, v229, v249, v249
  s_waitcnt vmcnt(15)
  s_barrier
  s_waitcnt lgkmcnt(2)
  v_mfma_f32_32x32x16_bf16 v[46:61], v[216:219], v[14:17], v[46:61]
  ds_read_b128 v[212:215], v4 offset:8192
  v_fma_f32 v230, v230, v249, v249
  v_fma_f32 v231, v231, v249, v249
  v_mfma_f32_32x32x16_bf16 v[62:77], v[216:219], v[18:21], v[62:77]
  s_add_u32 m0, s33, 0
  s_add_u32 s24, s33, 258048
  s_add_u32 s24, s24, s23
  buffer_load_dwordx4 v3, s[4:7], s24 offen offset:0 lds
  v_rcp_f32 v228, v228
  v_rcp_f32 v229, v229
  v_mfma_f32_32x32x16_bf16 v[46:61], v[220:223], v[22:25], v[46:61]
  ds_read_b128 v[216:219], v4 offset:9216
  v_rcp_f32 v230, v230
  v_rcp_f32 v231, v231
  v_mul_f32 v166, v166, v228
  v_mfma_f32_32x32x16_bf16 v[62:77], v[220:223], v[26:29], v[62:77]
  buffer_load_dwordx4 v3, s[4:7], s24 offen offset:1024 lds
  v_mul_f32 v167, v167, v229
  v_mul_f32 v168, v168, v230
  v_mul_f32 v169, v169, v231
  v_cvt_pk_bf16_f32 v240, v166, v167
  s_waitcnt lgkmcnt(2)
  v_mfma_f32_32x32x16_bf16 v[46:61], v[224:227], v[30:33], v[46:61]
  ds_read_b128 v[220:223], v4 offset:10240
  v_cvt_pk_bf16_f32 v241, v168, v169
  v_mul_f32 v232, v162, v162
  v_mul_f32 v233, v163, v163
  v_mul_f32 v234, v164, v164
  v_mfma_f32_32x32x16_bf16 v[62:77], v[224:227], v[34:37], v[62:77]
  buffer_load_dwordx4 v3, s[4:7], s24 offen offset:2048 lds
  v_mul_f32 v235, v165, v165
  v_fma_f32 v232, v232, v248, v247
  v_fma_f32 v233, v233, v248, v247
  v_fma_f32 v234, v234, v248, v247
  v_mfma_f32_32x32x16_bf16 v[46:61], v[208:211], v[38:41], v[46:61]
  ds_read_b128 v[224:227], v4 offset:11264
  v_fma_f32 v235, v235, v248, v247
  v_mul_f32 v232, v232, v162
  v_mul_f32 v233, v233, v163
  v_mul_f32 v234, v234, v164
  v_mul_f32 v235, v235, v165
  v_mfma_f32_32x32x16_bf16 v[62:77], v[208:211], v[42:45], v[62:77]
  buffer_load_dwordx4 v3, s[4:7], s24 offen offset:3072 lds
  v_exp_f32 v232, v232
  v_mul_f32 v170, v170, v162
  s_waitcnt lgkmcnt(2)
  v_mfma_f32_32x32x16_bf16 v[78:93], v[212:215], a[0:3], 0
  ds_read_b128 v[208:211], v4 offset:12288
  v_exp_f32 v233, v233
  v_mul_f32 v171, v171, v163
  v_mfma_f32_32x32x16_bf16 v[94:109], v[212:215], a[4:7], 0
  s_add_u32 m0, s33, 4096
  s_add_u32 s24, s33, 262144
  s_add_u32 s24, s24, s23
  buffer_load_dwordx4 v3, s[4:7], s24 offen offset:0 lds
  v_exp_f32 v234, v234
  v_mul_f32 v172, v172, v164
  v_mfma_f32_32x32x16_bf16 v[78:93], v[216:219], a[8:11], v[78:93]
  ds_read_b128 v[212:215], v4 offset:13312
  v_exp_f32 v235, v235
  v_mul_f32 v173, v173, v165
  v_fma_f32 v232, v232, v249, v249
  v_fma_f32 v233, v233, v249, v249
  v_mfma_f32_32x32x16_bf16 v[94:109], v[216:219], a[12:15], v[94:109]
  buffer_load_dwordx4 v3, s[4:7], s24 offen offset:1024 lds
  v_fma_f32 v234, v234, v249, v249
  v_fma_f32 v235, v235, v249, v249
  v_rcp_f32 v232, v232
  s_waitcnt lgkmcnt(2)
  v_mfma_f32_32x32x16_bf16 v[78:93], v[220:223], a[16:19], v[78:93]
  ds_read_b128 v[216:219], v4 offset:14336
  v_rcp_f32 v233, v233
  v_rcp_f32 v234, v234
  v_mfma_f32_32x32x16_bf16 v[94:109], v[220:223], a[20:23], v[94:109]
  buffer_load_dwordx4 v3, s[4:7], s24 offen offset:2048 lds
  v_rcp_f32 v235, v235
  v_mul_f32 v170, v170, v232
  v_mul_f32 v171, v171, v233
  v_mfma_f32_32x32x16_bf16 v[78:93], v[224:227], a[24:27], v[78:93]
  ds_read_b128 v[220:223], v4 offset:15360
  v_mul_f32 v172, v172, v234
  v_mul_f32 v173, v173, v235
  v_cvt_pk_bf16_f32 v242, v170, v171
  v_cvt_pk_bf16_f32 v243, v172, v173
  buffer_store_dwordx4 v[240:243], v8, s[8:11], s27 offen offset:1536 sc1
  v_mfma_f32_32x32x16_bf16 v[94:109], v[224:227], a[28:31], v[94:109]
  buffer_load_dwordx4 v3, s[4:7], s24 offen offset:3072 lds
  v_mul_f32 v228, v174, v174
  v_mul_f32 v229, v175, v175
  v_mul_f32 v230, v176, v176
  v_mul_f32 v231, v177, v177
  s_waitcnt lgkmcnt(2)
  v_mfma_f32_32x32x16_bf16 v[78:93], v[208:211], a[32:35], v[78:93]
  ds_read_b128 v[224:227], v4 offset:16384
  v_fma_f32 v228, v228, v245, v244
  v_fma_f32 v229, v229, v245, v244
  v_fma_f32 v230, v230, v245, v244
  v_fma_f32 v231, v231, v245, v244
  v_mfma_f32_32x32x16_bf16 v[94:109], v[208:211], a[36:39], v[94:109]
  s_add_u32 m0, s33, 8192
  s_add_u32 s24, s33, 266240
  s_add_u32 s24, s24, s23
  buffer_load_dwordx4 v3, s[4:7], s24 offen offset:0 lds
  v_mul_f32 v228, v228, v174
  v_mul_f32 v229, v229, v175
  v_mul_f32 v230, v230, v176
  v_mul_f32 v231, v231, v177
  v_mfma_f32_32x32x16_bf16 v[78:93], v[212:215], a[40:43], v[78:93]
  ds_read_b128 v[208:211], v4 offset:17408
  v_exp_f32 v228, v228
  v_mul_f32 v182, v182, v174
  v_exp_f32 v229, v229
  v_mfma_f32_32x32x16_bf16 v[94:109], v[212:215], a[44:47], v[94:109]
  s_cmp_lg_u32 s49, 0
  s_cbranch_scc1 p4_wd
  v_min_u32 v10, 17, v1
  s_mul_i32 s54, s45, 18
  s_add_u32 s54, s54, 144
  v_add_u32 v10, s54, v10
  s_mov_b32 s54, 83951616
  v_lshlrev_b32 v10, 6, v10
  s_mov_b32 s53, 0
p4_dp:
  s_sleep 2
  buffer_load_dword v252, v10, s[8:11], s54 offen sc1
  s_add_u32 s53, s53, 1
  s_waitcnt vmcnt(0)
  v_cmp_gt_u32 vcc, 1, v252
  s_cmp_gt_u32 s53, 0x8000
  s_cbranch_scc1 p4_dg
  s_cbranch_vccnz p4_dp
p4_dg:
p4_wd:
  v_mul_f32 v183, v183, v175
  v_exp_f32 v230, v230
  v_mul_f32 v184, v184, v176
  s_waitcnt lgkmcnt(2)
  v_mfma_f32_32x32x16_bf16 v[78:93], v[216:219], a[48:51], v[78:93]
  ds_read_b128 v[212:215], v4 offset:18432
  v_exp_f32 v231, v231
  v_mul_f32 v185, v185, v177
  v_fma_f32 v228, v228, v246, v246
  v_mfma_f32_32x32x16_bf16 v[94:109], v[216:219], a[52:55], v[94:109]
  s_mul_i32 s37, s20, 3072
  s_add_u32 m0, s37, 110592
  s_add_u32 s40, s37, 36864
  s_add_u32 s40, s40, s36
  buffer_load_dwordx4 v3, s[4:7], s40 offen offset:0 sc1 lds
  v_fma_f32 v229, v229, v246, v246
  v_fma_f32 v230, v230, v246, v246
  v_fma_f32 v231, v231, v246, v246
  v_mfma_f32_32x32x16_bf16 v[78:93], v[220:223], a[56:59], v[78:93]
  ds_read_b128 v[216:219], v4 offset:19456
  v_rcp_f32 v228, v228
  v_rcp_f32 v229, v229
  v_mfma_f32_32x32x16_bf16 v[94:109], v[220:223], a[60:63], v[94:109]
  buffer_load_dwordx4 v3, s[4:7], s40 offen offset:1024 sc1 lds
  v_rcp_f32 v230, v230
  v_rcp_f32 v231, v231
  s_waitcnt lgkmcnt(2)
  v_mfma_f32_32x32x16_bf16 v[78:93], v[224:227], a[64:67], v[78:93]
  ds_read_b128 v[220:223], v4 offset:20480
  v_mul_f32 v182, v182, v228
  v_mul_f32 v183, v183, v229
  v_mul_f32 v184, v184, v230
  v_mul_f32 v185, v185, v231
  v_mfma_f32_32x32x16_bf16 v[94:109], v[224:227], a[68:71], v[94:109]
  buffer_load_dwordx4 v3, s[4:7], s40 offen offset:2048 sc1 lds
  v_cvt_pk_bf16_f32 v236, v182, v183
  v_cvt_pk_bf16_f32 v237, v184, v185
  v_mul_f32 v232, v178, v178
  v_mul_f32 v233, v179, v179
  v_mfma_f32_32x32x16_bf16 v[78:93], v[208:211], a[72:75], v[78:93]
  ds_read_b128 v[224:227], v4 offset:21504
  v_mul_f32 v234, v180, v180
  v_mul_f32 v235, v181, v181
  v_fma_f32 v232, v232, v245, v244
  v_fma_f32 v233, v233, v245, v244
  v_fma_f32 v234, v234, v245, v244
  v_mfma_f32_32x32x16_bf16 v[94:109], v[208:211], a[76:79], v[94:109]
  s_mul_i32 s37, s20, 5120
  s_add_u32 m0, s37, 122880
  s_add_u32 s40, s37, 49152
  s_add_u32 s40, s40, s36
  buffer_load_dwordx4 v3, s[4:7], s40 offen offset:0 sc1 lds
  v_fma_f32 v235, v235, v245, v244
  v_mul_f32 v232, v232, v178
  v_mul_f32 v233, v233, v179
  v_mul_f32 v234, v234, v180
  s_waitcnt lgkmcnt(2)
  v_mfma_f32_32x32x16_bf16 v[78:93], v[212:215], a[80:83], v[78:93]
  ds_read_b128 v[208:211], v4 offset:22528
  v_mul_f32 v235, v235, v181
  v_exp_f32 v232, v232
  v_mul_f32 v186, v186, v178
  v_mfma_f32_32x32x16_bf16 v[94:109], v[212:215], a[84:87], v[94:109]
  buffer_load_dwordx4 v3, s[4:7], s40 offen offset:1024 sc1 lds
  v_exp_f32 v233, v233
  v_mul_f32 v187, v187, v179
  v_mfma_f32_32x32x16_bf16 v[78:93], v[216:219], a[88:91], v[78:93]
  ds_read_b128 v[212:215], v4 offset:23552
  v_exp_f32 v234, v234
  v_mul_f32 v188, v188, v180
  v_exp_f32 v235, v235
  v_mfma_f32_32x32x16_bf16 v[94:109], v[216:219], a[92:95], v[94:109]
  buffer_load_dwordx4 v3, s[4:7], s40 offen offset:2048 sc1 lds
  v_mul_f32 v189, v189, v181
  v_fma_f32 v232, v232, v246, v246
  v_fma_f32 v233, v233, v246, v246
  v_fma_f32 v234, v234, v246, v246
  s_waitcnt lgkmcnt(2)
  v_mfma_f32_32x32x16_bf16 v[78:93], v[220:223], a[96:99], v[78:93]
  ds_read_b128 v[216:219], v4 offset:24576
  v_fma_f32 v235, v235, v246, v246
  v_rcp_f32 v232, v232
  v_mfma_f32_32x32x16_bf16 v[94:109], v[220:223], a[100:103], v[94:109]
  buffer_load_dwordx4 v3, s[4:7], s40 offen offset:3072 sc1 lds
  v_rcp_f32 v233, v233
  v_rcp_f32 v234, v234
  v_mfma_f32_32x32x16_bf16 v[78:93], v[224:227], a[104:107], v[78:93]
  ds_read_b128 v[220:223], v4 offset:25600
  v_rcp_f32 v235, v235
  v_mul_f32 v186, v186, v232
  v_mul_f32 v187, v187, v233
  v_mul_f32 v188, v188, v234
  v_mfma_f32_32x32x16_bf16 v[94:109], v[224:227], a[108:111], v[94:109]
  v_mul_f32 v189, v189, v235
  v_cvt_pk_bf16_f32 v238, v186, v187
  v_cvt_pk_bf16_f32 v239, v188, v189
  buffer_store_dwordx4 v[236:239], v8, s[8:11], s26 offen offset:2048 sc1
  v_mul_f32 v228, v190, v190
  v_mul_f32 v229, v191, v191
  s_waitcnt lgkmcnt(2)
  v_mfma_f32_32x32x16_bf16 v[78:93], v[208:211], a[112:115], v[78:93]
  ds_read_b128 v[224:227], v4 offset:26624
  v_mul_f32 v230, v192, v192
  v_mul_f32 v231, v193, v193
  v_fma_f32 v228, v228, v248, v247
  v_fma_f32 v229, v229, v248, v247
  v_mfma_f32_32x32x16_bf16 v[94:109], v[208:211], a[116:119], v[94:109]
  v_fma_f32 v230, v230, v248, v247
  v_fma_f32 v231, v231, v248, v247
  v_mul_f32 v228, v228, v190
  v_mul_f32 v229, v229, v191
  v_mul_f32 v230, v230, v192
  v_mul_f32 v231, v231, v193
  v_mfma_f32_32x32x16_bf16 v[78:93], v[212:215], a[120:123], v[78:93]
  ds_read_b128 v[208:211], v4 offset:27648
  v_exp_f32 v228, v228
  v_mul_f32 v198, v198, v190
  v_exp_f32 v229, v229
  v_mfma_f32_32x32x16_bf16 v[94:109], v[212:215], a[124:127], v[94:109]
  v_mul_f32 v199, v199, v191
  v_exp_f32 v230, v230
  v_mul_f32 v200, v200, v192
  v_exp_f32 v231, v231
  s_waitcnt lgkmcnt(2)
  v_mfma_f32_32x32x16_bf16 v[78:93], v[216:219], a[128:131], v[78:93]
  ds_read_b128 v[212:215], v4 offset:28672
  v_mul_f32 v201, v201, v193
  v_fma_f32 v228, v228, v249, v249
  v_fma_f32 v229, v229, v249, v249
  v_fma_f32 v230, v230, v249, v249
  v_mfma_f32_32x32x16_bf16 v[94:109], v[216:219], a[132:135], v[94:109]
  v_fma_f32 v231, v231, v249, v249
  v_rcp_f32 v228, v228
  v_rcp_f32 v229, v229
  v_mfma_f32_32x32x16_bf16 v[78:93], v[220:223], a[136:139], v[78:93]
  ds_read_b128 v[216:219], v4 offset:29696
  v_rcp_f32 v230, v230
  v_rcp_f32 v231, v231
  v_mul_f32 v198, v198, v228
  v_mfma_f32_32x32x16_bf16 v[94:109], v[220:223], a[140:143], v[94:109]
  v_mul_f32 v199, v199, v229
  v_mul_f32 v200, v200, v230
  v_mul_f32 v201, v201, v231
  v_cvt_pk_bf16_f32 v240, v198, v199
  v_cvt_pk_bf16_f32 v241, v200, v201
  v_mul_f32 v232, v194, v194
  s_waitcnt lgkmcnt(2)
  v_mfma_f32_32x32x16_bf16 v[78:93], v[224:227], a[144:147], v[78:93]
  ds_read_b128 v[220:223], v4 offset:30720
  v_mul_f32 v233, v195, v195
  v_mul_f32 v234, v196, v196
  v_mul_f32 v235, v197, v197
  v_fma_f32 v232, v232, v248, v247
  v_mfma_f32_32x32x16_bf16 v[94:109], v[224:227], a[148:151], v[94:109]
  v_fma_f32 v233, v233, v248, v247
  v_fma_f32 v234, v234, v248, v247
  v_fma_f32 v235, v235, v248, v247
  v_mul_f32 v232, v232, v194
  v_mul_f32 v233, v233, v195
  v_mul_f32 v234, v234, v196
  v_mfma_f32_32x32x16_bf16 v[78:93], v[208:211], a[152:155], v[78:93]
  ds_read_b128 v[224:227], v4 offset:31744
  v_mul_f32 v235, v235, v197
  v_exp_f32 v232, v232
  v_mul_f32 v202, v202, v194
  v_mfma_f32_32x32x16_bf16 v[94:109], v[208:211], a[156:159], v[94:109]
  v_exp_f32 v233, v233
  v_mul_f32 v203, v203, v195
  v_exp_f32 v234, v234
  v_mul_f32 v204, v204, v196
  s_waitcnt lgkmcnt(2)
  v_mfma_f32_32x32x16_bf16 v[78:93], v[212:215], a[160:163], v[78:93]
  ds_read_b128 v[208:211], v4 offset:32768
  v_exp_f32 v235, v235
  v_mul_f32 v205, v205, v197
  v_fma_f32 v232, v232, v249, v249
  v_mfma_f32_32x32x16_bf16 v[94:109], v[212:215], a[164:167], v[94:109]
  v_fma_f32 v233, v233, v249, v249
  v_fma_f32 v234, v234, v249, v249
  v_fma_f32 v235, v235, v249, v249
  v_rcp_f32 v232, v232
  v_mfma_f32_32x32x16_bf16 v[78:93], v[216:219], a[168:171], v[78:93]
  ds_read_b128 v[212:215], v4 offset:33792
  v_rcp_f32 v233, v233
  v_rcp_f32 v234, v234
  v_mfma_f32_32x32x16_bf16 v[94:109], v[216:219], a[172:175], v[94:109]
  v_rcp_f32 v235, v235
  v_mul_f32 v202, v202, v232
  v_mul_f32 v203, v203, v233
  v_mul_f32 v204, v204, v234
  v_mul_f32 v205, v205, v235
  s_waitcnt lgkmcnt(2)
  v_mfma_f32_32x32x16_bf16 v[78:93], v[220:223], a[176:179], v[78:93]
  ds_read_b128 v[216:219], v4 offset:34816
  v_cvt_pk_bf16_f32 v242, v202, v203
  v_cvt_pk_bf16_f32 v243, v204, v205
  buffer_store_dwordx4 v[240:243], v8, s[8:11], s27 offen offset:2048 sc1
  v_mul_f32 v228, v46, v46
  v_mfma_f32_32x32x16_bf16 v[94:109], v[220:223], a[180:183], v[94:109]
  v_mul_f32 v229, v47, v47
  v_mul_f32 v230, v48, v48
  v_mul_f32 v231, v49, v49
  v_fma_f32 v228, v228, v245, v244
  v_fma_f32 v229, v229, v245, v244
  v_fma_f32 v230, v230, v245, v244
  v_mfma_f32_32x32x16_bf16 v[78:93], v[224:227], a[184:187], v[78:93]
  ds_read_b128 v[220:223], v4 offset:35840
  v_fma_f32 v231, v231, v245, v244
  v_mul_f32 v228, v228, v46
  v_mul_f32 v229, v229, v47
  v_mul_f32 v230, v230, v48
  v_mul_f32 v231, v231, v49
  v_mfma_f32_32x32x16_bf16 v[94:109], v[224:227], a[188:191], v[94:109]
  v_exp_f32 v228, v228
  v_mul_f32 v54, v54, v46
  v_exp_f32 v229, v229
  v_mul_f32 v55, v55, v47
  s_waitcnt lgkmcnt(2)
  v_mfma_f32_32x32x16_bf16 v[78:93], v[208:211], a[192:195], v[78:93]
  ds_read_b128 v[224:227], v4 offset:36864
  v_exp_f32 v230, v230
  v_mul_f32 v56, v56, v48
  v_mfma_f32_32x32x16_bf16 v[94:109], v[208:211], a[196:199], v[94:109]
  v_exp_f32 v231, v231
  v_mul_f32 v57, v57, v49
  v_fma_f32 v228, v228, v246, v246
  v_fma_f32 v229, v229, v246, v246
  v_fma_f32 v230, v230, v246, v246
  v_mfma_f32_32x32x16_bf16 v[78:93], v[212:215], a[200:203], v[78:93]
  ds_read_b128 v[208:211], v4 offset:37888
  v_fma_f32 v231, v231, v246, v246
  v_rcp_f32 v228, v228
  v_rcp_f32 v229, v229
  v_mfma_f32_32x32x16_bf16 v[94:109], v[212:215], a[204:207], v[94:109]
  v_rcp_f32 v230, v230
  v_rcp_f32 v231, v231
  v_mul_f32 v54, v54, v228
  v_mul_f32 v55, v55, v229
  s_waitcnt lgkmcnt(2)
  v_mfma_f32_32x32x16_bf16 v[78:93], v[216:219], a[208:211], v[78:93]
  ds_read_b128 v[212:215], v4 offset:38912
  v_mul_f32 v56, v56, v230
  v_mul_f32 v57, v57, v231
  v_cvt_pk_bf16_f32 v236, v54, v55
  v_cvt_pk_bf16_f32 v237, v56, v57
  v_mfma_f32_32x32x16_bf16 v[94:109], v[216:219], a[212:215], v[94:109]
  v_mul_f32 v232, v50, v50
  v_mul_f32 v233, v51, v51
  v_mul_f32 v234, v52, v52
  v_mul_f32 v235, v53, v53
  v_fma_f32 v232, v232, v245, v244
  v_fma_f32 v233, v233, v245, v244
  v_mfma_f32_32x32x16_bf16 v[78:93], v[220:223], a[216:219], v[78:93]
  ds_read_b128 v[216:219], v4 offset:39936
  v_fma_f32 v234, v234, v245, v244
  v_fma_f32 v235, v235, v245, v244
  v_mul_f32 v232, v232, v50
  v_mul_f32 v233, v233, v51
  v_mul_f32 v234, v234, v52
  v_mfma_f32_32x32x16_bf16 v[94:109], v[220:223], a[220:223], v[94:109]
  v_mul_f32 v235, v235, v53
  v_exp_f32 v232, v232
  v_mul_f32 v58, v58, v50
  v_exp_f32 v233, v233
  s_waitcnt lgkmcnt(2)
  v_mfma_f32_32x32x16_bf16 v[78:93], v[224:227], a[224:227], v[78:93]
  ds_read_b128 v[220:223], v4 offset:40960
  v_mul_f32 v59, v59, v51
  v_exp_f32 v234, v234
  v_mul_f32 v60, v60, v52
  v_mfma_f32_32x32x16_bf16 v[94:109], v[224:227], a[228:231], v[94:109]
  v_exp_f32 v235, v235
  v_mul_f32 v61, v61, v53
  v_fma_f32 v232, v232, v246, v246
  v_fma_f32 v233, v233, v246, v246
  v_fma_f32 v234, v234, v246, v246
  v_mfma_f32_32x32x16_bf16 v[78:93], v[208:211], a[232:235], v[78:93]
  ds_read_b128 v[224:227], v4 offset:41984
  v_fma_f32 v235, v235, v246, v246
  v_rcp_f32 v232, v232
  v_rcp_f32 v233, v233
  v_mfma_f32_32x32x16_bf16 v[94:109], v[208:211], a[236:239], v[94:109]
  v_rcp_f32 v234, v234
  v_rcp_f32 v235, v235
  v_mul_f32 v58, v58, v232
  v_mul_f32 v59, v59, v233
  s_waitcnt lgkmcnt(2)
  v_mfma_f32_32x32x16_bf16 v[78:93], v[212:215], a[240:243], v[78:93]
  ds_read_b128 v[208:211], v4 offset:43008
  v_mul_f32 v60, v60, v234
  v_mul_f32 v61, v61, v235
  v_cvt_pk_bf16_f32 v238, v58, v59
  v_cvt_pk_bf16_f32 v239, v60, v61
  v_mfma_f32_32x32x16_bf16 v[94:109], v[212:215], a[244:247], v[94:109]
  buffer_store_dwordx4 v[236:239], v8, s[8:11], s26 offen offset:2560 sc1
  v_mul_f32 v228, v62, v62
  v_mul_f32 v229, v63, v63
  v_mul_f32 v230, v64, v64
  v_mul_f32 v231, v65, v65
  v_fma_f32 v228, v228, v248, v247
  v_mfma_f32_32x32x16_bf16 v[78:93], v[216:219], a[248:251], v[78:93]
  ds_read_b128 v[212:215], v4 offset:44032
  v_fma_f32 v229, v229, v248, v247
  v_fma_f32 v230, v230, v248, v247
  v_fma_f32 v231, v231, v248, v247
  v_mul_f32 v228, v228, v62
  v_mul_f32 v229, v229, v63
  v_mfma_f32_32x32x16_bf16 v[94:109], v[216:219], a[252:255], v[94:109]
  v_mul_f32 v230, v230, v64
  v_mul_f32 v231, v231, v65
  v_exp_f32 v228, v228
  v_mul_f32 v70, v70, v62
  s_waitcnt vmcnt(10)
  s_barrier
  s_waitcnt lgkmcnt(2)
  v_mfma_f32_32x32x16_bf16 v[78:93], v[220:223], v[14:17], v[78:93]
  ds_read_b128 v[216:219], v3 offset:0
  v_exp_f32 v229, v229
  v_mfma_f32_32x32x16_bf16 v[94:109], v[220:223], v[18:21], v[94:109]
  s_add_u32 m0, s33, 36864
  s_add_u32 s24, s33, 294912
  s_add_u32 s24, s24, s23
  buffer_load_dwordx4 v3, s[4:7], s24 offen offset:0 lds
  v_mul_f32 v71, v71, v63
  v_exp_f32 v230, v230
  v_mul_f32 v72, v72, v64
  v_mfma_f32_32x32x16_bf16 v[78:93], v[224:227], v[22:25], v[78:93]
  ds_read_b128 v[220:223], v3 offset:1024
  v_exp_f32 v231, v231
  v_mul_f32 v73, v73, v65
  v_fma_f32 v228, v228, v249, v249
  v_fma_f32 v229, v229, v249, v249
  v_mfma_f32_32x32x16_bf16 v[94:109], v[224:227], v[26:29], v[94:109]
  s_add_u32 m0, s37, 126976
  s_add_u32 s40, s37, 53248
  s_add_u32 s40, s40, s36
  buffer_load_dwordx4 v3, s[4:7], s40 offen offset:0 sc1 lds
  v_fma_f32 v230, v230, v249, v249
  v_fma_f32 v231, v231, v249, v249
  v_rcp_f32 v228, v228
  s_waitcnt lgkmcnt(2)
  v_mfma_f32_32x32x16_bf16 v[78:93], v[208:211], v[30:33], v[78:93]
  ds_read_b128 v[224:227], v3 offset:2048
  v_rcp_f32 v229, v229
  v_rcp_f32 v230, v230
  v_mfma_f32_32x32x16_bf16 v[94:109], v[208:211], v[34:37], v[94:109]
  s_add_u32 m0, s33, 36864
  s_nop 0
  buffer_load_dwordx4 v3, s[4:7], s24 offen offset:1024 lds
  v_rcp_f32 v231, v231
  v_mul_f32 v70, v70, v228
  v_mul_f32 v71, v71, v229
  v_mfma_f32_32x32x16_bf16 v[78:93], v[212:215], v[38:41], v[78:93]
  ds_read_b128 v[208:211], v3 offset:3072
  v_mul_f32 v72, v72, v230
  v_mul_f32 v73, v73, v231
  v_cvt_pk_bf16_f32 v240, v70, v71
  v_cvt_pk_bf16_f32 v241, v72, v73
  v_mul_f32 v232, v66, v66
  v_mfma_f32_32x32x16_bf16 v[94:109], v[212:215], v[42:45], v[94:109]
  buffer_load_dwordx4 v3, s[4:7], s24 offen offset:2048 lds
  v_mul_f32 v233, v67, v67
  v_mul_f32 v234, v68, v68
  v_mul_f32 v235, v69, v69
  v_fma_f32 v232, v232, v248, v247
  s_waitcnt lgkmcnt(2)
  v_mfma_f32_32x32x16_bf16 v[110:125], v[216:219], a[0:3], 0
  ds_read_b128 v[212:215], v3 offset:4096
  v_fma_f32 v233, v233, v248, v247
  v_fma_f32 v234, v234, v248, v247
  v_fma_f32 v235, v235, v248, v247
  v_mul_f32 v232, v232, v66
  v_mfma_f32_32x32x16_bf16 v[126:141], v[216:219], a[4:7], 0
  buffer_load_dwordx4 v3, s[4:7], s24 offen offset:3072 lds
  v_mul_f32 v233, v233, v67
  v_mul_f32 v234, v234, v68
  v_mul_f32 v235, v235, v69
  v_mfma_f32_32x32x16_bf16 v[110:125], v[220:223], a[8:11], v[110:125]
  ds_read_b128 v[216:219], v3 offset:5120
  v_exp_f32 v232, v232
  v_mul_f32 v74, v74, v66
  v_exp_f32 v233, v233
  v_mfma_f32_32x32x16_bf16 v[126:141], v[220:223], a[12:15], v[126:141]
  s_add_u32 m0, s33, 40960
  s_add_u32 s24, s33, 299008
  s_add_u32 s24, s24, s23
  buffer_load_dwordx4 v3, s[4:7], s24 offen offset:0 lds
  v_mul_f32 v75, v75, v67
  v_exp_f32 v234, v234
  v_mul_f32 v76, v76, v68
  s_waitcnt lgkmcnt(2)
  v_mfma_f32_32x32x16_bf16 v[110:125], v[224:227], a[16:19], v[110:125]
  ds_read_b128 v[220:223], v3 offset:6144
  v_exp_f32 v235, v235
  v_mul_f32 v77, v77, v69
  v_fma_f32 v232, v232, v249, v249
  v_mfma_f32_32x32x16_bf16 v[126:141], v[224:227], a[20:23], v[126:141]
  buffer_load_dwordx4 v3, s[4:7], s24 offen offset:1024 lds
  v_fma_f32 v233, v233, v249, v249
  v_fma_f32 v234, v234, v249, v249
  v_fma_f32 v235, v235, v249, v249
  v_mfma_f32_32x32x16_bf16 v[110:125], v[208:211], a[24:27], v[110:125]
  ds_read_b128 v[224:227], v3 offset:7168
  v_rcp_f32 v232, v232
  v_rcp_f32 v233, v233
  v_mfma_f32_32x32x16_bf16 v[126:141], v[208:211], a[28:31], v[126:141]
  buffer_load_dwordx4 v3, s[4:7], s24 offen offset:2048 lds
  v_rcp_f32 v234, v234
  v_rcp_f32 v235, v235
  s_waitcnt lgkmcnt(2)
  v_mfma_f32_32x32x16_bf16 v[110:125], v[212:215], a[32:35], v[110:125]
  ds_read_b128 v[208:211], v3 offset:8192
  v_mul_f32 v74, v74, v232
  v_mul_f32 v75, v75, v233
  v_mul_f32 v76, v76, v234
  v_mul_f32 v77, v77, v235
  v_mfma_f32_32x32x16_bf16 v[126:141], v[212:215], a[36:39], v[126:141]
  buffer_load_dwordx4 v3, s[4:7], s24 offen offset:3072 lds
  v_cvt_pk_bf16_f32 v242, v74, v75
  v_cvt_pk_bf16_f32 v243, v76, v77
  buffer_store_dwordx4 v[240:243], v8, s[8:11], s27 offen offset:2560 sc1
  v_mul_f32 v228, v78, v78
  v_mfma_f32_32x32x16_bf16 v[110:125], v[216:219], a[40:43], v[110:125]
  ds_read_b128 v[212:215], v3 offset:9216
  v_mul_f32 v229, v79, v79
  v_mul_f32 v230, v80, v80
  v_mul_f32 v231, v81, v81
  v_fma_f32 v228, v228, v245, v244
  v_fma_f32 v229, v229, v245, v244
  v_mfma_f32_32x32x16_bf16 v[126:141], v[216:219], a[44:47], v[126:141]
  s_add_u32 m0, s33, 45056
  s_add_u32 s24, s33, 303104
  s_add_u32 s24, s24, s23
  buffer_load_dwordx4 v3, s[4:7], s24 offen offset:0 lds
  v_fma_f32 v230, v230, v245, v244
  v_fma_f32 v231, v231, v245, v244
  v_mul_f32 v228, v228, v78
  v_mul_f32 v229, v229, v79
  s_waitcnt lgkmcnt(2)
  v_mfma_f32_32x32x16_bf16 v[110:125], v[220:223], a[48:51], v[110:125]
  ds_read_b128 v[216:219], v3 offset:10240
  v_mul_f32 v230, v230, v80
  v_mul_f32 v231, v231, v81
  v_exp_f32 v228, v228
  v_mfma_f32_32x32x16_bf16 v[126:141], v[220:223], a[52:55], v[126:141]
  s_mul_i32 s37, s20, 5120
  s_add_u32 m0, s37, 143360
  s_add_u32 s40, s37, 69632
  s_add_u32 s40, s40, s36
  buffer_load_dwordx4 v3, s[4:7], s40 offen offset:0 sc1 lds
  v_mul_f32 v86, v86, v78
  v_exp_f32 v229, v229
  v_mul_f32 v87, v87, v79
  v_mfma_f32_32x32x16_bf16 v[110:125], v[224:227], a[56:59], v[110:125]
  ds_read_b128 v[220:223], v3 offset:11264
  v_exp_f32 v230, v230
  v_mul_f32 v88, v88, v80
  v_exp_f32 v231, v231
  v_mfma_f32_32x32x16_bf16 v[126:141], v[224:227], a[60:63], v[126:141]
  buffer_load_dwordx4 v3, s[4:7], s40 offen offset:1024 sc1 lds
  v_mul_f32 v89, v89, v81
  v_fma_f32 v228, v228, v246, v246
  v_fma_f32 v229, v229, v246, v246
  v_fma_f32 v230, v230, v246, v246
  s_waitcnt lgkmcnt(2)
  v_mfma_f32_32x32x16_bf16 v[110:125], v[208:211], a[64:67], v[110:125]
  ds_read_b128 v[224:227], v3 offset:12288
  v_fma_f32 v231, v231, v246, v246
  v_rcp_f32 v228, v228
  v_mfma_f32_32x32x16_bf16 v[126:141], v[208:211], a[68:71], v[126:141]
  buffer_load_dwordx4 v3, s[4:7], s40 offen offset:2048 sc1 lds
  v_rcp_f32 v229, v229
  v_rcp_f32 v230, v230
  v_mfma_f32_32x32x16_bf16 v[110:125], v[212:215], a[72:75], v[110:125]
  ds_read_b128 v[208:211], v3 offset:13312
  v_rcp_f32 v231, v231
  v_mul_f32 v86, v86, v228
  v_mul_f32 v87, v87, v229
  v_mul_f32 v88, v88, v230
  v_mfma_f32_32x32x16_bf16 v[126:141], v[212:215], a[76:79], v[126:141]
  buffer_load_dwordx4 v3, s[4:7], s40 offen offset:3072 sc1 lds
  v_mul_f32 v89, v89, v231
  v_cvt_pk_bf16_f32 v236, v86, v87
  v_cvt_pk_bf16_f32 v237, v88, v89
  v_mul_f32 v232, v82, v82
  s_lshl_b32 s35, s18, 4
  s_add_u32 s35, s35, s19
  s_lshl_b32 s35, s35, 6
  s_add_u32 s35, s35, 83968000
  v_mov_b32 v12, 1
  v_min_u32 v13, 1, v1
  v_lshlrev_b32 v13, 31, v13
  s_waitcnt vmcnt(16)
  buffer_store_dword v12, v13, s[8:11], s35 offen sc1
  s_waitcnt lgkmcnt(2)
  v_mfma_f32_32x32x16_bf16 v[110:125], v[216:219], a[80:83], v[110:125]
  ds_read_b128 v[212:215], v3 offset:14336
  v_mul_f32 v233, v83, v83
  v_mul_f32 v234, v84, v84
  v_mul_f32 v235, v85, v85
  v_fma_f32 v232, v232, v245, v244
  v_mfma_f32_32x32x16_bf16 v[126:141], v[216:219], a[84:87], v[126:141]
  s_add_u32 m0, s37, 147456
  s_add_u32 s40, s37, 73728
  s_add_u32 s40, s40, s36
  buffer_load_dwordx4 v3, s[4:7], s40 offen offset:0 sc1 lds
  v_fma_f32 v233, v233, v245, v244
  v_fma_f32 v234, v234, v245, v244
  v_fma_f32 v235, v235, v245, v244
  v_mul_f32 v232, v232, v82
  v_mfma_f32_32x32x16_bf16 v[110:125], v[220:223], a[88:91], v[110:125]
  ds_read_b128 v[216:219], v3 offset:15360
  v_mul_f32 v233, v233, v83
  v_mul_f32 v234, v234, v84
  v_mul_f32 v235, v235, v85
  v_exp_f32 v232, v232
  v_mfma_f32_32x32x16_bf16 v[126:141], v[220:223], a[92:95], v[126:141]
  s_lshr_b32 s54, s46, 1
  s_lshl_b32 s54, s54, 5
  s_lshl_b32 s53, s45, 3
  s_add_u32 s54, s54, s53
  v_and_b32 v10, 7, v1
  v_add_u32 v10, s54, v10
  s_and_b32 s54, s2, 1
  s_lshl_b32 s54, s54, 2
  s_bfe_u32 s53, s2, 0x20003
  s_add_u32 s54, s54, s53
  s_lshl_b32 s54, s54, 2
  s_add_u32 s54, s54, s20
  s_lshl_b32 s54, s54, 5
  s_lshr_b32 s53, s2, 5
  s_add_u32 s54, s54, s53
  v_and_b32 v11, 3, v1
  v_lshl_add_u32 v11, v11, 3, s54
  v_cmp_gt_u32 vcc, 8, v1
  s_mov_b32 s54, 83968000
  s_nop 0
  v_cndmask_b32 v10, v11, v10, vcc
  v_cndmask_b32 v9, 2, 0, vcc
  v_lshlrev_b32 v10, 6, v10
  v_mul_f32 v90, v90, v82
  v_exp_f32 v233, v233
  v_mul_f32 v91, v91, v83
  s_waitcnt lgkmcnt(2)
  v_mfma_f32_32x32x16_bf16 v[110:125], v[224:227], a[96:99], v[110:125]
  ds_read_b128 v[220:223], v3 offset:16384
  v_exp_f32 v234, v234
  v_mul_f32 v92, v92, v84
  v_mfma_f32_32x32x16_bf16 v[126:141], v[224:227], a[100:103], v[126:141]
  s_lshr_b32 s59, s2, 3
  s_lshl_b32 s59, s59, 2
  s_add_u32 s59, s59, s20
  s_cmp_ge_u32 s59, 2
  s_cbranch_scc1 cp_p4_skip
  s_getpc_b64 s[60:61]
cp_p4:
  s_lshl_b32 s62, s59, 13
  s_add_u32 s62, s62, down_part-cp_p4
  s_add_u32 s60, s60, s62
  s_addc_u32 s61, s61, 0
  v_lshlrev_b32 v252, 7, v1
  v_mov_b32 v253, s61
  v_add_co_u32 v252, vcc, s60, v252
  s_nop 1
  v_addc_co_u32 v253, vcc, 0, v253, vcc
  global_load_dword v254, v[252:253], off
cp_p4_skip:
  v_exp_f32 v235, v235
  v_mul_f32 v93, v93, v85
  v_fma_f32 v232, v232, v246, v246
  v_mfma_f32_32x32x16_bf16 v[110:125], v[208:211], a[104:107], v[110:125]
  ds_read_b128 v[224:227], v3 offset:17408
  v_fma_f32 v233, v233, v246, v246
  v_fma_f32 v234, v234, v246, v246
  v_fma_f32 v235, v235, v246, v246
  v_rcp_f32 v232, v232
  v_mfma_f32_32x32x16_bf16 v[126:141], v[208:211], a[108:111], v[126:141]
  v_rcp_f32 v233, v233
  v_rcp_f32 v234, v234
  v_rcp_f32 v235, v235
  s_waitcnt lgkmcnt(2)
  v_mfma_f32_32x32x16_bf16 v[110:125], v[212:215], a[112:115], v[110:125]
  ds_read_b128 v[208:211], v3 offset:18432
  v_mul_f32 v90, v90, v232
  v_mul_f32 v91, v91, v233
  v_mul_f32 v92, v92, v234
  v_mul_f32 v93, v93, v235
  v_mfma_f32_32x32x16_bf16 v[126:141], v[212:215], a[116:119], v[126:141]
  v_cvt_pk_bf16_f32 v238, v90, v91
  v_cvt_pk_bf16_f32 v239, v92, v93
  buffer_store_dwordx4 v[236:239], v8, s[8:11], s26 offen offset:3072 sc1
  v_mul_f32 v228, v94, v94
  v_mul_f32 v229, v95, v95
  v_mul_f32 v230, v96, v96
  v_mfma_f32_32x32x16_bf16 v[110:125], v[216:219], a[120:123], v[110:125]
  ds_read_b128 v[212:215], v3 offset:19456
  v_mul_f32 v231, v97, v97
  v_fma_f32 v228, v228, v248, v247
  v_fma_f32 v229, v229, v248, v247
  v_fma_f32 v230, v230, v248, v247
  v_fma_f32 v231, v231, v248, v247
  v_mfma_f32_32x32x16_bf16 v[126:141], v[216:219], a[124:127], v[126:141]
  v_mul_f32 v228, v228, v94
  v_mul_f32 v229, v229, v95
  v_mul_f32 v230, v230, v96
  v_mul_f32 v231, v231, v97
  v_exp_f32 v228, v228
  s_waitcnt lgkmcnt(2)
  v_mfma_f32_32x32x16_bf16 v[110:125], v[220:223], a[128:131], v[110:125]
  ds_read_b128 v[216:219], v3 offset:20480
  v_mul_f32 v102, v102, v94
  v_exp_f32 v229, v229
  v_mul_f32 v103, v103, v95
  v_mfma_f32_32x32x16_bf16 v[126:141], v[220:223], a[132:135], v[126:141]
  v_exp_f32 v230, v230
  v_mul_f32 v104, v104, v96
  v_exp_f32 v231, v231
  v_mul_f32 v105, v105, v97
  v_mfma_f32_32x32x16_bf16 v[110:125], v[224:227], a[136:139], v[110:125]
  ds_read_b128 v[220:223], v3 offset:21504
  v_fma_f32 v228, v228, v249, v249
  v_fma_f32 v229, v229, v249, v249
  v_fma_f32 v230, v230, v249, v249
  v_fma_f32 v231, v231, v249, v249
  v_mfma_f32_32x32x16_bf16 v[126:141], v[224:227], a[140:143], v[126:141]
  v_rcp_f32 v228, v228
  v_rcp_f32 v229, v229
  v_rcp_f32 v230, v230
  s_waitcnt lgkmcnt(2)
  v_mfma_f32_32x32x16_bf16 v[110:125], v[208:211], a[144:147], v[110:125]
  ds_read_b128 v[224:227], v3 offset:22528
  v_rcp_f32 v231, v231
  v_mul_f32 v102, v102, v228
  v_mul_f32 v103, v103, v229
  v_mfma_f32_32x32x16_bf16 v[126:141], v[208:211], a[148:151], v[126:141]
  v_mul_f32 v104, v104, v230
  v_mul_f32 v105, v105, v231
  v_cvt_pk_bf16_f32 v240, v102, v103
  v_cvt_pk_bf16_f32 v241, v104, v105
  v_mul_f32 v232, v98, v98
  v_mul_f32 v233, v99, v99
  v_mfma_f32_32x32x16_bf16 v[110:125], v[212:215], a[152:155], v[110:125]
  ds_read_b128 v[208:211], v3 offset:23552
  v_mul_f32 v234, v100, v100
  v_mul_f32 v235, v101, v101
  v_fma_f32 v232, v232, v248, v247
  v_fma_f32 v233, v233, v248, v247
  v_fma_f32 v234, v234, v248, v247
  v_mfma_f32_32x32x16_bf16 v[126:141], v[212:215], a[156:159], v[126:141]
  v_fma_f32 v235, v235, v248, v247
  v_mul_f32 v232, v232, v98
  v_mul_f32 v233, v233, v99
  v_mul_f32 v234, v234, v100
  v_mul_f32 v235, v235, v101
  s_waitcnt lgkmcnt(2)
  v_mfma_f32_32x32x16_bf16 v[110:125], v[216:219], a[160:163], v[110:125]
  ds_read_b128 v[212:215], v3 offset:24576
  v_exp_f32 v232, v232
  v_mul_f32 v106, v106, v98
  v_mfma_f32_32x32x16_bf16 v[126:141], v[216:219], a[164:167], v[126:141]
  v_exp_f32 v233, v233
  v_mul_f32 v107, v107, v99
  v_exp_f32 v234, v234
  v_mul_f32 v108, v108, v100
  v_mfma_f32_32x32x16_bf16 v[110:125], v[220:223], a[168:171], v[110:125]
  ds_read_b128 v[216:219], v3 offset:25600
  v_exp_f32 v235, v235
  v_mul_f32 v109, v109, v101
  v_fma_f32 v232, v232, v249, v249
  v_fma_f32 v233, v233, v249, v249
  v_mfma_f32_32x32x16_bf16 v[126:141], v[220:223], a[172:175], v[126:141]
  v_fma_f32 v234, v234, v249, v249
  v_fma_f32 v235, v235, v249, v249
  v_rcp_f32 v232, v232
  v_rcp_f32 v233, v233
  s_waitcnt lgkmcnt(2)
  v_mfma_f32_32x32x16_bf16 v[110:125], v[224:227], a[176:179], v[110:125]
  ds_read_b128 v[220:223], v3 offset:26624
  v_rcp_f32 v234, v234
  v_rcp_f32 v235, v235
  v_mfma_f32_32x32x16_bf16 v[126:141], v[224:227], a[180:183], v[126:141]
  v_mul_f32 v106, v106, v232
  v_mul_f32 v107, v107, v233
  v_mul_f32 v108, v108, v234
  v_mul_f32 v109, v109, v235
  v_cvt_pk_bf16_f32 v242, v106, v107
  v_cvt_pk_bf16_f32 v243, v108, v109
  v_mfma_f32_32x32x16_bf16 v[110:125], v[208:211], a[184:187], v[110:125]
  ds_read_b128 v[224:227], v3 offset:27648
  buffer_store_dwordx4 v[240:243], v8, s[8:11], s27 offen offset:3072 sc1
  v_mfma_f32_32x32x16_bf16 v[126:141], v[208:211], a[188:191], v[126:141]
  s_waitcnt lgkmcnt(2)
  v_mfma_f32_32x32x16_bf16 v[110:125], v[212:215], a[192:195], v[110:125]
  ds_read_b128 v[208:211], v3 offset:28672
  v_mfma_f32_32x32x16_bf16 v[126:141], v[212:215], a[196:199], v[126:141]
  v_mfma_f32_32x32x16_bf16 v[110:125], v[216:219], a[200:203], v[110:125]
  ds_read_b128 v[212:215], v3 offset:29696
  v_mfma_f32_32x32x16_bf16 v[126:141], v[216:219], a[204:207], v[126:141]
  s_waitcnt lgkmcnt(2)
  v_mfma_f32_32x32x16_bf16 v[110:125], v[220:223], a[208:211], v[110:125]
  ds_read_b128 v[216:219], v3 offset:30720
  v_mfma_f32_32x32x16_bf16 v[126:141], v[220:223], a[212:215], v[126:141]
  v_mfma_f32_32x32x16_bf16 v[110:125], v[224:227], a[216:219], v[110:125]
  ds_read_b128 v[220:223], v3 offset:31744
  v_mfma_f32_32x32x16_bf16 v[126:141], v[224:227], a[220:223], v[126:141]
  s_waitcnt lgkmcnt(2)
  v_mfma_f32_32x32x16_bf16 v[110:125], v[208:211], a[224:227], v[110:125]
  ds_read_b128 v[224:227], v3 offset:32768
  v_mfma_f32_32x32x16_bf16 v[126:141], v[208:211], a[228:231], v[126:141]
  v_mfma_f32_32x32x16_bf16 v[110:125], v[212:215], a[232:235], v[110:125]
  ds_read_b128 v[208:211], v3 offset:33792
  v_mfma_f32_32x32x16_bf16 v[126:141], v[212:215], a[236:239], v[126:141]
  buffer_load_dword v11, v10, s[8:11], s54 offen sc1
  v_add_u32 v2, 147456, v3
  s_waitcnt lgkmcnt(2)
  v_mfma_f32_32x32x16_bf16 v[110:125], v[216:219], a[240:243], v[110:125]
  ds_read_b128 v[212:215], v3 offset:34816
  v_mfma_f32_32x32x16_bf16 v[126:141], v[216:219], a[244:247], v[126:141]
  v_mfma_f32_32x32x16_bf16 v[110:125], v[220:223], a[248:251], v[110:125]
  ds_read_b128 v[216:219], v3 offset:35840
  v_mfma_f32_32x32x16_bf16 v[126:141], v[220:223], a[252:255], v[126:141]
  s_waitcnt vmcnt(9)
  s_barrier
  s_waitcnt lgkmcnt(2)
  v_mfma_f32_32x32x16_bf16 v[110:125], v[224:227], v[14:17], v[110:125]
  ds_read_b128 v[220:223], v3 offset:36864
  v_mfma_f32_32x32x16_bf16 v[126:141], v[224:227], v[18:21], v[126:141]
  s_mul_i32 s37, s20, 1024
  s_add_u32 m0, s37, 73728
  s_add_u32 s40, s37, 0
  s_add_u32 s40, s40, s36
  buffer_load_dwordx4 v3, s[4:7], s40 offen offset:0 sc1 lds
  v_mfma_f32_32x32x16_bf16 v[110:125], v[208:211], v[22:25], v[110:125]
  ds_read_b128 v[224:227], v3 offset:37888
  v_mfma_f32_32x32x16_bf16 v[126:141], v[208:211], v[26:29], v[126:141]
  s_mul_i32 s37, s20, 2048
  s_add_u32 m0, s37, 77824
  s_add_u32 s40, s37, 4096
  s_add_u32 s40, s40, s36
  buffer_load_dwordx4 v3, s[4:7], s40 offen offset:0 sc1 lds
  s_waitcnt lgkmcnt(2)
  v_mfma_f32_32x32x16_bf16 v[110:125], v[212:215], v[30:33], v[110:125]
  ds_read_b128 v[208:211], v3 offset:38912
  v_mfma_f32_32x32x16_bf16 v[126:141], v[212:215], v[34:37], v[126:141]
  buffer_load_dwordx4 v3, s[4:7], s40 offen offset:1024 sc1 lds
  v_mfma_f32_32x32x16_bf16 v[110:125], v[216:219], v[38:41], v[110:125]
  ds_read_b128 v[212:215], v3 offset:39936
  v_mfma_f32_32x32x16_bf16 v[126:141], v[216:219], v[42:45], v[126:141]
  s_mul_i32 s37, s20, 2048
  s_add_u32 m0, s37, 86016
  s_add_u32 s40, s37, 12288
  s_add_u32 s40, s40, s36
  buffer_load_dwordx4 v3, s[4:7], s40 offen offset:0 sc1 lds
  s_waitcnt lgkmcnt(2)
  v_mfma_f32_32x32x16_bf16 v[142:157], v[220:223], a[0:3], 0
  ds_read_b128 v[216:219], v3 offset:40960
  v_mfma_f32_32x32x16_bf16 v[158:173], v[220:223], a[4:7], 0
  buffer_load_dwordx4 v3, s[4:7], s40 offen offset:1024 sc1 lds
  v_mfma_f32_32x32x16_bf16 v[142:157], v[224:227], a[8:11], v[142:157]
  ds_read_b128 v[220:223], v3 offset:41984
  v_mfma_f32_32x32x16_bf16 v[158:173], v[224:227], a[12:15], v[158:173]
  s_mul_i32 s37, s20, 4096
  s_add_u32 m0, s37, 94208
  s_add_u32 s40, s37, 20480
  s_add_u32 s40, s40, s36
  buffer_load_dwordx4 v3, s[4:7], s40 offen offset:0 sc1 lds
  s_waitcnt lgkmcnt(2)
  v_mfma_f32_32x32x16_bf16 v[142:157], v[208:211], a[16:19], v[142:157]
  ds_read_b128 v[224:227], v3 offset:43008
  v_mfma_f32_32x32x16_bf16 v[158:173], v[208:211], a[20:23], v[158:173]
  buffer_load_dwordx4 v3, s[4:7], s40 offen offset:1024 sc1 lds
  v_mfma_f32_32x32x16_bf16 v[142:157], v[212:215], a[24:27], v[142:157]
  ds_read_b128 v[208:211], v3 offset:44032
  v_mfma_f32_32x32x16_bf16 v[158:173], v[212:215], a[28:31], v[158:173]
  buffer_load_dwordx4 v3, s[4:7], s40 offen offset:2048 sc1 lds
  s_waitcnt vmcnt(8)
  s_mov_b32 s53, 0
  s_branch p4_f1c
p4_f1p:
  buffer_load_dword v11, v10, s[8:11], s54 offen sc1
  s_add_u32 s53, s53, 1
  s_waitcnt vmcnt(0)
p4_f1c:
  v_add_u32 v11, v11, v9
  v_cmp_gt_u32 vcc, 1, v11
  s_cmp_gt_u32 s53, 0x8000
  s_cbranch_scc1 p4_f1g
  s_cbranch_vccnz p4_f1p
p4_f1g:
  s_waitcnt lgkmcnt(2)
  v_mfma_f32_32x32x16_bf16 v[142:157], v[216:219], a[32:35], v[142:157]
  ds_read_b128 v[212:215], v3 offset:45056
  v_mul_f32 v228, v110, v110
  v_mul_f32 v229, v111, v111
  v_mul_f32 v230, v112, v112
  v_mul_f32 v231, v113, v113
  v_mfma_f32_32x32x16_bf16 v[158:173], v[216:219], a[36:39], v[158:173]
  buffer_load_dwordx4 v3, s[4:7], s40 offen offset:3072 sc1 lds
  v_fma_f32 v228, v228, v245, v244
  v_fma_f32 v229, v229, v245, v244
  v_fma_f32 v230, v230, v245, v244
  v_fma_f32 v231, v231, v245, v244
  v_mfma_f32_32x32x16_bf16 v[142:157], v[220:223], a[40:43], v[142:157]
  ds_read_b128 v[216:219], v3 offset:46080
  v_mul_f32 v228, v228, v110
  v_mul_f32 v229, v229, v111
  v_mul_f32 v230, v230, v112
  v_mul_f32 v231, v231, v113
  v_mfma_f32_32x32x16_bf16 v[158:173], v[220:223], a[44:47], v[158:173]
  s_mul_i32 s37, s20, 5120
  s_add_u32 m0, s37, 0
  s_add_u32 s40, s37, 90112
  s_add_u32 s40, s40, s36
  buffer_load_dwordx4 v3, s[4:7], s40 offen offset:0 sc1 lds
  v_exp_f32 v228, v228
  v_mul_f32 v118, v118, v110
  s_waitcnt lgkmcnt(2)
  v_mfma_f32_32x32x16_bf16 v[142:157], v[224:227], a[48:51], v[142:157]
  ds_read_b128 v[220:223], v3 offset:47104
  v_exp_f32 v229, v229
  v_mul_f32 v119, v119, v111
  v_mfma_f32_32x32x16_bf16 v[158:173], v[224:227], a[52:55], v[158:173]
  buffer_load_dwordx4 v3, s[4:7], s40 offen offset:1024 sc1 lds
  v_exp_f32 v230, v230
  v_mul_f32 v120, v120, v112
  v_mfma_f32_32x32x16_bf16 v[142:157], v[208:211], a[56:59], v[142:157]
  ds_read_b128 v[224:227], v3 offset:48128
  v_exp_f32 v231, v231
  v_mul_f32 v121, v121, v113
  v_fma_f32 v228, v228, v246, v246
  v_fma_f32 v229, v229, v246, v246
  v_mfma_f32_32x32x16_bf16 v[158:173], v[208:211], a[60:63], v[158:173]
  buffer_load_dwordx4 v3, s[4:7], s40 offen offset:2048 sc1 lds
  v_fma_f32 v230, v230, v246, v246
  v_fma_f32 v231, v231, v246, v246
  v_rcp_f32 v228, v228
  s_waitcnt lgkmcnt(2)
  v_mfma_f32_32x32x16_bf16 v[142:157], v[212:215], a[64:67], v[142:157]
  ds_read_b128 v[208:211], v3 offset:49152
  v_rcp_f32 v229, v229
  v_rcp_f32 v230, v230
  v_mfma_f32_32x32x16_bf16 v[158:173], v[212:215], a[68:71], v[158:173]
  buffer_load_dwordx4 v3, s[4:7], s40 offen offset:3072 sc1 lds
  v_rcp_f32 v231, v231
  v_mul_f32 v118, v118, v228
  v_mul_f32 v119, v119, v229
  v_mfma_f32_32x32x16_bf16 v[142:157], v[216:219], a[72:75], v[142:157]
  ds_read_b128 v[212:215], v3 offset:50176
  v_mul_f32 v120, v120, v230
  v_mul_f32 v121, v121, v231
  v_cvt_pk_bf16_f32 v236, v118, v119
  v_cvt_pk_bf16_f32 v237, v120, v121
  v_mul_f32 v232, v114, v114
  v_mfma_f32_32x32x16_bf16 v[158:173], v[216:219], a[76:79], v[158:173]
  s_add_u32 m0, s37, 4096
  s_add_u32 s40, s37, 94208
  s_add_u32 s40, s40, s36
  buffer_load_dwordx4 v3, s[4:7], s40 offen offset:0 sc1 lds
  v_mul_f32 v233, v115, v115
  v_mul_f32 v234, v116, v116
  v_mul_f32 v235, v117, v117
  v_fma_f32 v232, v232, v245, v244
  s_waitcnt lgkmcnt(2)
  v_mfma_f32_32x32x16_bf16 v[142:157], v[220:223], a[80:83], v[142:157]
  ds_read_b128 v[216:219], v3 offset:51200
  v_fma_f32 v233, v233, v245, v244
  v_fma_f32 v234, v234, v245, v244
  v_fma_f32 v235, v235, v245, v244
  v_mul_f32 v232, v232, v114
  v_mfma_f32_32x32x16_bf16 v[158:173], v[220:223], a[84:87], v[158:173]
  s_add_u32 s42, s41, 0
  buffer_load_dwordx4 a[0:3], v3, s[8:11], s42 offen sc1
  v_mul_f32 v233, v233, v115
  v_mul_f32 v234, v234, v116
  v_mul_f32 v235, v235, v117
  v_mfma_f32_32x32x16_bf16 v[142:157], v[224:227], a[88:91], v[142:157]
  ds_read_b128 v[220:223], v3 offset:52224
  v_exp_f32 v232, v232
  v_mul_f32 v122, v122, v114
  v_exp_f32 v233, v233
  v_mfma_f32_32x32x16_bf16 v[158:173], v[224:227], a[92:95], v[158:173]
  buffer_load_dwordx4 a[4:7], v2, s[8:11], s42 offen sc1
  v_mul_f32 v123, v123, v115
  v_exp_f32 v234, v234
  v_mul_f32 v124, v124, v116
  s_waitcnt lgkmcnt(2)
  v_mfma_f32_32x32x16_bf16 v[142:157], v[208:211], a[96:99], v[142:157]
  ds_read_b128 v[224:227], v3 offset:53248
  v_exp_f32 v235, v235
  v_mul_f32 v125, v125, v117
  v_fma_f32 v232, v232, v246, v246
  v_mfma_f32_32x32x16_bf16 v[158:173], v[208:211], a[100:103], v[158:173]
  s_add_u32 s42, s41, 1024
  buffer_load_dwordx4 a[8:11], v3, s[8:11], s42 offen sc1
  v_fma_f32 v233, v233, v246, v246
  v_fma_f32 v234, v234, v246, v246
  v_fma_f32 v235, v235, v246, v246
  v_mfma_f32_32x32x16_bf16 v[142:157], v[212:215], a[104:107], v[142:157]
  ds_read_b128 v[208:211], v3 offset:54272
  v_rcp_f32 v232, v232
  v_rcp_f32 v233, v233
  v_mfma_f32_32x32x16_bf16 v[158:173], v[212:215], a[108:111], v[158:173]
  buffer_load_dwordx4 a[12:15], v2, s[8:11], s42 offen sc1
  v_rcp_f32 v234, v234
  v_rcp_f32 v235, v235
  s_waitcnt lgkmcnt(2)
  v_mfma_f32_32x32x16_bf16 v[142:157], v[216:219], a[112:115], v[142:157]
  ds_read_b128 v[212:215], v3 offset:55296
  v_mul_f32 v122, v122, v232
  v_mul_f32 v123, v123, v233
  v_mul_f32 v124, v124, v234
  v_mul_f32 v125, v125, v235
  v_mfma_f32_32x32x16_bf16 v[158:173], v[216:219], a[116:119], v[158:173]
  s_add_u32 s42, s41, 5120
  buffer_load_dwordx4 a[40:43], v3, s[8:11], s42 offen sc1
  v_cvt_pk_bf16_f32 v238, v122, v123
  v_cvt_pk_bf16_f32 v239, v124, v125
  buffer_store_dwordx4 v[236:239], v8, s[8:11], s26 offen offset:3584 sc1
  v_mul_f32 v228, v126, v126
  v_mfma_f32_32x32x16_bf16 v[142:157], v[220:223], a[120:123], v[142:157]
  ds_read_b128 v[216:219], v3 offset:56320
  v_mul_f32 v229, v127, v127
  v_mul_f32 v230, v128, v128
  v_mul_f32 v231, v129, v129
  v_fma_f32 v228, v228, v248, v247
  v_fma_f32 v229, v229, v248, v247
  v_mfma_f32_32x32x16_bf16 v[158:173], v[220:223], a[124:127], v[158:173]
  buffer_load_dwordx4 a[44:47], v2, s[8:11], s42 offen sc1
  v_fma_f32 v230, v230, v248, v247
  v_fma_f32 v231, v231, v248, v247
  v_mul_f32 v228, v228, v126
  v_mul_f32 v229, v229, v127
  s_waitcnt lgkmcnt(2)
  v_mfma_f32_32x32x16_bf16 v[142:157], v[224:227], a[128:131], v[142:157]
  ds_read_b128 v[220:223], v3 offset:57344
  v_mul_f32 v230, v230, v128
  v_mul_f32 v231, v231, v129
  v_exp_f32 v228, v228
  v_mfma_f32_32x32x16_bf16 v[158:173], v[224:227], a[132:135], v[158:173]
  s_add_u32 s42, s41, 6144
  buffer_load_dwordx4 a[48:51], v3, s[8:11], s42 offen sc1
  v_mul_f32 v134, v134, v126
  v_exp_f32 v229, v229
  v_mul_f32 v135, v135, v127
  v_mfma_f32_32x32x16_bf16 v[142:157], v[208:211], a[136:139], v[142:157]
  ds_read_b128 v[224:227], v3 offset:58368
  v_exp_f32 v230, v230
  v_mul_f32 v136, v136, v128
  v_exp_f32 v231, v231
  v_mfma_f32_32x32x16_bf16 v[158:173], v[208:211], a[140:143], v[158:173]
  buffer_load_dwordx4 a[52:55], v2, s[8:11], s42 offen sc1
  v_mul_f32 v137, v137, v129
  v_fma_f32 v228, v228, v249, v249
  v_fma_f32 v229, v229, v249, v249
  v_fma_f32 v230, v230, v249, v249
  s_waitcnt lgkmcnt(2)
  v_mfma_f32_32x32x16_bf16 v[142:157], v[212:215], a[144:147], v[142:157]
  ds_read_b128 v[208:211], v3 offset:59392
  v_fma_f32 v231, v231, v249, v249
  v_rcp_f32 v228, v228
  v_mfma_f32_32x32x16_bf16 v[158:173], v[212:215], a[148:151], v[158:173]
  s_add_u32 s42, s41, 9216
  buffer_load_dwordx4 a[72:75], v3, s[8:11], s42 offen sc1
  v_rcp_f32 v229, v229
  v_rcp_f32 v230, v230
  v_mfma_f32_32x32x16_bf16 v[142:157], v[216:219], a[152:155], v[142:157]
  ds_read_b128 v[212:215], v3 offset:60416
  v_rcp_f32 v231, v231
  v_mul_f32 v134, v134, v228
  v_mul_f32 v135, v135, v229
  v_mul_f32 v136, v136, v230
  v_mfma_f32_32x32x16_bf16 v[158:173], v[216:219], a[156:159], v[158:173]
  buffer_load_dwordx4 a[76:79], v2, s[8:11], s42 offen sc1
  v_mul_f32 v137, v137, v231
  v_cvt_pk_bf16_f32 v240, v134, v135
  v_cvt_pk_bf16_f32 v241, v136, v137
  v_mul_f32 v232, v130, v130
  s_waitcnt lgkmcnt(2)
  v_mfma_f32_32x32x16_bf16 v[142:157], v[220:223], a[160:163], v[142:157]
  ds_read_b128 v[216:219], v3 offset:61440
  v_mul_f32 v233, v131, v131
  v_mul_f32 v234, v132, v132
  v_mul_f32 v235, v133, v133
  v_fma_f32 v232, v232, v248, v247
  v_mfma_f32_32x32x16_bf16 v[158:173], v[220:223], a[164:167], v[158:173]
  s_add_u32 s42, s41, 10240
  buffer_load_dwordx4 a[80:83], v3, s[8:11], s42 offen sc1
  v_fma_f32 v233, v233, v248, v247
  v_fma_f32 v234, v234, v248, v247
  v_fma_f32 v235, v235, v248, v247
  v_mul_f32 v232, v232, v130
  v_mfma_f32_32x32x16_bf16 v[142:157], v[224:227], a[168:171], v[142:157]
  ds_read_b128 v[220:223], v3 offset:62464
  v_mul_f32 v233, v233, v131
  v_mul_f32 v234, v234, v132
  v_mul_f32 v235, v235, v133
  v_exp_f32 v232, v232
  v_mfma_f32_32x32x16_bf16 v[158:173], v[224:227], a[172:175], v[158:173]
  buffer_load_dwordx4 a[84:87], v2, s[8:11], s42 offen sc1
  v_mul_f32 v138, v138, v130
  v_exp_f32 v233, v233
  v_mul_f32 v139, v139, v131
  s_waitcnt lgkmcnt(2)
  v_mfma_f32_32x32x16_bf16 v[142:157], v[208:211], a[176:179], v[142:157]
  ds_read_b128 v[224:227], v3 offset:63488
  v_exp_f32 v234, v234
  v_mul_f32 v140, v140, v132
  v_mfma_f32_32x32x16_bf16 v[158:173], v[208:211], a[180:183], v[158:173]
  s_add_u32 s42, s41, 14336
  buffer_load_dwordx4 a[112:115], v3, s[8:11], s42 offen sc1
  v_exp_f32 v235, v235
  v_mul_f32 v141, v141, v133
  v_fma_f32 v232, v232, v249, v249
  v_mfma_f32_32x32x16_bf16 v[142:157], v[212:215], a[184:187], v[142:157]
  ds_read_b128 v[208:211], v3 offset:64512
  v_fma_f32 v233, v233, v249, v249
  v_fma_f32 v234, v234, v249, v249
  v_fma_f32 v235, v235, v249, v249
  v_rcp_f32 v232, v232
  v_mfma_f32_32x32x16_bf16 v[158:173], v[212:215], a[188:191], v[158:173]
  buffer_load_dwordx4 a[116:119], v2, s[8:11], s42 offen sc1
  v_rcp_f32 v233, v233
  v_rcp_f32 v234, v234
  s_waitcnt lgkmcnt(2)
  v_mfma_f32_32x32x16_bf16 v[142:157], v[216:219], a[192:195], v[142:157]
  ds_read_b128 v[212:215], v4 offset:0
  v_rcp_f32 v235, v235
  v_mul_f32 v138, v138, v232
  v_mul_f32 v139, v139, v233
  v_mfma_f32_32x32x16_bf16 v[158:173], v[216:219], a[196:199], v[158:173]
  s_add_u32 s42, s41, 15360
  buffer_load_dwordx4 a[120:123], v3, s[8:11], s42 offen sc1
  v_mul_f32 v140, v140, v234
  v_mul_f32 v141, v141, v235
  v_cvt_pk_bf16_f32 v242, v138, v139
  v_cvt_pk_bf16_f32 v243, v140, v141
  v_mfma_f32_32x32x16_bf16 v[142:157], v[220:223], a[200:203], v[142:157]
  ds_read_b128 v[216:219], v4 offset:1024
  buffer_store_dwordx4 v[240:243], v8, s[8:11], s27 offen offset:3584 sc1
  v_mfma_f32_32x32x16_bf16 v[158:173], v[220:223], a[204:207], v[158:173]
  buffer_load_dwordx4 a[124:127], v2, s[8:11], s42 offen sc1
  s_waitcnt lgkmcnt(2)
  v_mfma_f32_32x32x16_bf16 v[142:157], v[224:227], a[208:211], v[142:157]
  ds_read_b128 v[220:223], v4 offset:2048
  v_mfma_f32_32x32x16_bf16 v[158:173], v[224:227], a[212:215], v[158:173]
  s_add_u32 s42, s41, 18432
  buffer_load_dwordx4 a[144:147], v3, s[8:11], s42 offen sc1
  v_mfma_f32_32x32x16_bf16 v[142:157], v[208:211], a[216:219], v[142:157]
  ds_read_b128 v[224:227], v4 offset:3072
  v_mfma_f32_32x32x16_bf16 v[158:173], v[208:211], a[220:223], v[158:173]
  buffer_load_dwordx4 a[148:151], v2, s[8:11], s42 offen sc1
  s_waitcnt lgkmcnt(2)
  v_mfma_f32_32x32x16_bf16 v[142:157], v[212:215], a[224:227], v[142:157]
  ds_read_b128 v[208:211], v4 offset:4096
  v_mfma_f32_32x32x16_bf16 v[158:173], v[212:215], a[228:231], v[158:173]
  s_add_u32 s42, s41, 19456
  buffer_load_dwordx4 a[152:155], v3, s[8:11], s42 offen sc1
  v_mfma_f32_32x32x16_bf16 v[142:157], v[216:219], a[232:235], v[142:157]
  ds_read_b128 v[212:215], v4 offset:5120
  v_mfma_f32_32x32x16_bf16 v[158:173], v[216:219], a[236:239], v[158:173]
  buffer_load_dwordx4 a[156:159], v2, s[8:11], s42 offen sc1
  s_waitcnt lgkmcnt(2)
  v_mfma_f32_32x32x16_bf16 v[142:157], v[220:223], a[240:243], v[142:157]
  ds_read_b128 v[216:219], v4 offset:6144
  v_mfma_f32_32x32x16_bf16 v[158:173], v[220:223], a[244:247], v[158:173]
  s_add_u32 s42, s41, 23552
  buffer_load_dwordx4 a[184:187], v3, s[8:11], s42 offen sc1
  v_mfma_f32_32x32x16_bf16 v[142:157], v[224:227], a[248:251], v[142:157]
  ds_read_b128 v[220:223], v4 offset:7168
  v_mfma_f32_32x32x16_bf16 v[158:173], v[224:227], a[252:255], v[158:173]
  buffer_load_dwordx4 a[188:191], v2, s[8:11], s42 offen sc1
  v_mov_b32 v12, 2
  v_min_u32 v13, 1, v1
  v_lshlrev_b32 v13, 31, v13
  buffer_store_dword v12, v13, s[8:11], s35 offen sc1
  s_waitcnt lgkmcnt(2)
  v_mfma_f32_32x32x16_bf16 v[142:157], v[208:211], v[14:17], v[142:157]
  v_mfma_f32_32x32x16_bf16 v[158:173], v[208:211], v[18:21], v[158:173]
  s_add_u32 s42, s41, 24576
  buffer_load_dwordx4 a[192:195], v3, s[8:11], s42 offen sc1
  v_mfma_f32_32x32x16_bf16 v[142:157], v[212:215], v[22:25], v[142:157]
  v_mfma_f32_32x32x16_bf16 v[158:173], v[212:215], v[26:29], v[158:173]
  buffer_load_dwordx4 a[196:199], v2, s[8:11], s42 offen sc1
  s_waitcnt lgkmcnt(0)
  v_mfma_f32_32x32x16_bf16 v[142:157], v[216:219], v[30:33], v[142:157]
  v_mfma_f32_32x32x16_bf16 v[158:173], v[216:219], v[34:37], v[158:173]
  v_mfma_f32_32x32x16_bf16 v[142:157], v[220:223], v[38:41], v[142:157]
  v_mfma_f32_32x32x16_bf16 v[158:173], v[220:223], v[42:45], v[158:173]
down_part:
  s_mov_b32 s17, s44
  s_mov_b32 s18, s45
  s_mov_b32 s19, s46
  s_mov_b32 s34, s55
  s_mov_b32 s21, s41
  v_add_u32 v4, 0x10000, v3
  v_add_u32 v5, 0x20000, v3
  v_and_b32 v14, 15, v1
  v_lshrrev_b32 v15, 4, v1
  v_lshlrev_b32 v6, 4, v14
  v_lshl_add_u32 v6, v15, 9, v6
  v_lshrrev_b32 v18, 5, v1
  v_lshlrev_b32 v7, 4, v14
  v_lshl_add_u32 v7, v18, 9, v7
  v_and_b32 v19, 1, v15
  v_lshl_add_u32 v7, v19, 3, v7
  s_mul_i32 s23, s19, 36864
  s_mul_i32 s24, s17, 9216
  s_add_u32 s23, s23, s24
  s_add_u32 s25, s23, 24125440
  s_lshl_b32 s24, s18, 11
  s_add_u32 s24, s24, s23
  s_add_u32 s32, s24, 24117248
  v_mul_f32 v228, v142, v142
  v_mul_f32 v229, v143, v143
  v_mul_f32 v230, v144, v144
  v_mul_f32 v231, v145, v145
  v_fma_f32 v228, v228, v245, v244
  v_fma_f32 v229, v229, v245, v244
  v_fma_f32 v230, v230, v245, v244
  v_fma_f32 v231, v231, v245, v244
  v_mul_f32 v228, v228, v142
  v_mul_f32 v229, v229, v143
  v_mul_f32 v230, v230, v144
  v_mul_f32 v231, v231, v145
  v_exp_f32 v228, v228
  v_mul_f32 v150, v150, v142
  v_exp_f32 v229, v229
  v_mul_f32 v151, v151, v143
  v_exp_f32 v230, v230
  v_mul_f32 v152, v152, v144
  v_exp_f32 v231, v231
  v_mul_f32 v153, v153, v145
  v_fma_f32 v228, v228, v246, v246
  v_fma_f32 v229, v229, v246, v246
  v_fma_f32 v230, v230, v246, v246
  v_fma_f32 v231, v231, v246, v246
  v_rcp_f32 v228, v228
  v_rcp_f32 v229, v229
  v_rcp_f32 v230, v230
  v_rcp_f32 v231, v231
  v_mul_f32 v150, v150, v228
  v_mul_f32 v151, v151, v229
  v_mul_f32 v152, v152, v230
  v_mul_f32 v153, v153, v231
  v_cvt_pk_bf16_f32 v236, v150, v151
  v_cvt_pk_bf16_f32 v237, v152, v153
  v_mul_f32 v232, v146, v146
  v_mul_f32 v233, v147, v147
  v_mul_f32 v234, v148, v148
  v_mul_f32 v235, v149, v149
  v_fma_f32 v232, v232, v245, v244
  v_fma_f32 v233, v233, v245, v244
  v_fma_f32 v234, v234, v245, v244
  v_fma_f32 v235, v235, v245, v244
  v_mul_f32 v232, v232, v146
  v_mul_f32 v233, v233, v147
  v_mul_f32 v234, v234, v148
  v_mul_f32 v235, v235, v149
  v_exp_f32 v232, v232
  v_mul_f32 v154, v154, v146
  v_exp_f32 v233, v233
  v_mul_f32 v155, v155, v147
  v_exp_f32 v234, v234
  v_mul_f32 v156, v156, v148
  v_exp_f32 v235, v235
  v_mul_f32 v157, v157, v149
  v_fma_f32 v232, v232, v246, v246
  v_fma_f32 v233, v233, v246, v246
  v_fma_f32 v234, v234, v246, v246
  v_fma_f32 v235, v235, v246, v246
  v_rcp_f32 v232, v232
  v_rcp_f32 v233, v233
  v_rcp_f32 v234, v234
  v_rcp_f32 v235, v235
  v_mul_f32 v154, v154, v232
  v_mul_f32 v155, v155, v233
  v_mul_f32 v156, v156, v234
  v_mul_f32 v157, v157, v235
  v_cvt_pk_bf16_f32 v238, v154, v155
  v_cvt_pk_bf16_f32 v239, v156, v157
  buffer_store_dwordx4 v[236:239], v8, s[8:11], s28 offen offset:0 sc1
  v_mul_f32 v228, v158, v158
  v_mul_f32 v229, v159, v159
  v_mul_f32 v230, v160, v160
  v_mul_f32 v231, v161, v161
  v_fma_f32 v228, v228, v248, v247
  v_fma_f32 v229, v229, v248, v247
  v_fma_f32 v230, v230, v248, v247
  v_fma_f32 v231, v231, v248, v247
  v_mul_f32 v228, v228, v158
  v_mul_f32 v229, v229, v159
  v_mul_f32 v230, v230, v160
  v_mul_f32 v231, v231, v161
  v_exp_f32 v228, v228
  v_mul_f32 v166, v166, v158
  v_exp_f32 v229, v229
  v_mul_f32 v167, v167, v159
  v_exp_f32 v230, v230
  v_mul_f32 v168, v168, v160
  v_exp_f32 v231, v231
  v_mul_f32 v169, v169, v161
  v_fma_f32 v228, v228, v249, v249
  v_fma_f32 v229, v229, v249, v249
  v_fma_f32 v230, v230, v249, v249
  v_fma_f32 v231, v231, v249, v249
  v_rcp_f32 v228, v228
  v_rcp_f32 v229, v229
  v_rcp_f32 v230, v230
  v_rcp_f32 v231, v231
  v_mul_f32 v166, v166, v228
  v_mul_f32 v167, v167, v229
  v_mul_f32 v168, v168, v230
  v_mul_f32 v169, v169, v231
  v_cvt_pk_bf16_f32 v240, v166, v167
  v_cvt_pk_bf16_f32 v241, v168, v169
  v_mul_f32 v232, v162, v162
  v_mul_f32 v233, v163, v163
  v_mul_f32 v234, v164, v164
  v_mul_f32 v235, v165, v165
  v_fma_f32 v232, v232, v248, v247
  v_fma_f32 v233, v233, v248, v247
  v_fma_f32 v234, v234, v248, v247
  v_fma_f32 v235, v235, v248, v247
  v_mul_f32 v232, v232, v162
  v_mul_f32 v233, v233, v163
  v_mul_f32 v234, v234, v164
  v_mul_f32 v235, v235, v165
  v_exp_f32 v232, v232
  v_mul_f32 v170, v170, v162
  v_exp_f32 v233, v233
  v_mul_f32 v171, v171, v163
  v_exp_f32 v234, v234
  v_mul_f32 v172, v172, v164
  v_exp_f32 v235, v235
  v_mul_f32 v173, v173, v165
  v_fma_f32 v232, v232, v249, v249
  v_fma_f32 v233, v233, v249, v249
  v_fma_f32 v234, v234, v249, v249
  v_fma_f32 v235, v235, v249, v249
  v_rcp_f32 v232, v232
  v_rcp_f32 v233, v233
  v_rcp_f32 v234, v234
  v_rcp_f32 v235, v235
  v_mul_f32 v170, v170, v232
  v_mul_f32 v171, v171, v233
  v_mul_f32 v172, v172, v234
  v_mul_f32 v173, v173, v235
  v_cvt_pk_bf16_f32 v242, v170, v171
  v_cvt_pk_bf16_f32 v243, v172, v173
  buffer_store_dwordx4 v[240:243], v8, s[8:11], s29 offen offset:0 sc1
  s_waitcnt vmcnt(29)
  s_barrier
  ds_read_b128 v[174:177], v4 offset:8192
  ds_read_b128 v[178:181], v4 offset:9216
  ds_read_b128 v[182:185], v4 offset:10240
  ds_read_b128 v[186:189], v4 offset:11264
  ds_read_b128 v[190:193], v4 offset:12288
  ds_read_b128 v[194:197], v4 offset:13312
  s_waitcnt vmcnt(27) lgkmcnt(4)
  v_mfma_f32_16x16x32_bf16 v[24:27], v[174:177], a[0:3], 0
  ds_read_b128 v[198:201], v4 offset:14336
  v_mfma_f32_16x16x32_bf16 v[28:31], v[174:177], a[4:7], 0
  s_mul_i32 s37, s20, 5120
  s_add_u32 m0, s37, 20480
  s_add_u32 s40, s37, 110592
  s_add_u32 s40, s40, s36
  buffer_load_dwordx4 v3, s[4:7], s40 offen offset:0 sc1 lds
  v_mfma_f32_16x16x32_bf16 v[32:35], v[178:181], a[0:3], 0
  ds_read_b128 v[202:205], v4 offset:15360
  v_mfma_f32_16x16x32_bf16 v[36:39], v[178:181], a[4:7], 0
  buffer_load_dwordx4 v3, s[4:7], s40 offen offset:1024 sc1 lds
  s_waitcnt lgkmcnt(4)
  v_mfma_f32_16x16x32_bf16 v[40:43], v[182:185], a[0:3], 0
  ds_read_b128 v[174:177], v4 offset:16384
  v_mfma_f32_16x16x32_bf16 v[44:47], v[182:185], a[4:7], 0
  buffer_load_dwordx4 v3, s[4:7], s40 offen offset:2048 sc1 lds
  v_mfma_f32_16x16x32_bf16 v[48:51], v[186:189], a[0:3], 0
  ds_read_b128 v[178:181], v4 offset:17408
  v_mfma_f32_16x16x32_bf16 v[52:55], v[186:189], a[4:7], 0
  buffer_load_dwordx4 v3, s[4:7], s40 offen offset:3072 sc1 lds
  s_waitcnt lgkmcnt(4)
  v_mfma_f32_16x16x32_bf16 v[88:91], v[190:193], a[0:3], 0
  ds_read_b128 v[182:185], v4 offset:18432
  v_mov_b32 v12, 3
  v_mfma_f32_16x16x32_bf16 v[92:95], v[190:193], a[4:7], 0
  s_add_u32 m0, s37, 24576
  s_add_u32 s40, s37, 114688
  s_add_u32 s40, s40, s36
  buffer_load_dwordx4 v3, s[4:7], s40 offen offset:0 sc1 lds
  v_min_u32 v13, 1, v1
  s_waitcnt vmcnt(30)
  v_mfma_f32_16x16x32_bf16 v[24:27], v[194:197], a[8:11], v[24:27]
  ds_read_b128 v[186:189], v4 offset:19456
  v_lshlrev_b32 v13, 31, v13
  v_mfma_f32_16x16x32_bf16 v[28:31], v[194:197], a[12:15], v[28:31]
  s_waitcnt vmcnt(5)
  s_waitcnt lgkmcnt(4)
  v_mfma_f32_16x16x32_bf16 v[32:35], v[198:201], a[8:11], v[32:35]
  ds_read_b128 v[190:193], v4 offset:20480
  buffer_store_dword v12, v13, s[8:11], s35 offen sc1
  v_mfma_f32_16x16x32_bf16 v[36:39], v[198:201], a[12:15], v[36:39]
  s_mul_i32 s37, s20, 5120
  s_add_u32 m0, s37, 40960
  s_add_u32 s40, s37, 131072
  s_add_u32 s40, s40, s36
  buffer_load_dwordx4 v3, s[4:7], s40 offen offset:0 sc1 lds
  v_mfma_f32_16x16x32_bf16 v[40:43], v[202:205], a[8:11], v[40:43]
  ds_read_b128 v[194:197], v4 offset:21504
  v_mfma_f32_16x16x32_bf16 v[44:47], v[202:205], a[12:15], v[44:47]
  s_waitcnt lgkmcnt(4)
  v_mfma_f32_16x16x32_bf16 v[48:51], v[174:177], a[8:11], v[48:51]
  ds_read_b128 v[198:201], v4 offset:22528
  v_mfma_f32_16x16x32_bf16 v[52:55], v[174:177], a[12:15], v[52:55]
  v_mfma_f32_16x16x32_bf16 v[88:91], v[178:181], a[8:11], v[88:91]
  ds_read_b128 v[202:205], v4 offset:23552
  v_mfma_f32_16x16x32_bf16 v[92:95], v[178:181], a[12:15], v[92:95]
  s_waitcnt lgkmcnt(4)
  v_mfma_f32_16x16x32_bf16 v[24:27], v[182:185], a[40:43], v[24:27]
  ds_read_b128 v[174:177], v4 offset:24576
  v_mfma_f32_16x16x32_bf16 v[28:31], v[182:185], a[44:47], v[28:31]
  buffer_load_dwordx4 v3, s[4:7], s40 offen offset:1024 sc1 lds
  v_mfma_f32_16x16x32_bf16 v[32:35], v[186:189], a[40:43], v[32:35]
  ds_read_b128 v[178:181], v4 offset:25600
  v_mfma_f32_16x16x32_bf16 v[36:39], v[186:189], a[44:47], v[36:39]
  s_waitcnt lgkmcnt(4)
  v_mfma_f32_16x16x32_bf16 v[40:43], v[190:193], a[40:43], v[40:43]
  ds_read_b128 v[182:185], v4 offset:26624
  v_mfma_f32_16x16x32_bf16 v[44:47], v[190:193], a[44:47], v[44:47]
  v_mfma_f32_16x16x32_bf16 v[48:51], v[194:197], a[40:43], v[48:51]
  ds_read_b128 v[186:189], v4 offset:27648
  v_mfma_f32_16x16x32_bf16 v[52:55], v[194:197], a[44:47], v[52:55]
  s_waitcnt lgkmcnt(4)
  v_mfma_f32_16x16x32_bf16 v[88:91], v[198:201], a[40:43], v[88:91]
  ds_read_b128 v[190:193], v4 offset:28672
  v_mfma_f32_16x16x32_bf16 v[92:95], v[198:201], a[44:47], v[92:95]
  buffer_load_dwordx4 v3, s[4:7], s40 offen offset:2048 sc1 lds
  v_mfma_f32_16x16x32_bf16 v[24:27], v[202:205], a[48:51], v[24:27]
  ds_read_b128 v[194:197], v4 offset:29696
  v_mfma_f32_16x16x32_bf16 v[28:31], v[202:205], a[52:55], v[28:31]
  s_waitcnt lgkmcnt(4)
  v_mfma_f32_16x16x32_bf16 v[32:35], v[174:177], a[48:51], v[32:35]
  ds_read_b128 v[198:201], v4 offset:30720
  v_mfma_f32_16x16x32_bf16 v[36:39], v[174:177], a[52:55], v[36:39]
  v_mfma_f32_16x16x32_bf16 v[40:43], v[178:181], a[48:51], v[40:43]
  ds_read_b128 v[202:205], v4 offset:31744
  v_mfma_f32_16x16x32_bf16 v[44:47], v[178:181], a[52:55], v[44:47]
  s_waitcnt lgkmcnt(4)
  v_mfma_f32_16x16x32_bf16 v[48:51], v[182:185], a[48:51], v[48:51]
  ds_read_b128 v[174:177], v4 offset:32768
  v_mfma_f32_16x16x32_bf16 v[52:55], v[182:185], a[52:55], v[52:55]
  buffer_load_dwordx4 v3, s[4:7], s40 offen offset:3072 sc1 lds
  v_mfma_f32_16x16x32_bf16 v[88:91], v[186:189], a[48:51], v[88:91]
  ds_read_b128 v[178:181], v4 offset:33792
  v_mfma_f32_16x16x32_bf16 v[92:95], v[186:189], a[52:55], v[92:95]
  s_waitcnt lgkmcnt(4)
  v_mfma_f32_16x16x32_bf16 v[24:27], v[190:193], a[72:75], v[24:27]
  ds_read_b128 v[182:185], v4 offset:34816
  v_mfma_f32_16x16x32_bf16 v[28:31], v[190:193], a[76:79], v[28:31]
  v_mfma_f32_16x16x32_bf16 v[32:35], v[194:197], a[72:75], v[32:35]
  ds_read_b128 v[186:189], v4 offset:35840
  v_mfma_f32_16x16x32_bf16 v[36:39], v[194:197], a[76:79], v[36:39]
  s_waitcnt lgkmcnt(4)
  v_mfma_f32_16x16x32_bf16 v[40:43], v[198:201], a[72:75], v[40:43]
  ds_read_b128 v[190:193], v4 offset:36864
  v_mfma_f32_16x16x32_bf16 v[44:47], v[198:201], a[76:79], v[44:47]
  s_add_u32 m0, s37, 45056
  s_add_u32 s40, s37, 135168
  s_add_u32 s40, s40, s36
  buffer_load_dwordx4 v3, s[4:7], s40 offen offset:0 sc1 lds
  v_mfma_f32_16x16x32_bf16 v[48:51], v[202:205], a[72:75], v[48:51]
  ds_read_b128 v[194:197], v4 offset:37888
  v_mfma_f32_16x16x32_bf16 v[52:55], v[202:205], a[76:79], v[52:55]
  s_waitcnt lgkmcnt(4)
  v_mfma_f32_16x16x32_bf16 v[88:91], v[174:177], a[72:75], v[88:91]
  ds_read_b128 v[198:201], v4 offset:38912
  v_mfma_f32_16x16x32_bf16 v[92:95], v[174:177], a[76:79], v[92:95]
  v_mfma_f32_16x16x32_bf16 v[24:27], v[178:181], a[80:83], v[24:27]
  ds_read_b128 v[202:205], v4 offset:39936
  v_mfma_f32_16x16x32_bf16 v[28:31], v[178:181], a[84:87], v[28:31]
  s_waitcnt lgkmcnt(4)
  v_mfma_f32_16x16x32_bf16 v[32:35], v[182:185], a[80:83], v[32:35]
  ds_read_b128 v[174:177], v4 offset:40960
  v_mfma_f32_16x16x32_bf16 v[36:39], v[182:185], a[84:87], v[36:39]
  v_mfma_f32_16x16x32_bf16 v[40:43], v[186:189], a[80:83], v[40:43]
  ds_read_b128 v[178:181], v4 offset:41984
  v_mfma_f32_16x16x32_bf16 v[44:47], v[186:189], a[84:87], v[44:47]
  s_waitcnt lgkmcnt(4)
  v_mfma_f32_16x16x32_bf16 v[48:51], v[190:193], a[80:83], v[48:51]
  ds_read_b128 v[182:185], v4 offset:43008
  v_mfma_f32_16x16x32_bf16 v[52:55], v[190:193], a[84:87], v[52:55]
  v_mfma_f32_16x16x32_bf16 v[88:91], v[194:197], a[80:83], v[88:91]
  ds_read_b128 v[186:189], v4 offset:44032
  v_mfma_f32_16x16x32_bf16 v[92:95], v[194:197], a[84:87], v[92:95]
  s_waitcnt lgkmcnt(4)
  v_mfma_f32_16x16x32_bf16 v[24:27], v[198:201], a[112:115], v[24:27]
  ds_read_b128 v[190:193], v4 offset:45056
  v_mfma_f32_16x16x32_bf16 v[28:31], v[198:201], a[116:119], v[28:31]
  v_mfma_f32_16x16x32_bf16 v[32:35], v[202:205], a[112:115], v[32:35]
  ds_read_b128 v[194:197], v4 offset:46080
  v_mfma_f32_16x16x32_bf16 v[36:39], v[202:205], a[116:119], v[36:39]
  s_waitcnt lgkmcnt(4)
  v_mfma_f32_16x16x32_bf16 v[40:43], v[174:177], a[112:115], v[40:43]
  ds_read_b128 v[198:201], v4 offset:47104
  v_mfma_f32_16x16x32_bf16 v[44:47], v[174:177], a[116:119], v[44:47]
  v_mfma_f32_16x16x32_bf16 v[48:51], v[178:181], a[112:115], v[48:51]
  ds_read_b128 v[202:205], v4 offset:48128
  v_mfma_f32_16x16x32_bf16 v[52:55], v[178:181], a[116:119], v[52:55]
  s_waitcnt lgkmcnt(4)
  v_mfma_f32_16x16x32_bf16 v[88:91], v[182:185], a[112:115], v[88:91]
  ds_read_b128 v[174:177], v4 offset:49152
  v_mfma_f32_16x16x32_bf16 v[92:95], v[182:185], a[116:119], v[92:95]
  v_mfma_f32_16x16x32_bf16 v[24:27], v[186:189], a[120:123], v[24:27]
  ds_read_b128 v[178:181], v4 offset:50176
  v_mfma_f32_16x16x32_bf16 v[28:31], v[186:189], a[124:127], v[28:31]
  s_waitcnt lgkmcnt(4)
  v_mfma_f32_16x16x32_bf16 v[32:35], v[190:193], a[120:123], v[32:35]
  ds_read_b128 v[182:185], v4 offset:51200
  v_mfma_f32_16x16x32_bf16 v[36:39], v[190:193], a[124:127], v[36:39]
  v_mfma_f32_16x16x32_bf16 v[40:43], v[194:197], a[120:123], v[40:43]
  ds_read_b128 v[186:189], v4 offset:52224
  v_mfma_f32_16x16x32_bf16 v[44:47], v[194:197], a[124:127], v[44:47]
  s_add_u32 s22, s21, 27648
  buffer_load_dwordx4 a[216:219], v3, s[8:11], s22 offen sc1
  s_waitcnt lgkmcnt(4)
  v_mfma_f32_16x16x32_bf16 v[48:51], v[198:201], a[120:123], v[48:51]
  ds_read_b128 v[190:193], v4 offset:53248
  v_mfma_f32_16x16x32_bf16 v[52:55], v[198:201], a[124:127], v[52:55]
  buffer_load_dwordx4 a[220:223], v2, s[8:11], s22 offen sc1
  v_mfma_f32_16x16x32_bf16 v[88:91], v[202:205], a[120:123], v[88:91]
  ds_read_b128 v[194:197], v4 offset:54272
  v_mfma_f32_16x16x32_bf16 v[92:95], v[202:205], a[124:127], v[92:95]
  s_waitcnt lgkmcnt(4)
  v_mfma_f32_16x16x32_bf16 v[24:27], v[174:177], a[144:147], v[24:27]
  ds_read_b128 v[198:201], v4 offset:55296
  v_mfma_f32_16x16x32_bf16 v[28:31], v[174:177], a[148:151], v[28:31]
  v_mfma_f32_16x16x32_bf16 v[32:35], v[178:181], a[144:147], v[32:35]
  ds_read_b128 v[202:205], v4 offset:56320
  v_mfma_f32_16x16x32_bf16 v[36:39], v[178:181], a[148:151], v[36:39]
  s_waitcnt lgkmcnt(4)
  v_mfma_f32_16x16x32_bf16 v[40:43], v[182:185], a[144:147], v[40:43]
  ds_read_b128 v[174:177], v4 offset:57344
  v_mfma_f32_16x16x32_bf16 v[44:47], v[182:185], a[148:151], v[44:47]
  s_add_u32 s22, s21, 28672
  buffer_load_dwordx4 a[224:227], v3, s[8:11], s22 offen sc1
  v_mfma_f32_16x16x32_bf16 v[48:51], v[186:189], a[144:147], v[48:51]
  ds_read_b128 v[178:181], v4 offset:58368
  v_mfma_f32_16x16x32_bf16 v[52:55], v[186:189], a[148:151], v[52:55]
  buffer_load_dwordx4 a[228:231], v2, s[8:11], s22 offen sc1
  s_waitcnt lgkmcnt(4)
  v_mfma_f32_16x16x32_bf16 v[88:91], v[190:193], a[144:147], v[88:91]
  ds_read_b128 v[182:185], v4 offset:59392
  v_mfma_f32_16x16x32_bf16 v[92:95], v[190:193], a[148:151], v[92:95]
  buffer_load_dword v11, v10, s[8:11], s54 offen sc1
  v_mfma_f32_16x16x32_bf16 v[24:27], v[194:197], a[152:155], v[24:27]
  ds_read_b128 v[186:189], v4 offset:60416
  v_mfma_f32_16x16x32_bf16 v[28:31], v[194:197], a[156:159], v[28:31]
  s_waitcnt lgkmcnt(4)
  v_mfma_f32_16x16x32_bf16 v[32:35], v[198:201], a[152:155], v[32:35]
  ds_read_b128 v[190:193], v4 offset:61440
  v_mfma_f32_16x16x32_bf16 v[36:39], v[198:201], a[156:159], v[36:39]
  v_mfma_f32_16x16x32_bf16 v[40:43], v[202:205], a[152:155], v[40:43]
  ds_read_b128 v[194:197], v4 offset:62464
  v_mfma_f32_16x16x32_bf16 v[44:47], v[202:205], a[156:159], v[44:47]
  s_add_u32 s22, s21, 32768
  buffer_load_dwordx4 v[110:113], v3, s[8:11], s22 offen sc1
  s_waitcnt lgkmcnt(4)
  v_mfma_f32_16x16x32_bf16 v[48:51], v[174:177], a[152:155], v[48:51]
  ds_read_b128 v[198:201], v4 offset:63488
  v_mfma_f32_16x16x32_bf16 v[52:55], v[174:177], a[156:159], v[52:55]
  buffer_load_dwordx4 v[114:117], v2, s[8:11], s22 offen sc1
  v_mfma_f32_16x16x32_bf16 v[88:91], v[178:181], a[152:155], v[88:91]
  ds_read_b128 v[202:205], v4 offset:64512
  v_mfma_f32_16x16x32_bf16 v[92:95], v[178:181], a[156:159], v[92:95]
  s_waitcnt lgkmcnt(4)
  v_mfma_f32_16x16x32_bf16 v[24:27], v[182:185], a[184:187], v[24:27]
  ds_read_b128 v[174:177], v5 offset:0
  v_mfma_f32_16x16x32_bf16 v[28:31], v[182:185], a[188:191], v[28:31]
  v_mfma_f32_16x16x32_bf16 v[32:35], v[186:189], a[184:187], v[32:35]
  ds_read_b128 v[178:181], v5 offset:1024
  v_mfma_f32_16x16x32_bf16 v[36:39], v[186:189], a[188:191], v[36:39]
  s_waitcnt lgkmcnt(4)
  v_mfma_f32_16x16x32_bf16 v[40:43], v[190:193], a[184:187], v[40:43]
  ds_read_b128 v[182:185], v5 offset:2048
  v_mfma_f32_16x16x32_bf16 v[44:47], v[190:193], a[188:191], v[44:47]
  s_add_u32 s22, s21, 33792
  buffer_load_dwordx4 v[118:121], v3, s[8:11], s22 offen sc1
  v_mfma_f32_16x16x32_bf16 v[48:51], v[194:197], a[184:187], v[48:51]
  ds_read_b128 v[186:189], v5 offset:3072
  v_mfma_f32_16x16x32_bf16 v[52:55], v[194:197], a[188:191], v[52:55]
  buffer_load_dwordx4 v[122:125], v2, s[8:11], s22 offen sc1
  s_waitcnt lgkmcnt(4)
  v_mfma_f32_16x16x32_bf16 v[88:91], v[198:201], a[184:187], v[88:91]
  ds_read_b128 v[190:193], v5 offset:4096
  v_mfma_f32_16x16x32_bf16 v[92:95], v[198:201], a[188:191], v[92:95]
  v_mfma_f32_16x16x32_bf16 v[24:27], v[202:205], a[192:195], v[24:27]
  ds_read_b128 v[194:197], v5 offset:5120
  v_mfma_f32_16x16x32_bf16 v[28:31], v[202:205], a[196:199], v[28:31]
  s_waitcnt lgkmcnt(4)
  v_mfma_f32_16x16x32_bf16 v[32:35], v[174:177], a[192:195], v[32:35]
  ds_read_b128 v[198:201], v5 offset:6144
  v_mfma_f32_16x16x32_bf16 v[36:39], v[174:177], a[196:199], v[36:39]
  s_waitcnt vmcnt(4)
  s_mov_b32 s53, 0
  s_branch p4_f2c
p4_f2p:
  buffer_load_dword v11, v10, s[8:11], s54 offen sc1
  s_add_u32 s53, s53, 1
  s_waitcnt vmcnt(0)
p4_f2c:
  v_add_u32 v11, v11, v9
  v_cmp_gt_u32 vcc, 2, v11
  s_cmp_gt_u32 s53, 0x8000
  s_cbranch_scc1 p4_f2g
  s_cbranch_vccnz p4_f2p
p4_f2g:
  v_mfma_f32_16x16x32_bf16 v[40:43], v[178:181], a[192:195], v[40:43]
  ds_read_b128 v[202:205], v5 offset:7168
  v_mfma_f32_16x16x32_bf16 v[44:47], v[178:181], a[196:199], v[44:47]
  s_add_u32 s22, s21, 2048
  buffer_load_dwordx4 a[16:19], v3, s[8:11], s22 offen sc1
  s_waitcnt lgkmcnt(4)
  v_mfma_f32_16x16x32_bf16 v[48:51], v[182:185], a[192:195], v[48:51]
  ds_read_b128 v[174:177], v5 offset:8192
  v_mfma_f32_16x16x32_bf16 v[52:55], v[182:185], a[196:199], v[52:55]
  buffer_load_dwordx4 a[20:23], v2, s[8:11], s22 offen sc1
  v_mfma_f32_16x16x32_bf16 v[88:91], v[186:189], a[192:195], v[88:91]
  ds_read_b128 v[178:181], v5 offset:9216
  v_mfma_f32_16x16x32_bf16 v[92:95], v[186:189], a[196:199], v[92:95]
  s_waitcnt lgkmcnt(4)
  v_mfma_f32_16x16x32_bf16 v[24:27], v[190:193], a[216:219], v[24:27]
  ds_read_b128 v[182:185], v5 offset:10240
  v_mfma_f32_16x16x32_bf16 v[28:31], v[190:193], a[220:223], v[28:31]
  v_mfma_f32_16x16x32_bf16 v[32:35], v[194:197], a[216:219], v[32:35]
  ds_read_b128 v[186:189], v5 offset:11264
  v_mfma_f32_16x16x32_bf16 v[36:39], v[194:197], a[220:223], v[36:39]
  s_waitcnt lgkmcnt(4)
  v_mfma_f32_16x16x32_bf16 v[40:43], v[198:201], a[216:219], v[40:43]
  ds_read_b128 v[190:193], v5 offset:12288
  v_mfma_f32_16x16x32_bf16 v[44:47], v[198:201], a[220:223], v[44:47]
  s_add_u32 s22, s21, 7168
  buffer_load_dwordx4 a[56:59], v3, s[8:11], s22 offen sc1
  v_mfma_f32_16x16x32_bf16 v[48:51], v[202:205], a[216:219], v[48:51]
  ds_read_b128 v[194:197], v5 offset:13312
  v_mfma_f32_16x16x32_bf16 v[52:55], v[202:205], a[220:223], v[52:55]
  buffer_load_dwordx4 a[60:63], v2, s[8:11], s22 offen sc1
  s_waitcnt lgkmcnt(4)
  v_mfma_f32_16x16x32_bf16 v[88:91], v[174:177], a[216:219], v[88:91]
  ds_read_b128 v[198:201], v5 offset:14336
  v_mfma_f32_16x16x32_bf16 v[92:95], v[174:177], a[220:223], v[92:95]
  v_mfma_f32_16x16x32_bf16 v[24:27], v[178:181], a[224:227], v[24:27]
  ds_read_b128 v[202:205], v5 offset:15360
  v_mfma_f32_16x16x32_bf16 v[28:31], v[178:181], a[228:231], v[28:31]
  s_waitcnt lgkmcnt(4)
  v_mfma_f32_16x16x32_bf16 v[32:35], v[182:185], a[224:227], v[32:35]
  ds_read_b128 v[174:177], v5 offset:16384
  v_mfma_f32_16x16x32_bf16 v[36:39], v[182:185], a[228:231], v[36:39]
  v_mfma_f32_16x16x32_bf16 v[40:43], v[186:189], a[224:227], v[40:43]
  ds_read_b128 v[178:181], v5 offset:17408
  v_mfma_f32_16x16x32_bf16 v[44:47], v[186:189], a[228:231], v[44:47]
  s_add_u32 s22, s21, 11264
  buffer_load_dwordx4 a[88:91], v3, s[8:11], s22 offen sc1
  s_waitcnt lgkmcnt(4)
  v_mfma_f32_16x16x32_bf16 v[48:51], v[190:193], a[224:227], v[48:51]
  ds_read_b128 v[182:185], v5 offset:18432
  v_mfma_f32_16x16x32_bf16 v[52:55], v[190:193], a[228:231], v[52:55]
  buffer_load_dwordx4 a[92:95], v2, s[8:11], s22 offen sc1
  v_mfma_f32_16x16x32_bf16 v[88:91], v[194:197], a[224:227], v[88:91]
  ds_read_b128 v[186:189], v5 offset:19456
  v_mfma_f32_16x16x32_bf16 v[92:95], v[194:197], a[228:231], v[92:95]
  s_waitcnt vmcnt(8) lgkmcnt(4)
  v_mfma_f32_16x16x32_bf16 v[24:27], v[198:201], v[110:113], v[24:27]
  ds_read_b128 v[190:193], v5 offset:20480
  v_mfma_f32_16x16x32_bf16 v[28:31], v[198:201], v[114:117], v[28:31]
  v_mfma_f32_16x16x32_bf16 v[32:35], v[202:205], v[110:113], v[32:35]
  ds_read_b128 v[194:197], v5 offset:21504
  v_mfma_f32_16x16x32_bf16 v[36:39], v[202:205], v[114:117], v[36:39]
  s_waitcnt lgkmcnt(4)
  v_mfma_f32_16x16x32_bf16 v[40:43], v[174:177], v[110:113], v[40:43]
  ds_read_b128 v[198:201], v5 offset:22528
  v_mfma_f32_16x16x32_bf16 v[44:47], v[174:177], v[114:117], v[44:47]
  s_add_u32 s22, s21, 16384
  buffer_load_dwordx4 a[128:131], v3, s[8:11], s22 offen sc1
  v_mfma_f32_16x16x32_bf16 v[48:51], v[178:181], v[110:113], v[48:51]
  ds_read_b128 v[202:205], v5 offset:23552
  v_mfma_f32_16x16x32_bf16 v[52:55], v[178:181], v[114:117], v[52:55]
  buffer_load_dwordx4 a[132:135], v2, s[8:11], s22 offen sc1
  s_waitcnt lgkmcnt(4)
  v_mfma_f32_16x16x32_bf16 v[88:91], v[182:185], v[110:113], v[88:91]
  ds_read_b128 v[174:177], v5 offset:24576
  v_mfma_f32_16x16x32_bf16 v[92:95], v[182:185], v[114:117], v[92:95]
  s_waitcnt vmcnt(8)
  v_mfma_f32_16x16x32_bf16 v[24:27], v[186:189], v[118:121], v[24:27]
  ds_read_b128 v[178:181], v5 offset:25600
  v_mfma_f32_16x16x32_bf16 v[28:31], v[186:189], v[122:125], v[28:31]
  s_waitcnt lgkmcnt(4)
  v_mfma_f32_16x16x32_bf16 v[32:35], v[190:193], v[118:121], v[32:35]
  ds_read_b128 v[182:185], v5 offset:26624
  v_mfma_f32_16x16x32_bf16 v[36:39], v[190:193], v[122:125], v[36:39]
  v_mfma_f32_16x16x32_bf16 v[40:43], v[194:197], v[118:121], v[40:43]
  ds_read_b128 v[186:189], v5 offset:27648
  v_mfma_f32_16x16x32_bf16 v[44:47], v[194:197], v[122:125], v[44:47]
  s_add_u32 s22, s21, 20480
  buffer_load_dwordx4 a[160:163], v3, s[8:11], s22 offen sc1
  s_waitcnt lgkmcnt(4)
  v_mfma_f32_16x16x32_bf16 v[48:51], v[198:201], v[118:121], v[48:51]
  ds_read_b128 v[190:193], v5 offset:28672
  v_mfma_f32_16x16x32_bf16 v[52:55], v[198:201], v[122:125], v[52:55]
  buffer_load_dwordx4 a[164:167], v2, s[8:11], s22 offen sc1
  v_mfma_f32_16x16x32_bf16 v[88:91], v[202:205], v[118:121], v[88:91]
  ds_read_b128 v[194:197], v5 offset:29696
  v_mfma_f32_16x16x32_bf16 v[92:95], v[202:205], v[122:125], v[92:95]
  s_waitcnt vmcnt(8) lgkmcnt(4)
  v_mfma_f32_16x16x32_bf16 v[24:27], v[174:177], a[16:19], v[24:27]
  ds_read_b128 v[198:201], v5 offset:30720
  v_mfma_f32_16x16x32_bf16 v[28:31], v[174:177], a[20:23], v[28:31]
  v_mfma_f32_16x16x32_bf16 v[32:35], v[178:181], a[16:19], v[32:35]
  ds_read_b128 v[202:205], v5 offset:31744
  v_mfma_f32_16x16x32_bf16 v[36:39], v[178:181], a[20:23], v[36:39]
  s_waitcnt lgkmcnt(4)
  v_mfma_f32_16x16x32_bf16 v[40:43], v[182:185], a[16:19], v[40:43]
  ds_read_b128 v[174:177], v3 offset:0
  v_mfma_f32_16x16x32_bf16 v[44:47], v[182:185], a[20:23], v[44:47]
  s_add_u32 s22, s21, 25600
  buffer_load_dwordx4 a[200:203], v3, s[8:11], s22 offen sc1
  v_mfma_f32_16x16x32_bf16 v[48:51], v[186:189], a[16:19], v[48:51]
  ds_read_b128 v[178:181], v3 offset:1024
  v_mfma_f32_16x16x32_bf16 v[52:55], v[186:189], a[20:23], v[52:55]
  buffer_load_dwordx4 a[204:207], v2, s[8:11], s22 offen sc1
  s_waitcnt lgkmcnt(4)
  v_mfma_f32_16x16x32_bf16 v[88:91], v[190:193], a[16:19], v[88:91]
  ds_read_b128 v[182:185], v3 offset:2048
  v_mfma_f32_16x16x32_bf16 v[92:95], v[190:193], a[20:23], v[92:95]
  buffer_load_dword v11, v10, s[8:11], s54 offen sc1
  s_waitcnt vmcnt(9)
  v_mfma_f32_16x16x32_bf16 v[24:27], v[194:197], a[56:59], v[24:27]
  ds_read_b128 v[186:189], v3 offset:3072
  v_mfma_f32_16x16x32_bf16 v[28:31], v[194:197], a[60:63], v[28:31]
  s_waitcnt lgkmcnt(4)
  v_mfma_f32_16x16x32_bf16 v[32:35], v[198:201], a[56:59], v[32:35]
  ds_read_b128 v[190:193], v3 offset:4096
  v_mfma_f32_16x16x32_bf16 v[36:39], v[198:201], a[60:63], v[36:39]
  v_mfma_f32_16x16x32_bf16 v[40:43], v[202:205], a[56:59], v[40:43]
  ds_read_b128 v[194:197], v3 offset:5120
  v_mfma_f32_16x16x32_bf16 v[44:47], v[202:205], a[60:63], v[44:47]
  s_add_u32 s22, s21, 29696
  buffer_load_dwordx4 a[232:235], v3, s[8:11], s22 offen sc1
  s_waitcnt lgkmcnt(4)
  v_mfma_f32_16x16x32_bf16 v[48:51], v[174:177], a[56:59], v[48:51]
  ds_read_b128 v[198:201], v3 offset:6144
  v_mfma_f32_16x16x32_bf16 v[52:55], v[174:177], a[60:63], v[52:55]
  buffer_load_dwordx4 a[236:239], v2, s[8:11], s22 offen sc1
  v_mfma_f32_16x16x32_bf16 v[88:91], v[178:181], a[56:59], v[88:91]
  ds_read_b128 v[202:205], v3 offset:7168
  v_mfma_f32_16x16x32_bf16 v[92:95], v[178:181], a[60:63], v[92:95]
  s_waitcnt vmcnt(9) lgkmcnt(4)
  v_mfma_f32_16x16x32_bf16 v[24:27], v[182:185], a[88:91], v[24:27]
  ds_read_b128 v[174:177], v3 offset:8192
  v_mfma_f32_16x16x32_bf16 v[28:31], v[182:185], a[92:95], v[28:31]
  v_mfma_f32_16x16x32_bf16 v[32:35], v[186:189], a[88:91], v[32:35]
  ds_read_b128 v[178:181], v3 offset:9216
  v_mfma_f32_16x16x32_bf16 v[36:39], v[186:189], a[92:95], v[36:39]
  s_waitcnt lgkmcnt(4)
  v_mfma_f32_16x16x32_bf16 v[40:43], v[190:193], a[88:91], v[40:43]
  ds_read_b128 v[182:185], v3 offset:10240
  v_mfma_f32_16x16x32_bf16 v[44:47], v[190:193], a[92:95], v[44:47]
  s_add_u32 s22, s21, 34816
  buffer_load_dwordx4 v[126:129], v3, s[8:11], s22 offen sc1
  v_mfma_f32_16x16x32_bf16 v[48:51], v[194:197], a[88:91], v[48:51]
  ds_read_b128 v[186:189], v3 offset:11264
  v_mfma_f32_16x16x32_bf16 v[52:55], v[194:197], a[92:95], v[52:55]
  buffer_load_dwordx4 v[130:133], v2, s[8:11], s22 offen sc1
  s_waitcnt lgkmcnt(4)
  v_mfma_f32_16x16x32_bf16 v[88:91], v[198:201], a[88:91], v[88:91]
  ds_read_b128 v[190:193], v3 offset:12288
  v_mfma_f32_16x16x32_bf16 v[92:95], v[198:201], a[92:95], v[92:95]
  s_waitcnt vmcnt(9)
  v_mfma_f32_16x16x32_bf16 v[24:27], v[202:205], a[128:131], v[24:27]
  ds_read_b128 v[194:197], v3 offset:13312
  v_mfma_f32_16x16x32_bf16 v[28:31], v[202:205], a[132:135], v[28:31]
  s_waitcnt lgkmcnt(4)
  v_mfma_f32_16x16x32_bf16 v[32:35], v[174:177], a[128:131], v[32:35]
  ds_read_b128 v[198:201], v3 offset:14336
  v_mfma_f32_16x16x32_bf16 v[36:39], v[174:177], a[132:135], v[36:39]
  s_waitcnt vmcnt(4)
  s_mov_b32 s53, 0
  s_branch p4_f3c
p4_f3p:
  buffer_load_dword v11, v10, s[8:11], s54 offen sc1
  s_add_u32 s53, s53, 1
  s_waitcnt vmcnt(0)
p4_f3c:
  v_add_u32 v11, v11, v9
  v_cmp_gt_u32 vcc, 3, v11
  s_cmp_gt_u32 s53, 0x8000
  s_cbranch_scc1 p4_f3g
  s_cbranch_vccnz p4_f3p
p4_f3g:
  v_mfma_f32_16x16x32_bf16 v[40:43], v[178:181], a[128:131], v[40:43]
  ds_read_b128 v[202:205], v3 offset:15360
  v_mfma_f32_16x16x32_bf16 v[44:47], v[178:181], a[132:135], v[44:47]
  s_add_u32 s22, s21, 3072
  buffer_load_dwordx4 a[24:27], v3, s[8:11], s22 offen sc1
  s_waitcnt lgkmcnt(4)
  v_mfma_f32_16x16x32_bf16 v[48:51], v[182:185], a[128:131], v[48:51]
  ds_read_b128 v[174:177], v3 offset:16384
  v_mfma_f32_16x16x32_bf16 v[52:55], v[182:185], a[132:135], v[52:55]
  buffer_load_dwordx4 a[28:31], v2, s[8:11], s22 offen sc1
  v_mfma_f32_16x16x32_bf16 v[88:91], v[186:189], a[128:131], v[88:91]
  ds_read_b128 v[178:181], v3 offset:17408
  v_mfma_f32_16x16x32_bf16 v[92:95], v[186:189], a[132:135], v[92:95]
  s_waitcnt lgkmcnt(4)
  v_mfma_f32_16x16x32_bf16 v[24:27], v[190:193], a[160:163], v[24:27]
  ds_read_b128 v[182:185], v3 offset:18432
  v_mfma_f32_16x16x32_bf16 v[28:31], v[190:193], a[164:167], v[28:31]
  v_mfma_f32_16x16x32_bf16 v[32:35], v[194:197], a[160:163], v[32:35]
  ds_read_b128 v[186:189], v3 offset:19456
  v_mfma_f32_16x16x32_bf16 v[36:39], v[194:197], a[164:167], v[36:39]
  s_barrier
  s_waitcnt lgkmcnt(4)
  v_mfma_f32_16x16x32_bf16 v[40:43], v[198:201], a[160:163], v[40:43]
  ds_read_b128 v[190:193], v3 offset:20480
  v_mfma_f32_16x16x32_bf16 v[44:47], v[198:201], a[164:167], v[44:47]
  s_add_u32 s22, s21, 4096
  buffer_load_dwordx4 a[32:35], v3, s[8:11], s22 offen sc1
  v_mfma_f32_16x16x32_bf16 v[48:51], v[202:205], a[160:163], v[48:51]
  ds_read_b128 v[194:197], v3 offset:21504
  v_mfma_f32_16x16x32_bf16 v[52:55], v[202:205], a[164:167], v[52:55]
  buffer_load_dwordx4 a[36:39], v2, s[8:11], s22 offen sc1
  s_waitcnt lgkmcnt(4)
  v_mfma_f32_16x16x32_bf16 v[88:91], v[174:177], a[160:163], v[88:91]
  ds_read_b128 v[198:201], v3 offset:22528
  v_mfma_f32_16x16x32_bf16 v[92:95], v[174:177], a[164:167], v[92:95]
  s_mul_i32 s37, s20, 5120
  s_add_u32 m0, s37, 61440
  s_add_u32 s40, s37, 151552
  s_add_u32 s40, s40, s36
  buffer_load_dwordx4 v3, s[4:7], s40 offen offset:0 sc1 lds
  v_mfma_f32_16x16x32_bf16 v[24:27], v[178:181], a[200:203], v[24:27]
  ds_read_b128 v[202:205], v3 offset:23552
  v_mfma_f32_16x16x32_bf16 v[28:31], v[178:181], a[204:207], v[28:31]
  buffer_load_dwordx4 v3, s[4:7], s40 offen offset:1024 sc1 lds
  s_waitcnt lgkmcnt(4)
  v_mfma_f32_16x16x32_bf16 v[32:35], v[182:185], a[200:203], v[32:35]
  ds_read_b128 v[174:177], v3 offset:24576
  v_mfma_f32_16x16x32_bf16 v[36:39], v[182:185], a[204:207], v[36:39]
  buffer_load_dwordx4 v3, s[4:7], s40 offen offset:2048 sc1 lds
  v_mfma_f32_16x16x32_bf16 v[40:43], v[186:189], a[200:203], v[40:43]
  ds_read_b128 v[178:181], v3 offset:25600
  v_mfma_f32_16x16x32_bf16 v[44:47], v[186:189], a[204:207], v[44:47]
  buffer_load_dwordx4 v3, s[4:7], s40 offen offset:3072 sc1 lds
  s_waitcnt lgkmcnt(4)
  v_mfma_f32_16x16x32_bf16 v[48:51], v[190:193], a[200:203], v[48:51]
  ds_read_b128 v[182:185], v3 offset:26624
  v_mfma_f32_16x16x32_bf16 v[52:55], v[190:193], a[204:207], v[52:55]
  s_add_u32 m0, s37, 65536
  s_add_u32 s40, s37, 155648
  s_add_u32 s40, s40, s36
  buffer_load_dwordx4 v3, s[4:7], s40 offen offset:0 sc1 lds
  v_mfma_f32_16x16x32_bf16 v[88:91], v[194:197], a[200:203], v[88:91]
  ds_read_b128 v[186:189], v3 offset:27648
  v_mfma_f32_16x16x32_bf16 v[92:95], v[194:197], a[204:207], v[92:95]
  s_mul_i32 s37, s20, 5120
  s_add_u32 m0, s37, 81920
  s_add_u32 s40, s37, 172032
  s_add_u32 s40, s40, s36
  buffer_load_dwordx4 v3, s[4:7], s40 offen offset:0 sc1 lds
  s_waitcnt vmcnt(12) lgkmcnt(4)
  v_mfma_f32_16x16x32_bf16 v[24:27], v[198:201], a[232:235], v[24:27]
  ds_read_b128 v[190:193], v3 offset:28672
  v_mfma_f32_16x16x32_bf16 v[28:31], v[198:201], a[236:239], v[28:31]
  buffer_load_dwordx4 v3, s[4:7], s40 offen offset:1024 sc1 lds
  v_mfma_f32_16x16x32_bf16 v[32:35], v[202:205], a[232:235], v[32:35]
  ds_read_b128 v[194:197], v3 offset:29696
  v_mfma_f32_16x16x32_bf16 v[36:39], v[202:205], a[236:239], v[36:39]
  buffer_load_dwordx4 v3, s[4:7], s40 offen offset:2048 sc1 lds
  s_waitcnt lgkmcnt(4)
  v_mfma_f32_16x16x32_bf16 v[40:43], v[174:177], a[232:235], v[40:43]
  ds_read_b128 v[198:201], v3 offset:30720
  v_mfma_f32_16x16x32_bf16 v[44:47], v[174:177], a[236:239], v[44:47]
  buffer_load_dwordx4 v3, s[4:7], s40 offen offset:3072 sc1 lds
  v_mfma_f32_16x16x32_bf16 v[48:51], v[178:181], a[232:235], v[48:51]
  ds_read_b128 v[202:205], v3 offset:31744
  v_mfma_f32_16x16x32_bf16 v[52:55], v[178:181], a[236:239], v[52:55]
  s_add_u32 m0, s37, 86016
  s_add_u32 s40, s37, 176128
  s_add_u32 s40, s40, s36
  buffer_load_dwordx4 v3, s[4:7], s40 offen offset:0 sc1 lds
  s_waitcnt lgkmcnt(4)
  v_mfma_f32_16x16x32_bf16 v[88:91], v[182:185], a[232:235], v[88:91]
  ds_read_b128 v[174:177], v3 offset:32768
  v_mfma_f32_16x16x32_bf16 v[92:95], v[182:185], a[236:239], v[92:95]
  s_add_u32 s22, s21, 8192
  buffer_load_dwordx4 a[64:67], v3, s[8:11], s22 offen sc1
  s_waitcnt vmcnt(15)
  v_mfma_f32_16x16x32_bf16 v[24:27], v[186:189], v[126:129], v[24:27]
  ds_read_b128 v[178:181], v3 offset:33792
  v_mfma_f32_16x16x32_bf16 v[28:31], v[186:189], v[130:133], v[28:31]
  buffer_load_dwordx4 a[68:71], v2, s[8:11], s22 offen sc1
  s_waitcnt lgkmcnt(4)
  v_mfma_f32_16x16x32_bf16 v[32:35], v[190:193], v[126:129], v[32:35]
  ds_read_b128 v[182:185], v3 offset:34816
  v_mfma_f32_16x16x32_bf16 v[36:39], v[190:193], v[130:133], v[36:39]
  s_add_u32 s22, s21, 12288
  buffer_load_dwordx4 a[96:99], v3, s[8:11], s22 offen sc1
  v_mfma_f32_16x16x32_bf16 v[40:43], v[194:197], v[126:129], v[40:43]
  ds_read_b128 v[186:189], v3 offset:35840
  v_mfma_f32_16x16x32_bf16 v[44:47], v[194:197], v[130:133], v[44:47]
  buffer_load_dwordx4 a[100:103], v2, s[8:11], s22 offen sc1
  s_waitcnt lgkmcnt(4)
  v_mfma_f32_16x16x32_bf16 v[48:51], v[198:201], v[126:129], v[48:51]
  ds_read_b128 v[190:193], v3 offset:36864
  v_mfma_f32_16x16x32_bf16 v[52:55], v[198:201], v[130:133], v[52:55]
  s_add_u32 s22, s21, 13312
  buffer_load_dwordx4 a[104:107], v3, s[8:11], s22 offen sc1
  v_mfma_f32_16x16x32_bf16 v[88:91], v[202:205], v[126:129], v[88:91]
  ds_read_b128 v[194:197], v3 offset:37888
  v_mfma_f32_16x16x32_bf16 v[92:95], v[202:205], v[130:133], v[92:95]
  buffer_load_dwordx4 a[108:111], v2, s[8:11], s22 offen sc1
  s_waitcnt vmcnt(18) lgkmcnt(4)
  v_mfma_f32_16x16x32_bf16 v[24:27], v[174:177], a[24:27], v[24:27]
  ds_read_b128 v[198:201], v3 offset:38912
  v_mfma_f32_16x16x32_bf16 v[28:31], v[174:177], a[28:31], v[28:31]
  v_mfma_f32_16x16x32_bf16 v[32:35], v[178:181], a[24:27], v[32:35]
  ds_read_b128 v[202:205], v3 offset:39936
  v_mfma_f32_16x16x32_bf16 v[36:39], v[178:181], a[28:31], v[36:39]
  s_barrier
  s_waitcnt lgkmcnt(4)
  v_mfma_f32_16x16x32_bf16 v[40:43], v[182:185], a[24:27], v[40:43]
  ds_read_b128 v[174:177], v3 offset:40960
  v_mfma_f32_16x16x32_bf16 v[44:47], v[182:185], a[28:31], v[44:47]
  s_add_u32 s22, s21, 17408
  buffer_load_dwordx4 a[136:139], v3, s[8:11], s22 offen sc1
  v_mfma_f32_16x16x32_bf16 v[48:51], v[186:189], a[24:27], v[48:51]
  ds_read_b128 v[178:181], v3 offset:41984
  v_mfma_f32_16x16x32_bf16 v[52:55], v[186:189], a[28:31], v[52:55]
  buffer_load_dwordx4 a[140:143], v2, s[8:11], s22 offen sc1
  s_waitcnt lgkmcnt(4)
  v_mfma_f32_16x16x32_bf16 v[88:91], v[190:193], a[24:27], v[88:91]
  ds_read_b128 v[182:185], v3 offset:43008
  v_mfma_f32_16x16x32_bf16 v[92:95], v[190:193], a[28:31], v[92:95]
  s_waitcnt vmcnt(18)
  v_mfma_f32_16x16x32_bf16 v[24:27], v[194:197], a[32:35], v[24:27]
  ds_read_b128 v[186:189], v3 offset:44032
  v_mfma_f32_16x16x32_bf16 v[28:31], v[194:197], a[36:39], v[28:31]
  s_waitcnt lgkmcnt(4)
  v_mfma_f32_16x16x32_bf16 v[32:35], v[198:201], a[32:35], v[32:35]
  ds_read_b128 v[190:193], v3 offset:45056
  v_mfma_f32_16x16x32_bf16 v[36:39], v[198:201], a[36:39], v[36:39]
  v_mfma_f32_16x16x32_bf16 v[40:43], v[202:205], a[32:35], v[40:43]
  ds_read_b128 v[194:197], v3 offset:46080
  v_mfma_f32_16x16x32_bf16 v[44:47], v[202:205], a[36:39], v[44:47]
  s_add_u32 s22, s21, 21504
  buffer_load_dwordx4 a[168:171], v3, s[8:11], s22 offen sc1
  s_waitcnt lgkmcnt(4)
  v_mfma_f32_16x16x32_bf16 v[48:51], v[174:177], a[32:35], v[48:51]
  ds_read_b128 v[198:201], v3 offset:47104
  v_mfma_f32_16x16x32_bf16 v[52:55], v[174:177], a[36:39], v[52:55]
  buffer_load_dwordx4 a[172:175], v2, s[8:11], s22 offen sc1
  v_mfma_f32_16x16x32_bf16 v[88:91], v[178:181], a[32:35], v[88:91]
  ds_read_b128 v[202:205], v3 offset:48128
  v_mfma_f32_16x16x32_bf16 v[92:95], v[178:181], a[36:39], v[92:95]
  s_waitcnt vmcnt(8) lgkmcnt(4)
  v_mfma_f32_16x16x32_bf16 v[24:27], v[182:185], a[64:67], v[24:27]
  ds_read_b128 v[174:177], v3 offset:49152
  v_mfma_f32_16x16x32_bf16 v[28:31], v[182:185], a[68:71], v[28:31]
  v_mfma_f32_16x16x32_bf16 v[32:35], v[186:189], a[64:67], v[32:35]
  ds_read_b128 v[178:181], v3 offset:50176
  v_mfma_f32_16x16x32_bf16 v[36:39], v[186:189], a[68:71], v[36:39]
  s_waitcnt lgkmcnt(4)
  v_mfma_f32_16x16x32_bf16 v[40:43], v[190:193], a[64:67], v[40:43]
  ds_read_b128 v[182:185], v3 offset:51200
  v_mfma_f32_16x16x32_bf16 v[44:47], v[190:193], a[68:71], v[44:47]
  s_add_u32 s22, s21, 22528
  buffer_load_dwordx4 a[176:179], v3, s[8:11], s22 offen sc1
  v_mfma_f32_16x16x32_bf16 v[48:51], v[194:197], a[64:67], v[48:51]
  ds_read_b128 v[186:189], v3 offset:52224
  v_mfma_f32_16x16x32_bf16 v[52:55], v[194:197], a[68:71], v[52:55]
  buffer_load_dwordx4 a[180:183], v2, s[8:11], s22 offen sc1
  s_waitcnt lgkmcnt(4)
  v_mfma_f32_16x16x32_bf16 v[88:91], v[198:201], a[64:67], v[88:91]
  ds_read_b128 v[190:193], v3 offset:53248
  v_mfma_f32_16x16x32_bf16 v[92:95], v[198:201], a[68:71], v[92:95]
  s_waitcnt vmcnt(8)
  v_mfma_f32_16x16x32_bf16 v[24:27], v[202:205], a[96:99], v[24:27]
  ds_read_b128 v[194:197], v3 offset:54272
  v_mfma_f32_16x16x32_bf16 v[28:31], v[202:205], a[100:103], v[28:31]
  s_waitcnt lgkmcnt(4)
  v_mfma_f32_16x16x32_bf16 v[32:35], v[174:177], a[96:99], v[32:35]
  ds_read_b128 v[198:201], v3 offset:55296
  v_mfma_f32_16x16x32_bf16 v[36:39], v[174:177], a[100:103], v[36:39]
  v_mfma_f32_16x16x32_bf16 v[40:43], v[178:181], a[96:99], v[40:43]
  ds_read_b128 v[202:205], v3 offset:56320
  v_mfma_f32_16x16x32_bf16 v[44:47], v[178:181], a[100:103], v[44:47]
  s_add_u32 s22, s21, 26624
  buffer_load_dwordx4 a[208:211], v3, s[8:11], s22 offen sc1
  s_waitcnt lgkmcnt(4)
  v_mfma_f32_16x16x32_bf16 v[48:51], v[182:185], a[96:99], v[48:51]
  ds_read_b128 v[174:177], v3 offset:57344
  v_mfma_f32_16x16x32_bf16 v[52:55], v[182:185], a[100:103], v[52:55]
  buffer_load_dwordx4 a[212:215], v2, s[8:11], s22 offen sc1
  v_mfma_f32_16x16x32_bf16 v[88:91], v[186:189], a[96:99], v[88:91]
  ds_read_b128 v[178:181], v3 offset:58368
  v_mfma_f32_16x16x32_bf16 v[92:95], v[186:189], a[100:103], v[92:95]
  s_waitcnt vmcnt(8) lgkmcnt(4)
  v_mfma_f32_16x16x32_bf16 v[24:27], v[190:193], a[104:107], v[24:27]
  ds_read_b128 v[182:185], v3 offset:59392
  v_mfma_f32_16x16x32_bf16 v[28:31], v[190:193], a[108:111], v[28:31]
  v_mfma_f32_16x16x32_bf16 v[32:35], v[194:197], a[104:107], v[32:35]
  ds_read_b128 v[186:189], v3 offset:60416
  v_mfma_f32_16x16x32_bf16 v[36:39], v[194:197], a[108:111], v[36:39]
  s_barrier
  s_waitcnt lgkmcnt(4)
  v_mfma_f32_16x16x32_bf16 v[40:43], v[198:201], a[104:107], v[40:43]
  ds_read_b128 v[190:193], v3 offset:61440
  v_mfma_f32_16x16x32_bf16 v[44:47], v[198:201], a[108:111], v[44:47]
  s_mul_i32 s37, s20, 5120
  s_add_u32 m0, s37, 102400
  s_add_u32 s40, s37, 192512
  s_add_u32 s40, s40, s36
  buffer_load_dwordx4 v3, s[4:7], s40 offen offset:0 sc1 lds
  v_mfma_f32_16x16x32_bf16 v[48:51], v[202:205], a[104:107], v[48:51]
  ds_read_b128 v[194:197], v3 offset:62464
  v_mfma_f32_16x16x32_bf16 v[52:55], v[202:205], a[108:111], v[52:55]
  s_add_u32 s22, s21, 30720
  buffer_load_dwordx4 a[240:243], v3, s[8:11], s22 offen sc1
  s_waitcnt lgkmcnt(4)
  v_mfma_f32_16x16x32_bf16 v[88:91], v[174:177], a[104:107], v[88:91]
  ds_read_b128 v[198:201], v3 offset:63488
  v_mfma_f32_16x16x32_bf16 v[92:95], v[174:177], a[108:111], v[92:95]
  buffer_load_dwordx4 a[244:247], v2, s[8:11], s22 offen sc1
  s_waitcnt vmcnt(9)
  v_mfma_f32_16x16x32_bf16 v[24:27], v[178:181], a[136:139], v[24:27]
  ds_read_b128 v[202:205], v3 offset:64512
  v_mfma_f32_16x16x32_bf16 v[28:31], v[178:181], a[140:143], v[28:31]
  s_waitcnt lgkmcnt(4)
  v_mfma_f32_16x16x32_bf16 v[32:35], v[182:185], a[136:139], v[32:35]
  ds_read_b128 v[174:177], v4 offset:0
  v_mfma_f32_16x16x32_bf16 v[36:39], v[182:185], a[140:143], v[36:39]
  buffer_load_dwordx4 v3, s[4:7], s40 offen offset:1024 sc1 lds
  v_mfma_f32_16x16x32_bf16 v[40:43], v[186:189], a[136:139], v[40:43]
  ds_read_b128 v[178:181], v4 offset:1024
  v_mfma_f32_16x16x32_bf16 v[44:47], v[186:189], a[140:143], v[44:47]
  s_add_u32 s22, s21, 31744
  buffer_load_dwordx4 a[248:251], v3, s[8:11], s22 offen sc1
  s_waitcnt lgkmcnt(4)
  v_mfma_f32_16x16x32_bf16 v[48:51], v[190:193], a[136:139], v[48:51]
  ds_read_b128 v[182:185], v4 offset:2048
  v_mfma_f32_16x16x32_bf16 v[52:55], v[190:193], a[140:143], v[52:55]
  buffer_load_dwordx4 a[252:255], v2, s[8:11], s22 offen sc1
  v_mfma_f32_16x16x32_bf16 v[88:91], v[194:197], a[136:139], v[88:91]
  ds_read_b128 v[186:189], v4 offset:3072
  v_mfma_f32_16x16x32_bf16 v[92:95], v[194:197], a[140:143], v[92:95]
  s_waitcnt vmcnt(10) lgkmcnt(4)
  v_mfma_f32_16x16x32_bf16 v[24:27], v[198:201], a[168:171], v[24:27]
  ds_read_b128 v[190:193], v4 offset:4096
  v_mfma_f32_16x16x32_bf16 v[28:31], v[198:201], a[172:175], v[28:31]
  buffer_load_dwordx4 v3, s[4:7], s40 offen offset:2048 sc1 lds
  v_mfma_f32_16x16x32_bf16 v[32:35], v[202:205], a[168:171], v[32:35]
  ds_read_b128 v[194:197], v4 offset:5120
  v_mfma_f32_16x16x32_bf16 v[36:39], v[202:205], a[172:175], v[36:39]
  s_waitcnt lgkmcnt(4)
  v_mfma_f32_16x16x32_bf16 v[40:43], v[174:177], a[168:171], v[40:43]
  ds_read_b128 v[198:201], v4 offset:6144
  v_mfma_f32_16x16x32_bf16 v[44:47], v[174:177], a[172:175], v[44:47]
  s_add_u32 s22, s21, 35840
  buffer_load_dwordx4 v[134:137], v3, s[8:11], s22 offen sc1
  v_mfma_f32_16x16x32_bf16 v[48:51], v[178:181], a[168:171], v[48:51]
  ds_read_b128 v[202:205], v4 offset:7168
  v_mfma_f32_16x16x32_bf16 v[52:55], v[178:181], a[172:175], v[52:55]
  buffer_load_dwordx4 v[138:141], v2, s[8:11], s22 offen sc1
  s_waitcnt lgkmcnt(4)
  v_mfma_f32_16x16x32_bf16 v[88:91], v[182:185], a[168:171], v[88:91]
  ds_read_b128 v[174:177], v4 offset:8192
  v_mfma_f32_16x16x32_bf16 v[92:95], v[182:185], a[172:175], v[92:95]
  buffer_load_dwordx4 v3, s[4:7], s40 offen offset:3072 sc1 lds
  s_waitcnt vmcnt(12)
  v_mfma_f32_16x16x32_bf16 v[24:27], v[186:189], a[176:179], v[24:27]
  ds_read_b128 v[178:181], v4 offset:9216
  v_mfma_f32_16x16x32_bf16 v[28:31], v[186:189], a[180:183], v[28:31]
  s_waitcnt lgkmcnt(4)
  v_mfma_f32_16x16x32_bf16 v[32:35], v[190:193], a[176:179], v[32:35]
  ds_read_b128 v[182:185], v4 offset:10240
  v_mfma_f32_16x16x32_bf16 v[36:39], v[190:193], a[180:183], v[36:39]
  v_mfma_f32_16x16x32_bf16 v[40:43], v[194:197], a[176:179], v[40:43]
  ds_read_b128 v[186:189], v4 offset:11264
  v_mfma_f32_16x16x32_bf16 v[44:47], v[194:197], a[180:183], v[44:47]
  s_waitcnt lgkmcnt(4)
  v_mfma_f32_16x16x32_bf16 v[48:51], v[198:201], a[176:179], v[48:51]
  ds_read_b128 v[190:193], v4 offset:12288
  v_mfma_f32_16x16x32_bf16 v[52:55], v[198:201], a[180:183], v[52:55]
  s_add_u32 m0, s37, 106496
  s_add_u32 s40, s37, 196608
  s_add_u32 s40, s40, s36
  buffer_load_dwordx4 v3, s[4:7], s40 offen offset:0 sc1 lds
  v_mfma_f32_16x16x32_bf16 v[88:91], v[202:205], a[176:179], v[88:91]
  ds_read_b128 v[194:197], v4 offset:13312
  v_mfma_f32_16x16x32_bf16 v[92:95], v[202:205], a[180:183], v[92:95]
  s_waitcnt vmcnt(11) lgkmcnt(4)
  v_mfma_f32_16x16x32_bf16 v[24:27], v[174:177], a[208:211], v[24:27]
  ds_read_b128 v[198:201], v4 offset:14336
  v_mfma_f32_16x16x32_bf16 v[28:31], v[174:177], a[212:215], v[28:31]
  v_mfma_f32_16x16x32_bf16 v[32:35], v[178:181], a[208:211], v[32:35]
  ds_read_b128 v[202:205], v4 offset:15360
  v_mfma_f32_16x16x32_bf16 v[36:39], v[178:181], a[212:215], v[36:39]
  s_barrier
  s_waitcnt lgkmcnt(4)
  v_mfma_f32_16x16x32_bf16 v[40:43], v[182:185], a[208:211], v[40:43]
  ds_read_b128 v[174:177], v4 offset:16384
  v_mfma_f32_16x16x32_bf16 v[44:47], v[182:185], a[212:215], v[44:47]
  s_mul_i32 s37, s20, 5120
  s_add_u32 m0, s37, 122880
  s_add_u32 s40, s37, 212992
  s_add_u32 s40, s40, s36
  buffer_load_dwordx4 v3, s[4:7], s40 offen offset:0 sc1 lds
  v_mfma_f32_16x16x32_bf16 v[48:51], v[186:189], a[208:211], v[48:51]
  ds_read_b128 v[178:181], v4 offset:17408
  v_mfma_f32_16x16x32_bf16 v[52:55], v[186:189], a[212:215], v[52:55]
  s_waitcnt lgkmcnt(4)
  v_mfma_f32_16x16x32_bf16 v[88:91], v[190:193], a[208:211], v[88:91]
  ds_read_b128 v[182:185], v4 offset:18432
  v_mfma_f32_16x16x32_bf16 v[92:95], v[190:193], a[212:215], v[92:95]
  s_waitcnt vmcnt(9)
  v_mfma_f32_16x16x32_bf16 v[24:27], v[194:197], a[240:243], v[24:27]
  ds_read_b128 v[186:189], v4 offset:19456
  v_mfma_f32_16x16x32_bf16 v[28:31], v[194:197], a[244:247], v[28:31]
  s_waitcnt lgkmcnt(4)
  v_mfma_f32_16x16x32_bf16 v[32:35], v[198:201], a[240:243], v[32:35]
  ds_read_b128 v[190:193], v4 offset:20480
  v_mfma_f32_16x16x32_bf16 v[36:39], v[198:201], a[244:247], v[36:39]
  buffer_load_dwordx4 v3, s[4:7], s40 offen offset:1024 sc1 lds
  v_mfma_f32_16x16x32_bf16 v[40:43], v[202:205], a[240:243], v[40:43]
  ds_read_b128 v[194:197], v4 offset:21504
  v_mfma_f32_16x16x32_bf16 v[44:47], v[202:205], a[244:247], v[44:47]
  s_waitcnt lgkmcnt(4)
  v_mfma_f32_16x16x32_bf16 v[48:51], v[174:177], a[240:243], v[48:51]
  ds_read_b128 v[198:201], v4 offset:22528
  v_mfma_f32_16x16x32_bf16 v[52:55], v[174:177], a[244:247], v[52:55]
  v_mfma_f32_16x16x32_bf16 v[88:91], v[178:181], a[240:243], v[88:91]
  ds_read_b128 v[202:205], v4 offset:23552
  v_mfma_f32_16x16x32_bf16 v[92:95], v[178:181], a[244:247], v[92:95]
  s_waitcnt vmcnt(7) lgkmcnt(4)
  v_mfma_f32_16x16x32_bf16 v[24:27], v[182:185], a[248:251], v[24:27]
  ds_read_b128 v[174:177], v4 offset:24576
  v_mfma_f32_16x16x32_bf16 v[28:31], v[182:185], a[252:255], v[28:31]
  buffer_load_dwordx4 v3, s[4:7], s40 offen offset:2048 sc1 lds
  v_mfma_f32_16x16x32_bf16 v[32:35], v[186:189], a[248:251], v[32:35]
  ds_read_b128 v[178:181], v4 offset:25600
  v_mfma_f32_16x16x32_bf16 v[36:39], v[186:189], a[252:255], v[36:39]
  s_waitcnt lgkmcnt(4)
  v_mfma_f32_16x16x32_bf16 v[40:43], v[190:193], a[248:251], v[40:43]
  ds_read_b128 v[182:185], v4 offset:26624
  v_mfma_f32_16x16x32_bf16 v[44:47], v[190:193], a[252:255], v[44:47]
  buffer_load_dwordx4 v3, s[4:7], s40 offen offset:3072 sc1 lds
  v_mfma_f32_16x16x32_bf16 v[48:51], v[194:197], a[248:251], v[48:51]
  ds_read_b128 v[186:189], v4 offset:27648
  v_mfma_f32_16x16x32_bf16 v[52:55], v[194:197], a[252:255], v[52:55]
  s_waitcnt lgkmcnt(4)
  v_mfma_f32_16x16x32_bf16 v[88:91], v[198:201], a[248:251], v[88:91]
  ds_read_b128 v[190:193], v4 offset:28672
  v_mfma_f32_16x16x32_bf16 v[92:95], v[198:201], a[252:255], v[92:95]
  s_add_u32 m0, s37, 126976
  s_add_u32 s40, s37, 217088
  s_add_u32 s40, s40, s36
  buffer_load_dwordx4 v3, s[4:7], s40 offen offset:0 sc1 lds
  s_waitcnt vmcnt(7)
  v_mfma_f32_16x16x32_bf16 v[24:27], v[202:205], v[134:137], v[24:27]
  ds_read_b128 v[194:197], v4 offset:29696
  v_mfma_f32_16x16x32_bf16 v[28:31], v[202:205], v[138:141], v[28:31]
  s_waitcnt lgkmcnt(4)
  v_mfma_f32_16x16x32_bf16 v[32:35], v[174:177], v[134:137], v[32:35]
  ds_read_b128 v[198:201], v4 offset:30720
  v_mfma_f32_16x16x32_bf16 v[36:39], v[174:177], v[138:141], v[36:39]
  s_mul_i32 s37, s20, 5120
  s_add_u32 m0, s37, 143360
  s_add_u32 s40, s37, 233472
  s_add_u32 s40, s40, s36
  buffer_load_dwordx4 v3, s[4:7], s40 offen offset:0 sc1 lds
  v_mfma_f32_16x16x32_bf16 v[40:43], v[178:181], v[134:137], v[40:43]
  ds_read_b128 v[202:205], v4 offset:31744
  v_mfma_f32_16x16x32_bf16 v[44:47], v[178:181], v[138:141], v[44:47]
  s_waitcnt lgkmcnt(4)
  v_mfma_f32_16x16x32_bf16 v[48:51], v[182:185], v[134:137], v[48:51]
  ds_read_b128 v[174:177], v4 offset:32768
  v_mfma_f32_16x16x32_bf16 v[52:55], v[182:185], v[138:141], v[52:55]
  buffer_load_dwordx4 v3, s[4:7], s40 offen offset:1024 sc1 lds
  v_mfma_f32_16x16x32_bf16 v[88:91], v[186:189], v[134:137], v[88:91]
  ds_read_b128 v[178:181], v4 offset:33792
  v_mfma_f32_16x16x32_bf16 v[92:95], v[186:189], v[138:141], v[92:95]
  s_waitcnt lgkmcnt(4)
  v_mfma_f32_16x16x32_bf16 v[56:59], v[190:193], a[0:3], 0
  ds_read_b128 v[182:185], v4 offset:34816
  v_mfma_f32_16x16x32_bf16 v[60:63], v[190:193], a[4:7], 0
  buffer_load_dwordx4 v3, s[4:7], s40 offen offset:2048 sc1 lds
  v_mfma_f32_16x16x32_bf16 v[64:67], v[194:197], a[0:3], 0
  ds_read_b128 v[186:189], v4 offset:35840
  v_mfma_f32_16x16x32_bf16 v[68:71], v[194:197], a[4:7], 0
  s_waitcnt vmcnt(8)
  s_barrier
  s_waitcnt lgkmcnt(4)
  v_mfma_f32_16x16x32_bf16 v[56:59], v[198:201], a[8:11], v[56:59]
  ds_read_b128 v[190:193], v4 offset:36864
  v_mfma_f32_16x16x32_bf16 v[60:63], v[198:201], a[12:15], v[60:63]
  buffer_load_dwordx4 v3, s[4:7], s40 offen offset:3072 sc1 lds
  v_mfma_f32_16x16x32_bf16 v[64:67], v[202:205], a[8:11], v[64:67]
  ds_read_b128 v[194:197], v4 offset:37888
  v_mfma_f32_16x16x32_bf16 v[68:71], v[202:205], a[12:15], v[68:71]
  s_waitcnt lgkmcnt(4)
  v_mfma_f32_16x16x32_bf16 v[56:59], v[174:177], a[40:43], v[56:59]
  ds_read_b128 v[198:201], v4 offset:38912
  v_mfma_f32_16x16x32_bf16 v[60:63], v[174:177], a[44:47], v[60:63]
  s_add_u32 m0, s37, 147456
  s_add_u32 s40, s37, 237568
  s_add_u32 s40, s40, s36
  buffer_load_dwordx4 v3, s[4:7], s40 offen offset:0 sc1 lds
  v_mfma_f32_16x16x32_bf16 v[64:67], v[178:181], a[40:43], v[64:67]
  ds_read_b128 v[202:205], v4 offset:39936
  v_mfma_f32_16x16x32_bf16 v[68:71], v[178:181], a[44:47], v[68:71]
  s_waitcnt lgkmcnt(4)
  v_mfma_f32_16x16x32_bf16 v[56:59], v[182:185], a[48:51], v[56:59]
  ds_read_b128 v[174:177], v4 offset:40960
  v_mfma_f32_16x16x32_bf16 v[60:63], v[182:185], a[52:55], v[60:63]
  s_mul_i32 s37, s20, 5120
  s_add_u32 m0, s37, 0
  s_add_u32 s40, s37, 253952
  s_add_u32 s40, s40, s36
  buffer_load_dwordx4 v3, s[4:7], s40 offen offset:0 sc1 lds
  v_mfma_f32_16x16x32_bf16 v[64:67], v[186:189], a[48:51], v[64:67]
  ds_read_b128 v[178:181], v4 offset:41984
  v_mfma_f32_16x16x32_bf16 v[68:71], v[186:189], a[52:55], v[68:71]
  s_waitcnt lgkmcnt(4)
  v_mfma_f32_16x16x32_bf16 v[56:59], v[190:193], a[72:75], v[56:59]
  ds_read_b128 v[182:185], v4 offset:43008
  v_mfma_f32_16x16x32_bf16 v[60:63], v[190:193], a[76:79], v[60:63]
  buffer_load_dwordx4 v3, s[4:7], s40 offen offset:1024 sc1 lds
  v_mfma_f32_16x16x32_bf16 v[64:67], v[194:197], a[72:75], v[64:67]
  ds_read_b128 v[186:189], v4 offset:44032
  v_mfma_f32_16x16x32_bf16 v[68:71], v[194:197], a[76:79], v[68:71]
  s_waitcnt lgkmcnt(4)
  v_mfma_f32_16x16x32_bf16 v[56:59], v[198:201], a[80:83], v[56:59]
  ds_read_b128 v[190:193], v4 offset:45056
  v_mfma_f32_16x16x32_bf16 v[60:63], v[198:201], a[84:87], v[60:63]
  buffer_load_dwordx4 v3, s[4:7], s40 offen offset:2048 sc1 lds
  v_mfma_f32_16x16x32_bf16 v[64:67], v[202:205], a[80:83], v[64:67]
  ds_read_b128 v[194:197], v4 offset:46080
  v_mfma_f32_16x16x32_bf16 v[68:71], v[202:205], a[84:87], v[68:71]
  s_waitcnt lgkmcnt(4)
  v_mfma_f32_16x16x32_bf16 v[56:59], v[174:177], a[112:115], v[56:59]
  ds_read_b128 v[198:201], v4 offset:47104
  v_mfma_f32_16x16x32_bf16 v[60:63], v[174:177], a[116:119], v[60:63]
  buffer_load_dwordx4 v3, s[4:7], s40 offen offset:3072 sc1 lds
  v_mfma_f32_16x16x32_bf16 v[64:67], v[178:181], a[112:115], v[64:67]
  ds_read_b128 v[202:205], v4 offset:48128
  v_mfma_f32_16x16x32_bf16 v[68:71], v[178:181], a[116:119], v[68:71]
  s_waitcnt lgkmcnt(4)
  v_mfma_f32_16x16x32_bf16 v[56:59], v[182:185], a[120:123], v[56:59]
  ds_read_b128 v[174:177], v4 offset:49152
  v_mfma_f32_16x16x32_bf16 v[60:63], v[182:185], a[124:127], v[60:63]
  s_add_u32 m0, s37, 4096
  s_add_u32 s40, s37, 258048
  s_add_u32 s40, s40, s36
  buffer_load_dwordx4 v3, s[4:7], s40 offen offset:0 sc1 lds
  v_mfma_f32_16x16x32_bf16 v[64:67], v[186:189], a[120:123], v[64:67]
  ds_read_b128 v[178:181], v4 offset:50176
  v_mfma_f32_16x16x32_bf16 v[68:71], v[186:189], a[124:127], v[68:71]
  s_waitcnt lgkmcnt(4)
  v_mfma_f32_16x16x32_bf16 v[56:59], v[190:193], a[144:147], v[56:59]
  ds_read_b128 v[182:185], v4 offset:51200
  v_mfma_f32_16x16x32_bf16 v[60:63], v[190:193], a[148:151], v[60:63]
  s_mul_i32 s37, s20, 5120
  s_add_u32 m0, s37, 20480
  s_add_u32 s40, s37, 274432
  s_add_u32 s40, s40, s36
  buffer_load_dwordx4 v3, s[4:7], s40 offen offset:0 sc1 lds
  v_mfma_f32_16x16x32_bf16 v[64:67], v[194:197], a[144:147], v[64:67]
  ds_read_b128 v[186:189], v4 offset:52224
  v_mfma_f32_16x16x32_bf16 v[68:71], v[194:197], a[148:151], v[68:71]
  s_waitcnt lgkmcnt(4)
  v_mfma_f32_16x16x32_bf16 v[56:59], v[198:201], a[152:155], v[56:59]
  ds_read_b128 v[190:193], v4 offset:53248
  v_mfma_f32_16x16x32_bf16 v[60:63], v[198:201], a[156:159], v[60:63]
  buffer_load_dwordx4 v3, s[4:7], s40 offen offset:1024 sc1 lds
  v_mfma_f32_16x16x32_bf16 v[64:67], v[202:205], a[152:155], v[64:67]
  ds_read_b128 v[194:197], v4 offset:54272
  v_mfma_f32_16x16x32_bf16 v[68:71], v[202:205], a[156:159], v[68:71]
  s_waitcnt lgkmcnt(4)
  v_mfma_f32_16x16x32_bf16 v[56:59], v[174:177], a[184:187], v[56:59]
  ds_read_b128 v[198:201], v4 offset:55296
  v_mfma_f32_16x16x32_bf16 v[60:63], v[174:177], a[188:191], v[60:63]
  buffer_load_dwordx4 v3, s[4:7], s40 offen offset:2048 sc1 lds
  v_mfma_f32_16x16x32_bf16 v[64:67], v[178:181], a[184:187], v[64:67]
  ds_read_b128 v[202:205], v4 offset:56320
  v_mfma_f32_16x16x32_bf16 v[68:71], v[178:181], a[188:191], v[68:71]
  s_waitcnt vmcnt(13)
  s_barrier
  s_waitcnt lgkmcnt(4)
  v_mfma_f32_16x16x32_bf16 v[56:59], v[182:185], a[192:195], v[56:59]
  ds_read_b128 v[174:177], v4 offset:57344
  v_mfma_f32_16x16x32_bf16 v[60:63], v[182:185], a[196:199], v[60:63]
  buffer_load_dwordx4 v3, s[4:7], s40 offen offset:3072 sc1 lds
  v_mfma_f32_16x16x32_bf16 v[64:67], v[186:189], a[192:195], v[64:67]
  ds_read_b128 v[178:181], v4 offset:58368
  v_mfma_f32_16x16x32_bf16 v[68:71], v[186:189], a[196:199], v[68:71]
  s_waitcnt lgkmcnt(4)
  v_mfma_f32_16x16x32_bf16 v[56:59], v[190:193], a[216:219], v[56:59]
  ds_read_b128 v[182:185], v4 offset:59392
  v_mfma_f32_16x16x32_bf16 v[60:63], v[190:193], a[220:223], v[60:63]
  s_add_u32 m0, s37, 24576
  s_add_u32 s40, s37, 278528
  s_add_u32 s40, s40, s36
  buffer_load_dwordx4 v3, s[4:7], s40 offen offset:0 sc1 lds
  v_mfma_f32_16x16x32_bf16 v[64:67], v[194:197], a[216:219], v[64:67]
  ds_read_b128 v[186:189], v4 offset:60416
  v_mfma_f32_16x16x32_bf16 v[68:71], v[194:197], a[220:223], v[68:71]
  s_waitcnt lgkmcnt(4)
  v_mfma_f32_16x16x32_bf16 v[56:59], v[198:201], a[224:227], v[56:59]
  ds_read_b128 v[190:193], v4 offset:61440
  v_mfma_f32_16x16x32_bf16 v[60:63], v[198:201], a[228:231], v[60:63]
  s_mul_i32 s37, s20, 5120
  s_add_u32 m0, s37, 40960
  s_add_u32 s40, s37, 294912
  s_add_u32 s40, s40, s36
  buffer_load_dwordx4 v3, s[4:7], s40 offen offset:0 sc1 lds
  v_mfma_f32_16x16x32_bf16 v[64:67], v[202:205], a[224:227], v[64:67]
  ds_read_b128 v[194:197], v4 offset:62464
  v_mfma_f32_16x16x32_bf16 v[68:71], v[202:205], a[228:231], v[68:71]
  s_waitcnt lgkmcnt(4)
  v_mfma_f32_16x16x32_bf16 v[56:59], v[174:177], v[110:113], v[56:59]
  ds_read_b128 v[198:201], v4 offset:63488
  v_mfma_f32_16x16x32_bf16 v[60:63], v[174:177], v[114:117], v[60:63]
  buffer_load_dwordx4 v3, s[4:7], s40 offen offset:1024 sc1 lds
  v_mfma_f32_16x16x32_bf16 v[64:67], v[178:181], v[110:113], v[64:67]
  ds_read_b128 v[202:205], v4 offset:64512
  v_mfma_f32_16x16x32_bf16 v[68:71], v[178:181], v[114:117], v[68:71]
  s_waitcnt lgkmcnt(4)
  v_mfma_f32_16x16x32_bf16 v[56:59], v[182:185], v[118:121], v[56:59]
  ds_read_b128 v[174:177], v5 offset:0
  v_mfma_f32_16x16x32_bf16 v[60:63], v[182:185], v[122:125], v[60:63]
  buffer_load_dwordx4 v3, s[4:7], s40 offen offset:2048 sc1 lds
  v_mfma_f32_16x16x32_bf16 v[64:67], v[186:189], v[118:121], v[64:67]
  ds_read_b128 v[178:181], v5 offset:1024
  v_mfma_f32_16x16x32_bf16 v[68:71], v[186:189], v[122:125], v[68:71]
  s_waitcnt lgkmcnt(4)
  v_mfma_f32_16x16x32_bf16 v[56:59], v[190:193], a[16:19], v[56:59]
  ds_read_b128 v[182:185], v5 offset:2048
  v_mfma_f32_16x16x32_bf16 v[60:63], v[190:193], a[20:23], v[60:63]
  buffer_load_dwordx4 v3, s[4:7], s40 offen offset:3072 sc1 lds
  v_mfma_f32_16x16x32_bf16 v[64:67], v[194:197], a[16:19], v[64:67]
  ds_read_b128 v[186:189], v5 offset:3072
  v_mfma_f32_16x16x32_bf16 v[68:71], v[194:197], a[20:23], v[68:71]
  s_waitcnt lgkmcnt(4)
  v_mfma_f32_16x16x32_bf16 v[56:59], v[198:201], a[56:59], v[56:59]
  ds_read_b128 v[190:193], v5 offset:4096
  v_mfma_f32_16x16x32_bf16 v[60:63], v[198:201], a[60:63], v[60:63]
  s_add_u32 m0, s37, 45056
  s_add_u32 s40, s37, 299008
  s_add_u32 s40, s40, s36
  buffer_load_dwordx4 v3, s[4:7], s40 offen offset:0 sc1 lds
  v_mfma_f32_16x16x32_bf16 v[64:67], v[202:205], a[56:59], v[64:67]
  ds_read_b128 v[194:197], v5 offset:5120
  v_mfma_f32_16x16x32_bf16 v[68:71], v[202:205], a[60:63], v[68:71]
  s_waitcnt lgkmcnt(4)
  v_mfma_f32_16x16x32_bf16 v[56:59], v[174:177], a[88:91], v[56:59]
  ds_read_b128 v[198:201], v5 offset:6144
  v_mfma_f32_16x16x32_bf16 v[60:63], v[174:177], a[92:95], v[60:63]
  s_mul_i32 s37, s20, 4096
  s_add_u32 m0, s37, 61440
  s_add_u32 s40, s37, 315392
  s_add_u32 s40, s40, s36
  buffer_load_dwordx4 v3, s[4:7], s40 offen offset:0 sc1 lds
  v_mfma_f32_16x16x32_bf16 v[64:67], v[178:181], a[88:91], v[64:67]
  ds_read_b128 v[202:205], v5 offset:7168
  v_mfma_f32_16x16x32_bf16 v[68:71], v[178:181], a[92:95], v[68:71]
  s_waitcnt lgkmcnt(4)
  v_mfma_f32_16x16x32_bf16 v[56:59], v[182:185], a[128:131], v[56:59]
  ds_read_b128 v[174:177], v5 offset:8192
  v_mfma_f32_16x16x32_bf16 v[60:63], v[182:185], a[132:135], v[60:63]
  buffer_load_dwordx4 v3, s[4:7], s40 offen offset:1024 sc1 lds
  v_mfma_f32_16x16x32_bf16 v[64:67], v[186:189], a[128:131], v[64:67]
  ds_read_b128 v[178:181], v5 offset:9216
  v_mfma_f32_16x16x32_bf16 v[68:71], v[186:189], a[132:135], v[68:71]
  s_waitcnt lgkmcnt(4)
  v_mfma_f32_16x16x32_bf16 v[56:59], v[190:193], a[160:163], v[56:59]
  ds_read_b128 v[182:185], v5 offset:10240
  v_mfma_f32_16x16x32_bf16 v[60:63], v[190:193], a[164:167], v[60:63]
  buffer_load_dwordx4 v3, s[4:7], s40 offen offset:2048 sc1 lds
  v_mfma_f32_16x16x32_bf16 v[64:67], v[194:197], a[160:163], v[64:67]
  ds_read_b128 v[186:189], v5 offset:11264
  v_mfma_f32_16x16x32_bf16 v[68:71], v[194:197], a[164:167], v[68:71]
  s_waitcnt vmcnt(18)
  s_barrier
  s_waitcnt lgkmcnt(4)
  v_mfma_f32_16x16x32_bf16 v[56:59], v[198:201], a[200:203], v[56:59]
  ds_read_b128 v[190:193], v5 offset:12288
  v_mfma_f32_16x16x32_bf16 v[60:63], v[198:201], a[204:207], v[60:63]
  buffer_load_dwordx4 v[158:161], v6, s[8:11], s32 offen offset:0 sc1
  v_mfma_f32_16x16x32_bf16 v[64:67], v[202:205], a[200:203], v[64:67]
  ds_read_b128 v[194:197], v5 offset:13312
  v_mfma_f32_16x16x32_bf16 v[68:71], v[202:205], a[204:207], v[68:71]
  s_waitcnt lgkmcnt(4)
  v_mfma_f32_16x16x32_bf16 v[56:59], v[174:177], a[232:235], v[56:59]
  ds_read_b128 v[198:201], v5 offset:14336
  v_mfma_f32_16x16x32_bf16 v[60:63], v[174:177], a[236:239], v[60:63]
  buffer_load_dwordx4 v[162:165], v6, s[8:11], s32 offen offset:256 sc1
  v_mfma_f32_16x16x32_bf16 v[64:67], v[178:181], a[232:235], v[64:67]
  ds_read_b128 v[202:205], v5 offset:15360
  v_mfma_f32_16x16x32_bf16 v[68:71], v[178:181], a[236:239], v[68:71]
  s_waitcnt lgkmcnt(4)
  v_mfma_f32_16x16x32_bf16 v[56:59], v[182:185], v[126:129], v[56:59]
  ds_read_b128 v[174:177], v5 offset:16384
  v_mfma_f32_16x16x32_bf16 v[60:63], v[182:185], v[130:133], v[60:63]
  buffer_load_dwordx2 v[166:167], v7, s[8:11], s25 offen offset:0 sc1
  v_mfma_f32_16x16x32_bf16 v[64:67], v[186:189], v[126:129], v[64:67]
  ds_read_b128 v[178:181], v5 offset:17408
  v_mfma_f32_16x16x32_bf16 v[68:71], v[186:189], v[130:133], v[68:71]
  s_waitcnt lgkmcnt(4)
  v_mfma_f32_16x16x32_bf16 v[56:59], v[190:193], a[24:27], v[56:59]
  ds_read_b128 v[182:185], v5 offset:18432
  v_mfma_f32_16x16x32_bf16 v[60:63], v[190:193], a[28:31], v[60:63]
  buffer_load_dwordx2 v[168:169], v7, s[8:11], s25 offen offset:256 sc1
  v_mfma_f32_16x16x32_bf16 v[64:67], v[194:197], a[24:27], v[64:67]
  ds_read_b128 v[186:189], v5 offset:19456
  v_mfma_f32_16x16x32_bf16 v[68:71], v[194:197], a[28:31], v[68:71]
  s_waitcnt lgkmcnt(4)
  v_mfma_f32_16x16x32_bf16 v[56:59], v[198:201], a[32:35], v[56:59]
  ds_read_b128 v[190:193], v5 offset:20480
  v_mfma_f32_16x16x32_bf16 v[60:63], v[198:201], a[36:39], v[60:63]
  buffer_load_dwordx4 v3, s[4:7], s40 offen offset:3072 sc1 lds
  v_mfma_f32_16x16x32_bf16 v[64:67], v[202:205], a[32:35], v[64:67]
  ds_read_b128 v[194:197], v5 offset:21504
  s_nop 3
  v_mfma_f32_16x16x32_bf16 v[68:71], v[202:205], a[36:39], v[68:71]
  s_add_u32 s35, s18, 1
  s_and_b32 s35, s35, 3
  s_waitcnt lgkmcnt(4)
  v_mfma_f32_16x16x32_bf16 v[56:59], v[174:177], a[64:67], v[56:59]
  ds_read_b128 v[198:201], v5 offset:22528
  s_mul_i32 s35, s35, 6144
  v_mfma_f32_16x16x32_bf16 v[60:63], v[174:177], a[68:71], v[60:63]
  s_add_u32 s35, s35, s34
  v_cvt_pk_bf16_f32 v142, v24, v25
  v_mfma_f32_16x16x32_bf16 v[64:67], v[178:181], a[64:67], v[64:67]
  ds_read_b128 v[202:205], v5 offset:23552
  v_cvt_pk_bf16_f32 v143, v26, v27
  v_mfma_f32_16x16x32_bf16 v[68:71], v[178:181], a[68:71], v[68:71]
  v_cvt_pk_bf16_f32 v144, v32, v33
  v_cvt_pk_bf16_f32 v145, v34, v35
  s_waitcnt lgkmcnt(4)
  v_mfma_f32_16x16x32_bf16 v[56:59], v[182:185], a[96:99], v[56:59]
  ds_read_b128 v[174:177], v5 offset:24576
  buffer_store_dwordx4 v[142:145], v3, s[8:11], s35 offen offset:0 sc1
  v_mfma_f32_16x16x32_bf16 v[60:63], v[182:185], a[100:103], v[60:63]
  v_cvt_pk_bf16_f32 v146, v28, v29
  v_cvt_pk_bf16_f32 v147, v30, v31
  v_mfma_f32_16x16x32_bf16 v[64:67], v[186:189], a[96:99], v[64:67]
  ds_read_b128 v[178:181], v5 offset:25600
  v_cvt_pk_bf16_f32 v148, v36, v37
  v_mfma_f32_16x16x32_bf16 v[68:71], v[186:189], a[100:103], v[68:71]
  v_cvt_pk_bf16_f32 v149, v38, v39
  buffer_store_dwordx4 v[146:149], v3, s[8:11], s35 offen offset:1024 sc1
  s_waitcnt lgkmcnt(4)
  v_mfma_f32_16x16x32_bf16 v[56:59], v[190:193], a[104:107], v[56:59]
  ds_read_b128 v[182:185], v5 offset:26624
  s_add_u32 s35, s18, 2
  v_mfma_f32_16x16x32_bf16 v[60:63], v[190:193], a[108:111], v[60:63]
  s_and_b32 s35, s35, 3
  s_mul_i32 s35, s35, 6144
  v_mfma_f32_16x16x32_bf16 v[64:67], v[194:197], a[104:107], v[64:67]
  ds_read_b128 v[186:189], v5 offset:27648
  s_add_u32 s35, s35, s34
  v_mfma_f32_16x16x32_bf16 v[68:71], v[194:197], a[108:111], v[68:71]
  v_cvt_pk_bf16_f32 v150, v40, v41
  v_cvt_pk_bf16_f32 v151, v42, v43
  s_waitcnt lgkmcnt(4)
  v_mfma_f32_16x16x32_bf16 v[56:59], v[198:201], a[136:139], v[56:59]
  ds_read_b128 v[190:193], v5 offset:28672
  v_cvt_pk_bf16_f32 v152, v48, v49
  v_mfma_f32_16x16x32_bf16 v[60:63], v[198:201], a[140:143], v[60:63]
  v_cvt_pk_bf16_f32 v153, v50, v51
  buffer_store_dwordx4 v[150:153], v3, s[8:11], s35 offen offset:2048 sc1
  v_mfma_f32_16x16x32_bf16 v[64:67], v[202:205], a[136:139], v[64:67]
  ds_read_b128 v[194:197], v5 offset:29696
  v_cvt_pk_bf16_f32 v154, v44, v45
  v_mfma_f32_16x16x32_bf16 v[68:71], v[202:205], a[140:143], v[68:71]
  v_cvt_pk_bf16_f32 v155, v46, v47
  v_cvt_pk_bf16_f32 v156, v52, v53
  s_waitcnt lgkmcnt(4)
  v_mfma_f32_16x16x32_bf16 v[56:59], v[174:177], a[168:171], v[56:59]
  ds_read_b128 v[198:201], v5 offset:30720
  v_cvt_pk_bf16_f32 v157, v54, v55
  v_mfma_f32_16x16x32_bf16 v[60:63], v[174:177], a[172:175], v[60:63]
  buffer_store_dwordx4 v[154:157], v3, s[8:11], s35 offen offset:3072 sc1
  s_sub_u32 s35, s20, s18
  v_mfma_f32_16x16x32_bf16 v[64:67], v[178:181], a[168:171], v[64:67]
  ds_read_b128 v[202:205], v5 offset:31744
  s_add_u32 s35, s35, 3
  v_mfma_f32_16x16x32_bf16 v[68:71], v[178:181], a[172:175], v[68:71]
  s_and_b32 s35, s35, 3
  s_lshl_b32 s35, s35, 10
  s_waitcnt vmcnt(22)
  s_barrier
  s_waitcnt lgkmcnt(4)
  v_mfma_f32_16x16x32_bf16 v[56:59], v[182:185], a[176:179], v[56:59]
  ds_read_b128 v[174:177], v3 offset:0
  s_add_u32 s35, s35, s34
  v_mfma_f32_16x16x32_bf16 v[60:63], v[182:185], a[180:183], v[60:63]
  s_add_u32 s35, s35, 24576
  v_cvt_pk_bf16_f32 v142, v88, v89
  v_mfma_f32_16x16x32_bf16 v[64:67], v[186:189], a[176:179], v[64:67]
  ds_read_b128 v[178:181], v3 offset:1024
  v_cvt_pk_bf16_f32 v143, v90, v91
  v_mfma_f32_16x16x32_bf16 v[68:71], v[186:189], a[180:183], v[68:71]
  v_cvt_pk_bf16_f32 v144, v92, v93
  v_cvt_pk_bf16_f32 v145, v94, v95
  s_waitcnt lgkmcnt(4)
  v_mfma_f32_16x16x32_bf16 v[56:59], v[190:193], a[208:211], v[56:59]
  ds_read_b128 v[182:185], v3 offset:2048
  buffer_store_dwordx4 v[142:145], v3, s[8:11], s35 offen sc1
  v_mfma_f32_16x16x32_bf16 v[60:63], v[190:193], a[212:215], v[60:63]
  s_mul_i32 s41, s18, 6144
  s_add_u32 s41, s41, s34
  v_mfma_f32_16x16x32_bf16 v[64:67], v[194:197], a[208:211], v[64:67]
  ds_read_b128 v[186:189], v3 offset:3072
  s_add_u32 s42, s41, 4096
  v_mfma_f32_16x16x32_bf16 v[68:71], v[194:197], a[212:215], v[68:71]
  s_add_u32 s43, s34, 24576
  s_cmp_eq_u32 s18, s20
  s_waitcnt lgkmcnt(4)
  v_mfma_f32_16x16x32_bf16 v[56:59], v[198:201], a[240:243], v[56:59]
  ds_read_b128 v[190:193], v3 offset:4096
  s_cselect_b32 s43, s43, 268435456
  v_mfma_f32_16x16x32_bf16 v[60:63], v[198:201], a[244:247], v[60:63]
  v_mfma_f32_16x16x32_bf16 v[64:67], v[202:205], a[240:243], v[64:67]
  ds_read_b128 v[194:197], v3 offset:5120
  v_mfma_f32_16x16x32_bf16 v[68:71], v[202:205], a[244:247], v[68:71]
  s_waitcnt lgkmcnt(4)
  v_mfma_f32_16x16x32_bf16 v[56:59], v[174:177], a[248:251], v[56:59]
  ds_read_b128 v[198:201], v3 offset:6144
  v_mfma_f32_16x16x32_bf16 v[60:63], v[174:177], a[252:255], v[60:63]
  v_mfma_f32_16x16x32_bf16 v[64:67], v[178:181], a[248:251], v[64:67]
  ds_read_b128 v[202:205], v3 offset:7168
  v_mfma_f32_16x16x32_bf16 v[68:71], v[178:181], a[252:255], v[68:71]
  s_waitcnt lgkmcnt(4)
  v_mfma_f32_16x16x32_bf16 v[56:59], v[182:185], v[134:137], v[56:59]
  ds_read_b128 v[174:177], v3 offset:8192
  v_mfma_f32_16x16x32_bf16 v[60:63], v[182:185], v[138:141], v[60:63]
  v_mfma_f32_16x16x32_bf16 v[64:67], v[186:189], v[134:137], v[64:67]
  ds_read_b128 v[178:181], v3 offset:9216
  v_mfma_f32_16x16x32_bf16 v[68:71], v[186:189], v[138:141], v[68:71]
  s_waitcnt lgkmcnt(4)
  v_mfma_f32_16x16x32_bf16 v[72:75], v[190:193], a[0:3], 0
  ds_read_b128 v[182:185], v3 offset:10240
  v_mfma_f32_16x16x32_bf16 v[76:79], v[190:193], a[4:7], 0
  v_mfma_f32_16x16x32_bf16 v[80:83], v[194:197], a[0:3], 0
  ds_read_b128 v[186:189], v3 offset:11264
  v_mfma_f32_16x16x32_bf16 v[84:87], v[194:197], a[4:7], 0
  s_waitcnt lgkmcnt(4)
  v_mfma_f32_16x16x32_bf16 v[72:75], v[198:201], a[8:11], v[72:75]
  ds_read_b128 v[190:193], v3 offset:12288
  s_add_u32 s35, s18, 3
  v_mfma_f32_16x16x32_bf16 v[76:79], v[198:201], a[12:15], v[76:79]
  s_and_b32 s35, s35, 3
  s_mul_i32 s35, s35, 6144
  v_mfma_f32_16x16x32_bf16 v[80:83], v[202:205], a[8:11], v[80:83]
  ds_read_b128 v[194:197], v3 offset:13312
  s_add_u32 s35, s35, s34
  v_mfma_f32_16x16x32_bf16 v[84:87], v[202:205], a[12:15], v[84:87]
  s_add_u32 s35, s35, 4096
  v_cvt_pk_bf16_f32 v142, v56, v57
  s_waitcnt lgkmcnt(4)
  v_mfma_f32_16x16x32_bf16 v[72:75], v[174:177], a[16:19], v[72:75]
  ds_read_b128 v[198:201], v3 offset:14336
  v_cvt_pk_bf16_f32 v143, v58, v59
  v_mfma_f32_16x16x32_bf16 v[76:79], v[174:177], a[20:23], v[76:79]
  v_cvt_pk_bf16_f32 v144, v64, v65
  v_cvt_pk_bf16_f32 v145, v66, v67
  v_mfma_f32_16x16x32_bf16 v[80:83], v[178:181], a[16:19], v[80:83]
  ds_read_b128 v[202:205], v3 offset:15360
  buffer_store_dwordx4 v[142:145], v3, s[8:11], s35 offen offset:0 sc1
  v_mfma_f32_16x16x32_bf16 v[84:87], v[178:181], a[20:23], v[84:87]
  v_cvt_pk_bf16_f32 v146, v60, v61
  v_cvt_pk_bf16_f32 v147, v62, v63
  s_waitcnt lgkmcnt(4)
  v_mfma_f32_16x16x32_bf16 v[72:75], v[182:185], a[24:27], v[72:75]
  ds_read_b128 v[174:177], v3 offset:16384
  v_cvt_pk_bf16_f32 v148, v68, v69
  v_mfma_f32_16x16x32_bf16 v[76:79], v[182:185], a[28:31], v[76:79]
  v_cvt_pk_bf16_f32 v149, v70, v71
  buffer_store_dwordx4 v[146:149], v3, s[8:11], s35 offen offset:1024 sc1
  v_mfma_f32_16x16x32_bf16 v[80:83], v[186:189], a[24:27], v[80:83]
  ds_read_b128 v[178:181], v3 offset:17408
  v_mfma_f32_16x16x32_bf16 v[84:87], v[186:189], a[28:31], v[84:87]
  s_waitcnt lgkmcnt(4)
  v_mfma_f32_16x16x32_bf16 v[72:75], v[190:193], a[32:35], v[72:75]
  ds_read_b128 v[182:185], v3 offset:18432
  v_mfma_f32_16x16x32_bf16 v[76:79], v[190:193], a[36:39], v[76:79]
  v_mfma_f32_16x16x32_bf16 v[80:83], v[194:197], a[32:35], v[80:83]
  ds_read_b128 v[186:189], v3 offset:19456
  v_mfma_f32_16x16x32_bf16 v[84:87], v[194:197], a[36:39], v[84:87]
  s_waitcnt vmcnt(20)
  s_barrier
  s_waitcnt lgkmcnt(4)
  v_mfma_f32_16x16x32_bf16 v[72:75], v[198:201], a[40:43], v[72:75]
  ds_read_b128 v[190:193], v3 offset:20480
  v_mfma_f32_16x16x32_bf16 v[76:79], v[198:201], a[44:47], v[76:79]
  v_mfma_f32_16x16x32_bf16 v[80:83], v[202:205], a[40:43], v[80:83]
  ds_read_b128 v[194:197], v3 offset:21504
  v_mfma_f32_16x16x32_bf16 v[84:87], v[202:205], a[44:47], v[84:87]
  s_waitcnt lgkmcnt(4)
  v_mfma_f32_16x16x32_bf16 v[72:75], v[174:177], a[48:51], v[72:75]
  ds_read_b128 v[198:201], v3 offset:22528
  v_mfma_f32_16x16x32_bf16 v[76:79], v[174:177], a[52:55], v[76:79]
  v_mfma_f32_16x16x32_bf16 v[80:83], v[178:181], a[48:51], v[80:83]
  ds_read_b128 v[202:205], v3 offset:23552
  v_mfma_f32_16x16x32_bf16 v[84:87], v[178:181], a[52:55], v[84:87]
  s_waitcnt lgkmcnt(4)
  v_mfma_f32_16x16x32_bf16 v[72:75], v[182:185], a[56:59], v[72:75]
  ds_read_b128 v[174:177], v3 offset:24576
  v_mfma_f32_16x16x32_bf16 v[76:79], v[182:185], a[60:63], v[76:79]
  v_mfma_f32_16x16x32_bf16 v[80:83], v[186:189], a[56:59], v[80:83]
  ds_read_b128 v[178:181], v3 offset:25600
  v_mfma_f32_16x16x32_bf16 v[84:87], v[186:189], a[60:63], v[84:87]
  s_waitcnt lgkmcnt(4)
  v_mfma_f32_16x16x32_bf16 v[72:75], v[190:193], a[64:67], v[72:75]
  ds_read_b128 v[182:185], v3 offset:26624
  v_mfma_f32_16x16x32_bf16 v[76:79], v[190:193], a[68:71], v[76:79]
  v_mfma_f32_16x16x32_bf16 v[80:83], v[194:197], a[64:67], v[80:83]
  ds_read_b128 v[186:189], v3 offset:27648
  v_mfma_f32_16x16x32_bf16 v[84:87], v[194:197], a[68:71], v[84:87]
  s_waitcnt lgkmcnt(4)
  v_mfma_f32_16x16x32_bf16 v[72:75], v[198:201], a[72:75], v[72:75]
  ds_read_b128 v[190:193], v3 offset:28672
  v_mfma_f32_16x16x32_bf16 v[76:79], v[198:201], a[76:79], v[76:79]
  v_mfma_f32_16x16x32_bf16 v[80:83], v[202:205], a[72:75], v[80:83]
  ds_read_b128 v[194:197], v3 offset:29696
  v_mfma_f32_16x16x32_bf16 v[84:87], v[202:205], a[76:79], v[84:87]
  s_waitcnt lgkmcnt(4)
  v_mfma_f32_16x16x32_bf16 v[72:75], v[174:177], a[80:83], v[72:75]
  ds_read_b128 v[198:201], v3 offset:30720
  v_mfma_f32_16x16x32_bf16 v[76:79], v[174:177], a[84:87], v[76:79]
  v_mfma_f32_16x16x32_bf16 v[80:83], v[178:181], a[80:83], v[80:83]
  ds_read_b128 v[202:205], v3 offset:31744
  v_mfma_f32_16x16x32_bf16 v[84:87], v[178:181], a[84:87], v[84:87]
  s_waitcnt lgkmcnt(4)
  v_mfma_f32_16x16x32_bf16 v[72:75], v[182:185], a[88:91], v[72:75]
  ds_read_b128 v[174:177], v3 offset:32768
  v_mfma_f32_16x16x32_bf16 v[76:79], v[182:185], a[92:95], v[76:79]
  v_mfma_f32_16x16x32_bf16 v[80:83], v[186:189], a[88:91], v[80:83]
  ds_read_b128 v[178:181], v3 offset:33792
  v_mfma_f32_16x16x32_bf16 v[84:87], v[186:189], a[92:95], v[84:87]
  s_waitcnt lgkmcnt(4)
  v_mfma_f32_16x16x32_bf16 v[72:75], v[190:193], a[96:99], v[72:75]
  ds_read_b128 v[182:185], v3 offset:34816
  v_mfma_f32_16x16x32_bf16 v[76:79], v[190:193], a[100:103], v[76:79]
  v_mfma_f32_16x16x32_bf16 v[80:83], v[194:197], a[96:99], v[80:83]
  ds_read_b128 v[186:189], v3 offset:35840
  v_mfma_f32_16x16x32_bf16 v[84:87], v[194:197], a[100:103], v[84:87]
  s_waitcnt lgkmcnt(4)
  v_mfma_f32_16x16x32_bf16 v[72:75], v[198:201], a[104:107], v[72:75]
  ds_read_b128 v[190:193], v3 offset:36864
  v_mfma_f32_16x16x32_bf16 v[76:79], v[198:201], a[108:111], v[76:79]
  v_mfma_f32_16x16x32_bf16 v[80:83], v[202:205], a[104:107], v[80:83]
  ds_read_b128 v[194:197], v3 offset:37888
  v_mfma_f32_16x16x32_bf16 v[84:87], v[202:205], a[108:111], v[84:87]
  s_waitcnt lgkmcnt(4)
  v_mfma_f32_16x16x32_bf16 v[72:75], v[174:177], a[112:115], v[72:75]
  ds_read_b128 v[198:201], v3 offset:38912
  v_mfma_f32_16x16x32_bf16 v[76:79], v[174:177], a[116:119], v[76:79]
  v_mfma_f32_16x16x32_bf16 v[80:83], v[178:181], a[112:115], v[80:83]
  ds_read_b128 v[202:205], v3 offset:39936
  v_mfma_f32_16x16x32_bf16 v[84:87], v[178:181], a[116:119], v[84:87]
  s_waitcnt vmcnt(15)
  s_barrier
  s_waitcnt lgkmcnt(4)
  v_mfma_f32_16x16x32_bf16 v[72:75], v[182:185], a[120:123], v[72:75]
  ds_read_b128 v[174:177], v3 offset:40960
  v_mfma_f32_16x16x32_bf16 v[76:79], v[182:185], a[124:127], v[76:79]
  buffer_load_dwordx4 v[206:209], v3, s[8:11], s41 offen offset:0 sc1
  v_mfma_f32_16x16x32_bf16 v[80:83], v[186:189], a[120:123], v[80:83]
  ds_read_b128 v[178:181], v3 offset:41984
  v_mfma_f32_16x16x32_bf16 v[84:87], v[186:189], a[124:127], v[84:87]
  buffer_load_dwordx4 v[210:213], v3, s[8:11], s41 offen offset:1024 sc1
  s_waitcnt lgkmcnt(4)
  v_mfma_f32_16x16x32_bf16 v[72:75], v[190:193], a[128:131], v[72:75]
  ds_read_b128 v[182:185], v3 offset:43008
  v_mfma_f32_16x16x32_bf16 v[76:79], v[190:193], a[132:135], v[76:79]
  buffer_load_dwordx4 v[214:217], v3, s[8:11], s41 offen offset:2048 sc1
  v_mfma_f32_16x16x32_bf16 v[80:83], v[194:197], a[128:131], v[80:83]
  ds_read_b128 v[186:189], v3 offset:44032
  v_mfma_f32_16x16x32_bf16 v[84:87], v[194:197], a[132:135], v[84:87]
  buffer_load_dwordx4 v[218:221], v3, s[8:11], s41 offen offset:3072 sc1
  s_waitcnt lgkmcnt(4)
  v_mfma_f32_16x16x32_bf16 v[72:75], v[198:201], a[136:139], v[72:75]
  ds_read_b128 v[190:193], v3 offset:45056
  v_mfma_f32_16x16x32_bf16 v[76:79], v[198:201], a[140:143], v[76:79]
  buffer_load_dwordx4 v[222:225], v3, s[8:11], s42 offen offset:0 sc1
  v_mfma_f32_16x16x32_bf16 v[80:83], v[202:205], a[136:139], v[80:83]
  ds_read_b128 v[194:197], v3 offset:46080
  v_mfma_f32_16x16x32_bf16 v[84:87], v[202:205], a[140:143], v[84:87]
  buffer_load_dwordx4 v[226:229], v3, s[8:11], s42 offen offset:1024 sc1
  s_waitcnt lgkmcnt(4)
  v_mfma_f32_16x16x32_bf16 v[72:75], v[174:177], a[144:147], v[72:75]
  ds_read_b128 v[198:201], v3 offset:47104
  v_mfma_f32_16x16x32_bf16 v[76:79], v[174:177], a[148:151], v[76:79]
  buffer_load_dwordx4 v[230:233], v3, s[8:11], s43 offen offset:0 sc1
  v_mfma_f32_16x16x32_bf16 v[80:83], v[178:181], a[144:147], v[80:83]
  ds_read_b128 v[202:205], v3 offset:48128
  v_mfma_f32_16x16x32_bf16 v[84:87], v[178:181], a[148:151], v[84:87]
  buffer_load_dwordx4 v[234:237], v3, s[8:11], s43 offen offset:1024 sc1
  s_waitcnt lgkmcnt(4)
  v_mfma_f32_16x16x32_bf16 v[72:75], v[182:185], a[152:155], v[72:75]
  ds_read_b128 v[174:177], v3 offset:49152
  v_mfma_f32_16x16x32_bf16 v[76:79], v[182:185], a[156:159], v[76:79]
  buffer_load_dwordx4 v[238:241], v3, s[8:11], s43 offen offset:2048 sc1
  v_mfma_f32_16x16x32_bf16 v[80:83], v[186:189], a[152:155], v[80:83]
  ds_read_b128 v[178:181], v3 offset:50176
  v_mfma_f32_16x16x32_bf16 v[84:87], v[186:189], a[156:159], v[84:87]
  s_waitcnt lgkmcnt(4)
  v_mfma_f32_16x16x32_bf16 v[72:75], v[190:193], a[160:163], v[72:75]
  ds_read_b128 v[182:185], v3 offset:51200
  v_mfma_f32_16x16x32_bf16 v[76:79], v[190:193], a[164:167], v[76:79]
  v_mfma_f32_16x16x32_bf16 v[80:83], v[194:197], a[160:163], v[80:83]
  ds_read_b128 v[186:189], v3 offset:52224
  v_mfma_f32_16x16x32_bf16 v[84:87], v[194:197], a[164:167], v[84:87]
  s_waitcnt lgkmcnt(4)
  v_mfma_f32_16x16x32_bf16 v[72:75], v[198:201], a[168:171], v[72:75]
  ds_read_b128 v[190:193], v3 offset:53248
  v_mfma_f32_16x16x32_bf16 v[76:79], v[198:201], a[172:175], v[76:79]
  v_mfma_f32_16x16x32_bf16 v[80:83], v[202:205], a[168:171], v[80:83]
  ds_read_b128 v[194:197], v3 offset:54272
  v_mfma_f32_16x16x32_bf16 v[84:87], v[202:205], a[172:175], v[84:87]
  s_waitcnt lgkmcnt(4)
  v_mfma_f32_16x16x32_bf16 v[72:75], v[174:177], a[176:179], v[72:75]
  ds_read_b128 v[198:201], v3 offset:55296
  v_mfma_f32_16x16x32_bf16 v[76:79], v[174:177], a[180:183], v[76:79]
  v_mfma_f32_16x16x32_bf16 v[80:83], v[178:181], a[176:179], v[80:83]
  ds_read_b128 v[202:205], v3 offset:56320
  v_mfma_f32_16x16x32_bf16 v[84:87], v[178:181], a[180:183], v[84:87]
  s_waitcnt lgkmcnt(4)
  v_mfma_f32_16x16x32_bf16 v[72:75], v[182:185], a[184:187], v[72:75]
  ds_read_b128 v[174:177], v3 offset:57344
  v_mfma_f32_16x16x32_bf16 v[76:79], v[182:185], a[188:191], v[76:79]
  v_mfma_f32_16x16x32_bf16 v[80:83], v[186:189], a[184:187], v[80:83]
  ds_read_b128 v[178:181], v3 offset:58368
  v_mfma_f32_16x16x32_bf16 v[84:87], v[186:189], a[188:191], v[84:87]
  s_waitcnt lgkmcnt(4)
  v_mfma_f32_16x16x32_bf16 v[72:75], v[190:193], a[192:195], v[72:75]
  ds_read_b128 v[182:185], v3 offset:59392
  v_mfma_f32_16x16x32_bf16 v[76:79], v[190:193], a[196:199], v[76:79]
  v_mfma_f32_16x16x32_bf16 v[80:83], v[194:197], a[192:195], v[80:83]
  ds_read_b128 v[186:189], v3 offset:60416
  v_mfma_f32_16x16x32_bf16 v[84:87], v[194:197], a[196:199], v[84:87]
  s_waitcnt vmcnt(16)
  s_barrier
  s_waitcnt lgkmcnt(4)
  v_mfma_f32_16x16x32_bf16 v[72:75], v[198:201], a[200:203], v[72:75]
  ds_read_b128 v[190:193], v3 offset:61440
  v_mfma_f32_16x16x32_bf16 v[76:79], v[198:201], a[204:207], v[76:79]
  v_mfma_f32_16x16x32_bf16 v[80:83], v[202:205], a[200:203], v[80:83]
  ds_read_b128 v[194:197], v3 offset:62464
  v_mfma_f32_16x16x32_bf16 v[84:87], v[202:205], a[204:207], v[84:87]
  s_waitcnt lgkmcnt(4)
  v_mfma_f32_16x16x32_bf16 v[72:75], v[174:177], a[208:211], v[72:75]
  ds_read_b128 v[198:201], v3 offset:63488
  v_mfma_f32_16x16x32_bf16 v[76:79], v[174:177], a[212:215], v[76:79]
  v_mfma_f32_16x16x32_bf16 v[80:83], v[178:181], a[208:211], v[80:83]
  ds_read_b128 v[202:205], v3 offset:64512
  v_mfma_f32_16x16x32_bf16 v[84:87], v[178:181], a[212:215], v[84:87]
  s_waitcnt lgkmcnt(4)
  v_mfma_f32_16x16x32_bf16 v[72:75], v[182:185], a[216:219], v[72:75]
  ds_read_b128 v[174:177], v4 offset:0
  v_mfma_f32_16x16x32_bf16 v[76:79], v[182:185], a[220:223], v[76:79]
  v_mfma_f32_16x16x32_bf16 v[80:83], v[186:189], a[216:219], v[80:83]
  ds_read_b128 v[178:181], v4 offset:1024
  v_mfma_f32_16x16x32_bf16 v[84:87], v[186:189], a[220:223], v[84:87]
  s_waitcnt lgkmcnt(4)
  v_mfma_f32_16x16x32_bf16 v[72:75], v[190:193], a[224:227], v[72:75]
  ds_read_b128 v[182:185], v4 offset:2048
  v_mfma_f32_16x16x32_bf16 v[76:79], v[190:193], a[228:231], v[76:79]
  v_mfma_f32_16x16x32_bf16 v[80:83], v[194:197], a[224:227], v[80:83]
  ds_read_b128 v[186:189], v4 offset:3072
  v_mfma_f32_16x16x32_bf16 v[84:87], v[194:197], a[228:231], v[84:87]
  s_waitcnt lgkmcnt(4)
  v_mfma_f32_16x16x32_bf16 v[72:75], v[198:201], a[232:235], v[72:75]
  ds_read_b128 v[190:193], v4 offset:4096
  v_mfma_f32_16x16x32_bf16 v[76:79], v[198:201], a[236:239], v[76:79]
  v_mfma_f32_16x16x32_bf16 v[80:83], v[202:205], a[232:235], v[80:83]
  ds_read_b128 v[194:197], v4 offset:5120
  v_mfma_f32_16x16x32_bf16 v[84:87], v[202:205], a[236:239], v[84:87]
  s_waitcnt lgkmcnt(4)
  v_mfma_f32_16x16x32_bf16 v[72:75], v[174:177], a[240:243], v[72:75]
  ds_read_b128 v[198:201], v4 offset:6144
  v_mfma_f32_16x16x32_bf16 v[76:79], v[174:177], a[244:247], v[76:79]
  v_mfma_f32_16x16x32_bf16 v[80:83], v[178:181], a[240:243], v[80:83]
  ds_read_b128 v[202:205], v4 offset:7168
  v_mfma_f32_16x16x32_bf16 v[84:87], v[178:181], a[244:247], v[84:87]
  s_waitcnt lgkmcnt(4)
  v_mfma_f32_16x16x32_bf16 v[72:75], v[182:185], a[248:251], v[72:75]
  ds_read_b128 v[174:177], v4 offset:8192
  v_mfma_f32_16x16x32_bf16 v[76:79], v[182:185], a[252:255], v[76:79]
  v_mfma_f32_16x16x32_bf16 v[80:83], v[186:189], a[248:251], v[80:83]
  ds_read_b128 v[178:181], v4 offset:9216
  v_mfma_f32_16x16x32_bf16 v[84:87], v[186:189], a[252:255], v[84:87]
  s_waitcnt lgkmcnt(4)
  v_mfma_f32_16x16x32_bf16 v[72:75], v[190:193], v[110:113], v[72:75]
  ds_read_b128 v[182:185], v4 offset:10240
  v_mfma_f32_16x16x32_bf16 v[76:79], v[190:193], v[114:117], v[76:79]
  v_mfma_f32_16x16x32_bf16 v[80:83], v[194:197], v[110:113], v[80:83]
  ds_read_b128 v[186:189], v4 offset:11264
  v_mfma_f32_16x16x32_bf16 v[84:87], v[194:197], v[114:117], v[84:87]
  s_waitcnt lgkmcnt(4)
  v_mfma_f32_16x16x32_bf16 v[72:75], v[198:201], v[118:121], v[72:75]
  v_mfma_f32_16x16x32_bf16 v[76:79], v[198:201], v[122:125], v[76:79]
  v_mfma_f32_16x16x32_bf16 v[80:83], v[202:205], v[118:121], v[80:83]
  v_mfma_f32_16x16x32_bf16 v[84:87], v[202:205], v[122:125], v[84:87]
  s_waitcnt lgkmcnt(2)
  v_mfma_f32_16x16x32_bf16 v[72:75], v[174:177], v[126:129], v[72:75]
  v_mfma_f32_16x16x32_bf16 v[76:79], v[174:177], v[130:133], v[76:79]
  v_mfma_f32_16x16x32_bf16 v[80:83], v[178:181], v[126:129], v[80:83]
  v_mfma_f32_16x16x32_bf16 v[84:87], v[178:181], v[130:133], v[84:87]
  s_waitcnt lgkmcnt(0)
  v_mfma_f32_16x16x32_bf16 v[72:75], v[182:185], v[134:137], v[72:75]
  v_mfma_f32_16x16x32_bf16 v[76:79], v[182:185], v[138:141], v[76:79]
  v_mfma_f32_16x16x32_bf16 v[80:83], v[186:189], v[134:137], v[80:83]
  v_mfma_f32_16x16x32_bf16 v[84:87], v[186:189], v[138:141], v[84:87]
  s_mov_b32 s38, 0x00003f80
  s_mov_b32 s39, 0x3f800000
  s_cmp_eq_u32 s49, 0
  s_cbranch_scc1 p4_oa
  s_load_dwordx2 s[26:27], s[0:1], 56
  s_waitcnt lgkmcnt(0)
  s_mov_b32 s12, s26
  s_mov_b32 s13, s27
  s_mov_b32 s14, 2359296
  s_mov_b32 s15, 0x20000
  v_mul_u32_u24 v16, 1152, v14
  v_lshl_add_u32 v16, v15, 4, v16
  v_and_b32 v17, 31, v1
  v_mul_u32_u24 v17, 1152, v17
  v_lshl_add_u32 v17, v18, 4, v17
  s_mul_i32 s52, s19, 36864
  s_mul_i32 s48, s17, 288
  s_add_u32 s52, s52, s48
  s_lshl_b32 s48, s18, 6
  s_add_u32 s50, s52, s48
  s_add_u32 s51, s50, 18432
  s_add_u32 s52, s52, 256
  s_branch p4_ob
p4_oa:
  s_mov_b32 s12, s8
  s_mov_b32 s13, s9
  s_mov_b32 s14, 268435456
  s_mov_b32 s15, 0x20000
  v_mov_b32 v16, v6
  v_mov_b32 v17, v3
  s_add_u32 s50, s24, 88080384
  s_add_u32 s51, s50, 256
  s_add_u32 s52, s23, 88088576
p4_ob:
  v_mov_b32 v20, 0
  v_mov_b32 v21, 0
  v_mov_b32 v22, 0
  v_mov_b32 v23, 0
  s_mov_b32 s53, 0x3f803f80
  s_mov_b32 s47, 0
  s_waitcnt vmcnt(9)
  v_dot2_f32_bf16 v72, v158, s38, v72
  v_dot2_f32_bf16 v73, v158, s39, v73
  v_dot2_f32_bf16 v74, v159, s38, v74
  v_dot2_f32_bf16 v75, v159, s39, v75
  v_dot2_f32_bf16 v80, v160, s38, v80
  v_dot2_f32_bf16 v81, v160, s39, v81
  v_dot2_f32_bf16 v82, v161, s38, v82
  v_dot2_f32_bf16 v83, v161, s39, v83
  v_dot2_f32_bf16 v76, v162, s38, v76
  v_dot2_f32_bf16 v77, v162, s39, v77
  v_dot2_f32_bf16 v78, v163, s38, v78
  v_dot2_f32_bf16 v79, v163, s39, v79
  v_dot2_f32_bf16 v84, v164, s38, v84
  v_dot2_f32_bf16 v85, v164, s39, v85
  v_dot2_f32_bf16 v86, v165, s38, v86
  v_dot2_f32_bf16 v87, v165, s39, v87
  v_dot2_f32_bf16 v88, v166, s38, v88
  v_dot2_f32_bf16 v89, v166, s39, v89
  v_dot2_f32_bf16 v90, v167, s38, v90
  v_dot2_f32_bf16 v91, v167, s39, v91
  v_dot2_f32_bf16 v92, v168, s38, v92
  v_dot2_f32_bf16 v93, v168, s39, v93
  v_dot2_f32_bf16 v94, v169, s38, v94
  v_dot2_f32_bf16 v95, v169, s39, v95
  s_branch p4_chk
p4_poll:
  buffer_load_dwordx4 v[206:209], v3, s[8:11], s41 offen offset:0 sc1
  buffer_load_dwordx4 v[210:213], v3, s[8:11], s41 offen offset:1024 sc1
  buffer_load_dwordx4 v[214:217], v3, s[8:11], s41 offen offset:2048 sc1
  buffer_load_dwordx4 v[218:221], v3, s[8:11], s41 offen offset:3072 sc1
  buffer_load_dwordx4 v[222:225], v3, s[8:11], s42 offen offset:0 sc1
  buffer_load_dwordx4 v[226:229], v3, s[8:11], s42 offen offset:1024 sc1
  buffer_load_dwordx4 v[230:233], v3, s[8:11], s43 offen offset:0 sc1
  buffer_load_dwordx4 v[234:237], v3, s[8:11], s43 offen offset:1024 sc1
  buffer_load_dwordx4 v[238:241], v3, s[8:11], s43 offen offset:2048 sc1
p4_chk:
  s_add_u32 s47, s47, 1
  s_waitcnt vmcnt(0)
  v_max3_u32 v12, v206, v207, v208
  v_max3_u32 v13, v209, v210, v211
  v_max3_u32 v13, v13, v212, v213
  v_max3_u32 v12, v12, v214, v215
  v_max3_u32 v13, v13, v216, v217
  v_max3_u32 v12, v12, v218, v219
  v_max3_u32 v13, v13, v220, v221
  v_max3_u32 v12, v12, v222, v223
  v_max3_u32 v13, v13, v224, v225
  v_max3_u32 v12, v12, v226, v227
  v_max3_u32 v13, v13, v228, v229
  v_max3_u32 v12, v12, v230, v231
  v_max3_u32 v13, v13, v232, v233
  v_max3_u32 v12, v12, v234, v235
  v_max3_u32 v13, v13, v236, v237
  v_max3_u32 v12, v12, v238, v239
  v_max3_u32 v13, v13, v240, v241
  v_max_u32 v12, v12, v13
  v_cmp_eq_u32 vcc, -1, v12
  s_cmp_gt_u32 s47, 0x2000
  s_cbranch_scc1 p4_go
  s_cbranch_vccnz p4_poll
p4_go:
  v_dot2_f32_bf16 v72, v206, s38, v72
  v_dot2_f32_bf16 v73, v206, s39, v73
  v_dot2_f32_bf16 v74, v207, s38, v74
  v_dot2_f32_bf16 v75, v207, s39, v75
  v_dot2_f32_bf16 v80, v208, s38, v80
  v_dot2_f32_bf16 v81, v208, s39, v81
  v_dot2_f32_bf16 v82, v209, s38, v82
  v_dot2_f32_bf16 v83, v209, s39, v83
  v_dot2_f32_bf16 v76, v210, s38, v76
  v_dot2_f32_bf16 v77, v210, s39, v77
  v_dot2_f32_bf16 v78, v211, s38, v78
  v_dot2_f32_bf16 v79, v211, s39, v79
  v_dot2_f32_bf16 v84, v212, s38, v84
  v_dot2_f32_bf16 v85, v212, s39, v85
  v_dot2_f32_bf16 v86, v213, s38, v86
  v_dot2_f32_bf16 v87, v213, s39, v87
  v_dot2_f32_bf16 v72, v214, s38, v72
  v_dot2_f32_bf16 v73, v214, s39, v73
  v_dot2_f32_bf16 v74, v215, s38, v74
  v_dot2_f32_bf16 v75, v215, s39, v75
  v_dot2_f32_bf16 v80, v216, s38, v80
  v_dot2_f32_bf16 v81, v216, s39, v81
  v_dot2_f32_bf16 v82, v217, s38, v82
  v_dot2_f32_bf16 v83, v217, s39, v83
  v_dot2_f32_bf16 v76, v218, s38, v76
  v_dot2_f32_bf16 v77, v218, s39, v77
  v_dot2_f32_bf16 v78, v219, s38, v78
  v_dot2_f32_bf16 v79, v219, s39, v79
  v_dot2_f32_bf16 v84, v220, s38, v84
  v_dot2_f32_bf16 v85, v220, s39, v85
  v_dot2_f32_bf16 v86, v221, s38, v86
  v_dot2_f32_bf16 v87, v221, s39, v87
  v_dot2_f32_bf16 v72, v222, s38, v72
  v_dot2_f32_bf16 v73, v222, s39, v73
  v_dot2_f32_bf16 v74, v223, s38, v74
  v_dot2_f32_bf16 v75, v223, s39, v75
  v_dot2_f32_bf16 v80, v224, s38, v80
  v_dot2_f32_bf16 v81, v224, s39, v81
  v_dot2_f32_bf16 v82, v225, s38, v82
  v_dot2_f32_bf16 v83, v225, s39, v83
  v_dot2_f32_bf16 v76, v226, s38, v76
  v_dot2_f32_bf16 v77, v226, s39, v77
  v_dot2_f32_bf16 v78, v227, s38, v78
  v_dot2_f32_bf16 v79, v227, s39, v79
  v_dot2_f32_bf16 v84, v228, s38, v84
  v_dot2_f32_bf16 v85, v228, s39, v85
  v_dot2_f32_bf16 v86, v229, s38, v86
  v_dot2_f32_bf16 v87, v229, s39, v87
  s_nop 0
  v_cvt_pk_bf16_f32 v142, v72, v73
  v_cvt_pk_bf16_f32 v143, v74, v75
  v_cvt_pk_bf16_f32 v144, v80, v81
  v_cvt_pk_bf16_f32 v145, v82, v83
  buffer_store_dwordx4 v[142:145], v16, s[12:15], s50 offen sc1
  v_cvt_pk_bf16_f32 v146, v76, v77
  v_cvt_pk_bf16_f32 v147, v78, v79
  v_cvt_pk_bf16_f32 v148, v84, v85
  v_cvt_pk_bf16_f32 v149, v86, v87
  buffer_store_dwordx4 v[146:149], v16, s[12:15], s51 offen sc1
  s_cmp_lg_u32 s18, s20
  s_cbranch_scc1 p4_no9
  v_dot2_f32_bf16 v88, v230, s38, v88
  v_dot2_f32_bf16 v89, v230, s39, v89
  v_dot2_f32_bf16 v90, v231, s38, v90
  v_dot2_f32_bf16 v91, v231, s39, v91
  v_dot2_f32_bf16 v92, v232, s38, v92
  v_dot2_f32_bf16 v93, v232, s39, v93
  v_dot2_f32_bf16 v94, v233, s38, v94
  v_dot2_f32_bf16 v95, v233, s39, v95
  v_dot2_f32_bf16 v88, v234, s38, v88
  v_dot2_f32_bf16 v89, v234, s39, v89
  v_dot2_f32_bf16 v90, v235, s38, v90
  v_dot2_f32_bf16 v91, v235, s39, v91
  v_dot2_f32_bf16 v92, v236, s38, v92
  v_dot2_f32_bf16 v93, v236, s39, v93
  v_dot2_f32_bf16 v94, v237, s38, v94
  v_dot2_f32_bf16 v95, v237, s39, v95
  v_dot2_f32_bf16 v88, v238, s38, v88
  v_dot2_f32_bf16 v89, v238, s39, v89
  v_dot2_f32_bf16 v90, v239, s38, v90
  v_dot2_f32_bf16 v91, v239, s39, v91
  v_dot2_f32_bf16 v92, v240, s38, v92
  v_dot2_f32_bf16 v93, v240, s39, v93
  v_dot2_f32_bf16 v94, v241, s38, v94
  v_dot2_f32_bf16 v95, v241, s39, v95
  s_nop 0
  v_cvt_pk_bf16_f32 v150, v88, v89
  v_cvt_pk_bf16_f32 v151, v90, v91
  v_cvt_pk_bf16_f32 v152, v92, v93
  v_cvt_pk_bf16_f32 v153, v94, v95
  v_dot2c_f32_bf16 v20, s53, v150
  v_dot2c_f32_bf16 v21, v150, v150
  v_dot2c_f32_bf16 v20, s53, v151
  v_dot2c_f32_bf16 v21, v151, v151
  v_dot2c_f32_bf16 v22, s53, v152
  v_dot2c_f32_bf16 v23, v152, v152
  v_dot2c_f32_bf16 v22, s53, v153
  v_dot2c_f32_bf16 v23, v153, v153
  v_permlane16_swap_b32 v150, v152
  v_permlane16_swap_b32 v151, v153
  buffer_store_dwordx4 v[150:153], v17, s[12:15], s52 offen sc1
p4_no9:
  s_cmp_lg_u32 s49, 0
  s_cbranch_scc1 main_kernel_end
  v_dot2c_f32_bf16 v20, s53, v142
  v_dot2c_f32_bf16 v21, v142, v142
  v_dot2c_f32_bf16 v20, s53, v143
  v_dot2c_f32_bf16 v21, v143, v143
  v_dot2c_f32_bf16 v20, s53, v144
  v_dot2c_f32_bf16 v21, v144, v144
  v_dot2c_f32_bf16 v20, s53, v145
  v_dot2c_f32_bf16 v21, v145, v145
  v_dot2c_f32_bf16 v22, s53, v146
  v_dot2c_f32_bf16 v23, v146, v146
  v_dot2c_f32_bf16 v22, s53, v147
  v_dot2c_f32_bf16 v23, v147, v147
  v_dot2c_f32_bf16 v22, s53, v148
  v_dot2c_f32_bf16 v23, v148, v148
  v_dot2c_f32_bf16 v22, s53, v149
  v_dot2c_f32_bf16 v23, v149, v149
  s_lshl_b32 s47, s17, 2
  s_add_u32 s47, s47, s18
  s_lshl_b32 s47, s47, 14
  s_lshl_b32 s48, s19, 8
  s_add_u32 s47, s47, s48
  s_add_u32 s47, s47, 115867648
  v_permlane16_swap_b32 v20, v22
  v_permlane16_swap_b32 v21, v23
  v_add_f32 v20, v20, v22
  v_add_f32 v21, v21, v23
  v_mov_b32 v22, v20
  v_mov_b32 v23, v21
  v_lshlrev_b32 v11, 3, v1
  v_lshl_or_b32 v11, v18, 31, v11
  v_permlane32_swap_b32 v22, v20
  v_permlane32_swap_b32 v23, v21
  v_add_f32 v20, v20, v22
  v_add_f32 v21, v21, v23
  buffer_store_dwordx2 v[20:21], v11, s[8:11], s47 offen sc1
  s_lshr_b32 s48, s19, 2
  s_lshl_b32 s48, s48, 2
  s_add_u32 s48, s48, s17
  s_lshl_b32 s48, s48, 2
  s_add_u32 s48, s48, s18
  s_lshl_b32 s48, s48, 6
  s_add_u32 s48, s48, 151044096
  v_mov_b32 v12, 1
  v_min_u32 v13, 1, v0
  v_lshlrev_b32 v13, 31, v13
  s_waitcnt vmcnt(0)
  s_barrier
  buffer_store_dword v12, v13, s[8:11], s48 offen sc1
  s_mov_b32 s49, 1
  s_add_u32 s8, s8, 67108864
  s_addc_u32 s9, s9, 0
  s_cmp_lt_u32 s2, 224
  s_cbranch_scc1 main_p1
main_s1:
  s_mov_b32 s44, 256
  s_sub_u32 s45, s2, 80
  s_cmp_ge_u32 s2, 224
  s_cselect_b32 s44, s45, s44
  s_mov_b32 s3, 1
  s_cmp_ge_u32 s2, 256
  s_cbranch_scc1 main_n2
  s_cmp_lg_u32 s49, 0
  s_cbranch_scc1 main_n2
  s_mov_b32 s43, 256
  s_mov_b32 s45, 0
  s_mov_b32 s46, 0
  s_branch prep_common
main_s3:
  v_mov_b32 v12, 2
  v_min_u32 v13, 1, v0
  v_lshlrev_b32 v13, 31, v13
  s_waitcnt vmcnt(0)
  s_barrier
  buffer_store_dword v12, v13, s[8:11], s48 offen sc1
  s_mov_b32 s44, 256
  s_sub_u32 s45, s2, 16
  s_cmp_ge_u32 s2, 192
  s_cselect_b32 s44, s45, s44
  s_mov_b32 s3, 2
  s_cmp_ge_u32 s2, 232
  s_cbranch_scc1 main_p4
  s_cmp_lg_u32 s49, 0
  s_cbranch_scc1 main_p4
  s_mov_b32 s43, 256
  s_mov_b32 s45, 0
  s_mov_b32 s46, 0
  s_branch prep_common
main_ret:
  s_load_dwordx2 s[4:5], s[0:1], 72
  v_and_b32 v1, 63, v0
  v_lshrrev_b32 v2, 6, v0
  v_lshlrev_b32 v3, 4, v1
  v_readfirstlane_b32 s20, v2
  s_mov_b32 s49, 0
  s_mov_b32 s6, 268435456
  s_mov_b32 s7, 0x20000
  s_mov_b32 s10, 268435456
  s_mov_b32 s11, 0x20000
  s_waitcnt lgkmcnt(0)
  s_mov_b32 s8, s4
  s_mov_b32 s9, s5
  s_cmp_eq_u32 s3, 1
  s_cbranch_scc1 main_n2
  s_branch main_p4
main_n2:
  s_bfe_u32 s31, s2, 0x40003
  s_lshr_b32 s33, s2, 7
  s_and_b32 s32, s2, 7
  s_lshl_b32 s32, s32, 1
  s_add_u32 s32, s32, s33
  s_lshr_b32 s35, s32, 2
  s_mul_i32 s34, s35, 0x1010001
  s_add_u32 s34, s34, 0x80809984
  s_mul_i32 s36, s32, 18
  s_lshr_b32 s35, s36, 6
  s_lshl_b32 s35, s35, 8
  s_add_u32 s34, s34, s35
  s_add_u32 s36, s36, 17
  s_lshr_b32 s36, s36, 6
  s_lshl_b32 s36, s36, 12
  s_add_u32 s34, s34, s36
  v_bfe_u32 v184, v1, 2, 2
  v_and_b32 v185, 3, v1
  v_cmp_eq_u32 vcc, 3, v184
  v_min_u32 v184, 2, v184
  v_add_u32 v186, 4, v185
  v_cndmask_b32 v185, v185, v186, vcc
  v_lshlrev_b32 v185, 2, v185
  v_bfe_u32 v185, s34, v185, 4
  s_sub_u32 s35, s31, 2
  v_add_u32 v184, s35, v184
  v_max_i32 v184, 0, v184
  v_lshl_add_u32 v184, v184, 4, v185
  v_lshlrev_b32 v184, 6, v184
  s_mov_b32 s40, 83886080
  s_lshl_b32 s34, s31, 2
  s_add_u32 s33, s34, s20
  v_and_b32 v191, 31, v1
  v_lshrrev_b32 v192, 5, v1
  s_mul_i32 s35, s20, 3
  s_add_u32 s34, s34, s35
  s_sub_u32 s34, s34, 8
  s_lshl_b32 s41, s32, 16
  s_add_u32 s42, s41, 36700160
  s_add_u32 s41, s41, 38797312
  s_lshl_b32 s35, s33, 10
  s_add_u32 s42, s42, s35
  s_bfe_u32 s43, s32, 0x10002
  s_lshl_b32 s43, s43, 16
  s_bfe_u32 s44, s32, 0x10003
  s_lshl_b32 s44, s44, 9
  s_add_u32 s43, s43, s44
  s_and_b32 s44, s32, 3
  s_lshl_b32 s44, s44, 2
  s_add_u32 s43, s43, s44
  s_add_u32 s43, s43, 40894464
  s_add_u32 s44, s43, s35
  s_add_u32 s43, s43, 0x20000
  s_lshl_b32 s35, s34, 10
  v_add_u32 v186, s35, v3
  v_lshlrev_b32 v187, 4, v191
  v_lshl_add_u32 v188, v192, 10, v187
  v_add_u32 v188, s35, v188
  s_add_u32 s12, s8, 41943040
  s_addc_u32 s13, s9, 0
  s_mov_b32 s14, 2359360
  s_mov_b32 s15, 0x20000
  s_mul_i32 s34, s34, 36864
  s_mul_i32 s36, s32, 288
  s_add_u32 s34, s34, s36
  v_mul_u32_u24 v189, 9216, v192
  v_add_u32 v189, v189, v187
  v_cmp_gt_u32 vcc, 18, v191
  v_add_u32 v189, s34, v189
  v_mov_b32 v190, 2359296
  v_lshl_or_b32 v187, v192, 31, v187
  v_cndmask_b32 v189, v190, v189, vcc
  v_mov_b32 v190, 18432
  s_mul_i32 s35, s20, 3072
  v_cndmask_b32 v190, 0, v190, vcc
  s_mul_i32 s37, s20, 384
  s_add_u32 s37, s37, 24576
  s_mul_i32 s38, s20, 6144
  s_add_u32 s38, s38, 28672
  buffer_load_dword v185, v184, s[8:11], s40 offen sc1
  s_waitcnt vmcnt(0)
  s_mov_b32 s53, 0
  s_branch p2_enc
p2_enp:
  buffer_load_dword v185, v184, s[8:11], s40 offen sc1
  s_add_u32 s53, s53, 1
  s_waitcnt vmcnt(0)
p2_enc:
  v_cmp_gt_u32 vcc, 1, v185
  s_cmp_gt_u32 s53, 0x8000
  s_cbranch_scc1 p2_eng
  s_cbranch_vccz p2_eng
  s_sleep 2
  s_branch p2_enp
p2_eng:
  s_add_u32 m0, s35, 0
  s_nop 0
  buffer_load_dwordx4 v186, s[8:11], s41 offen sc1 lds
  s_add_u32 m0, s35, 1024
  v_add_u32 v186, 1024, v186
  buffer_load_dwordx4 v186, s[8:11], s41 offen sc1 lds
  s_add_u32 m0, s35, 2048
  v_add_u32 v186, 1024, v186
  buffer_load_dwordx4 v186, s[8:11], s41 offen sc1 lds
  s_add_u32 m0, s37, 0
  s_nop 0
  buffer_load_dword v188, s[8:11], s43 offen sc1 lds
  s_add_u32 m0, s37, 256
  v_add_u32 v188, 2048, v188
  buffer_load_dword v188, s[8:11], s43 offen sc1 lds
  buffer_load_dwordx4 v[124:127], v3, s[8:11], s42 offen sc1
  buffer_load_dword v128, v187, s[8:11], s44 offen sc1
  s_add_u32 m0, s38, 0
  s_nop 0
  buffer_load_dwordx4 v189, s[12:15], 0 offen sc1 lds
  s_add_u32 m0, s38, 1024
  v_add_u32 v189, v189, v190
  buffer_load_dwordx4 v189, s[12:15], 0 offen sc1 lds
  s_add_u32 m0, s38, 2048
  v_add_u32 v189, v189, v190
  buffer_load_dwordx4 v189, s[12:15], 0 offen sc1 lds
  s_add_u32 m0, s38, 3072
  v_add_u32 v189, v189, v190
  buffer_load_dwordx4 v189, s[12:15], 0 offen sc1 lds
  s_add_u32 m0, s38, 4096
  v_add_u32 v189, v189, v190
  buffer_load_dwordx4 v189, s[12:15], 0 offen sc1 lds
  s_add_u32 m0, s38, 5120
  v_add_u32 v189, v189, v190
  buffer_load_dwordx4 v189, s[12:15], 0 offen sc1 lds
  s_waitcnt vmcnt(6)
  s_branch main_p2
main_kernel_end:
  s_endpgm
main_kernel_fin:
.fill 2304, 4, 0xbf800000
.section .rodata,"a"
.p2align 6
.amdhsa_kernel prep_kernel
  .amdhsa_next_free_vgpr 132
  .amdhsa_next_free_sgpr 64
  .amdhsa_accum_offset 132
  .amdhsa_group_segment_fixed_size 0
  .amdhsa_kernarg_size 80
  .amdhsa_user_sgpr_count 2
  .amdhsa_user_sgpr_kernarg_segment_ptr 1
  .amdhsa_system_sgpr_workgroup_id_x 1
.end_amdhsa_kernel
.p2align 6
.amdhsa_kernel main_kernel
  .amdhsa_next_free_vgpr 512
  .amdhsa_next_free_sgpr 64
  .amdhsa_accum_offset 256
  .amdhsa_group_segment_fixed_size 0
  .amdhsa_kernarg_size 80
  .amdhsa_user_sgpr_count 2
  .amdhsa_user_sgpr_kernarg_segment_ptr 1
  .amdhsa_system_sgpr_workgroup_id_x 1
.end_amdhsa_kernel
```
